```python
import torch

def _softmax(x, axis=-1):
    return torch.softmax(x, dim=axis)
def _gelu(x):
    return torch.nn.functional.gelu(x, approximate="tanh")
def _silu(x):
    return torch.nn.functional.silu(x)
def _sigmoid(x):
    return torch.sigmoid(x)
def _layernorm(x, axis=-1, eps=1e-5):
    m = x.mean(dim=axis, keepdim=True)
    v = x.var(dim=axis, keepdim=True, unbiased=False)
    return (x - m) / torch.sqrt(v + eps)
def _scatter_add(tgt, idx, src, axis=0):
    return tgt.clone().index_add_(axis, idx, src)
def _segment_sum(src, seg, n):
    out = torch.zeros((n,) + src.shape[1:], dtype=src.dtype)
    return out.index_add_(0, seg, src)
def _pad(x, pw):
    flat = tuple(v for pair in reversed(pw) for v in pair)
    return torch.nn.functional.pad(x, flat)

kernel_name = 'recurrent_scan__softmax_full_mha__dense_activation_relu__prompt'

def setup_inputs():

    _w = (lambda a: (lambda t: t.to(torch.bfloat16) if t.is_floating_point() else t)(torch.as_tensor(a)))
    def _A_setup():
        B, S, D = 1, 2048, 640
        return {
            "x": _w((lambda *s: torch.randn(*s, dtype=torch.bfloat16) * 0.05)(B, S, D)),
            "wqkv": _w((lambda *s: torch.randn(*s, dtype=torch.bfloat16) * 0.05)(D, 3 * D)),
            "wo": _w((lambda *s: torch.randn(*s, dtype=torch.bfloat16) * 0.05)(D, D)),
        }
    _A_in = _A_setup()

    def _B_setup():
        B, S, D, Dff = 1, 2048, 640, 1536
        return {
            "x": _w((lambda *s: torch.randn(*s, dtype=torch.bfloat16) * 0.05)(B, S, D)),
            "w1": _w((lambda *s: torch.randn(*s, dtype=torch.bfloat16) * 0.05)(D, Dff)),
            "w2": _w((lambda *s: torch.randn(*s, dtype=torch.bfloat16) * 0.05)(Dff, D)),
        }
    _B_in = _B_setup()

    return {
        "A_x": _A_in["x"],
        "A_wqkv": _A_in["wqkv"],
        "A_wo": _A_in["wo"],
        "B_x": _B_in["x"],
        "B_w1": _B_in["w1"],
        "B_w2": _B_in["w2"],
    }

def reference(A_x, A_wqkv, A_wo, B_x, B_w1, B_w2):
    def _A_ref(x, wqkv, wo):
        B, S, D = x.shape
        H = 32; Dh = D // H
        qkv = (lambda x, *d: x.permute(*d))((x @ wqkv).reshape(B, S, 3, H, Dh), 2, 0, 3, 1, 4)
        q, k, v = qkv[0], qkv[1], qkv[2]
        scale = Dh ** -0.5
        scores = torch.einsum("bhqd,bhkd->bhqk", q, k) * scale
        p = _softmax(scores, axis=-1)
        o = torch.einsum("bhqk,bhkd->bhqd", p, v)
        return (lambda x, *d: x.permute(*d))(o, 0, 2, 1, 3).reshape(B, S, D) @ wo

    def _B_ref(x, w1, w2):
        h = torch.einsum("bsd,df->bsf", x, w1)
        zero = torch.zeros_like(h)
        h = torch.maximum(h, zero)
        return torch.einsum("bsf,fd->bsd", h, w2)

    x = A_x
    xn = _layernorm(x, axis=-1)
    s = _A_ref(xn, A_wqkv, A_wo)
    g = _silu(_B_ref(xn, B_w1, B_w2))
    return x + s * g
```

```asm
; @launch kernel=recurrent_scan__softmax_full_mha__dense_activation_relu__prompt_kernel grid=(256,1,1) block=(512,1,1) lds=150080
; @launch kernel=attn_kernel grid=(256,1,1) block=(768,1,1) lds=159232
.amdgcn_target "amdgcn-amd-amdhsa--gfx950"
.text
.globl recurrent_scan__softmax_full_mha__dense_activation_relu__prompt_kernel
.p2align 8
.type recurrent_scan__softmax_full_mha__dense_activation_relu__prompt_kernel,@function
recurrent_scan__softmax_full_mha__dense_activation_relu__prompt_kernel:
  s_cmp_ge_u32 s2, 256
  s_cbranch_scc1 K1_END
  s_load_dwordx8 s[4:11], s[0:1], 0
  s_load_dwordx4 s[12:15], s[0:1], 32
  s_load_dwordx4 s[16:19], s[0:1], 48
  s_load_dwordx2 s[20:21], s[0:1], 64
  v_lshrrev_b32 v1, 6, v0
  v_and_b32 v0, 63, v0
  s_and_b32 s3, s2, 7
  s_lshr_b32 s22, s2, 3
  v_readfirstlane_b32 s36, v1
  s_and_b32 s23, s3, 1
  s_lshl_b32 s23, s23, 2
  s_and_b32 s39, s22, 3
  s_add_u32 s39, s39, s23
  s_lshr_b32 s49, s22, 2
  s_lshr_b32 s50, s3, 1
  s_mul_i32 s50, s50, 7
  s_add_u32 s40, s50, s49
  s_cmp_eq_u32 s49, 7
  s_cbranch_scc1 K1_HELP_A
  s_cmp_ge_u32 s40, 27
  s_cbranch_scc1 K1_HELP_B
  s_cmp_lt_u32 s36, 4
  s_cbranch_scc1 K1_COMP
  s_sub_u32 s42, s36, 4
  s_cmp_lt_u32 s40, 15
  s_cselect_b32 s41, 3840, 0
  s_cselect_b32 s3, 0, 3072
  s_or_b32 s41, s41, s3
  v_lshrrev_b32 v1, 3, v0
  v_mul_u32_u24 v1, 1280, v1
  v_and_b32 v2, 7, v0
  v_lshrrev_b32 v3, 4, v0
  v_xor_b32 v2, v2, v3
  v_lshl_add_u32 v8, v2, 4, v1
  v_xor_b32 v2, 4, v2
  v_lshl_add_u32 v9, v2, 4, v1
  v_mul_u32_u24 v1, s41, v3
  v_lshlrev_b32 v4, 1, v3
  v_and_b32 v2, 15, v0
  v_xor_b32 v2, v2, v4
  v_lshl_add_u32 v10, v2, 4, v1
  v_xor_b32 v2, 8, v2
  v_lshl_add_u32 v11, v2, 4, v1
  s_mul_i32 s43, s42, 81920
  s_lshl_b32 s3, s41, 4
  s_mul_i32 s44, s42, s3
  s_lshl_b32 s45, s42, 13
  s_lshl_b32 s46, s42, 12
  s_add_u32 s46, s46, 32768
  s_lshl_b32 s48, s41, 2
  s_mul_i32 s3, s39, 327680
  s_waitcnt lgkmcnt(0)
  s_add_u32 s24, s4, s3
  s_addc_u32 s25, s5, 0
  s_and_b32 s25, s25, 0xffff
  s_mov_b32 s26, 327680
  s_mov_b32 s27, 0x00020000
  s_cmp_lt_u32 s40, 15
  s_cbranch_scc1 K1_WQKV
  s_sub_u32 s3, s40, 15
  s_lshl_b32 s3, s3, 8
  s_add_u32 s28, s12, s3
  s_addc_u32 s29, s13, 0
  s_sub_u32 s30, 1966080, s3
  s_branch K1_WDONE
K1_WQKV:
  s_lshl_b32 s3, s40, 8
  s_add_u32 s28, s6, s3
  s_addc_u32 s29, s7, 0
  s_sub_u32 s30, 2457600, s3
K1_WDONE:
  s_and_b32 s29, s29, 0xffff
  s_mov_b32 s31, 0x00020000
  s_mul_i32 s50, s48, 0
  s_add_u32 s50, s50, s44
  s_add_u32 m0, s46, 0
  s_nop 0
  buffer_load_dwordx4 v10, s[28:31], s50 offen lds
  s_add_u32 m0, s46, 1024
  s_add_u32 s50, s50, s48
  buffer_load_dwordx4 v10, s[28:31], s50 offen lds
  s_add_u32 m0, s46, 2048
  s_add_u32 s50, s50, s48
  buffer_load_dwordx4 v11, s[28:31], s50 offen lds
  s_add_u32 m0, s46, 3072
  s_add_u32 s50, s50, s48
  buffer_load_dwordx4 v11, s[28:31], s50 offen lds
  s_add_u32 m0, s45, 0
  s_add_u32 s51, s43, 0
  buffer_load_dwordx4 v8, s[24:27], s51 offen lds
  s_add_u32 m0, s45, 1024
  s_add_u32 s51, s43, 10240
  buffer_load_dwordx4 v9, s[24:27], s51 offen lds
  s_add_u32 m0, s45, 2048
  s_add_u32 s51, s43, 20480
  buffer_load_dwordx4 v8, s[24:27], s51 offen lds
  s_add_u32 m0, s45, 3072
  s_add_u32 s51, s43, 30720
  buffer_load_dwordx4 v9, s[24:27], s51 offen lds
  s_add_u32 m0, s45, 4096
  s_add_u32 s51, s43, 40960
  buffer_load_dwordx4 v8, s[24:27], s51 offen lds
  s_add_u32 m0, s45, 5120
  s_add_u32 s51, s43, 51200
  buffer_load_dwordx4 v9, s[24:27], s51 offen lds
  s_add_u32 m0, s45, 6144
  s_add_u32 s51, s43, 61440
  buffer_load_dwordx4 v8, s[24:27], s51 offen lds
  s_add_u32 m0, s45, 7168
  s_add_u32 s51, s43, 71680
  buffer_load_dwordx4 v9, s[24:27], s51 offen lds
  s_mul_i32 s50, s48, 16
  s_add_u32 s50, s50, s44
  s_add_u32 m0, s46, 49152
  s_nop 0
  buffer_load_dwordx4 v10, s[28:31], s50 offen lds
  s_add_u32 m0, s46, 50176
  s_add_u32 s50, s50, s48
  buffer_load_dwordx4 v10, s[28:31], s50 offen lds
  s_add_u32 m0, s46, 51200
  s_add_u32 s50, s50, s48
  buffer_load_dwordx4 v11, s[28:31], s50 offen lds
  s_add_u32 m0, s46, 52224
  s_add_u32 s50, s50, s48
  buffer_load_dwordx4 v11, s[28:31], s50 offen lds
  s_add_u32 m0, s45, 49152
  s_add_u32 s51, s43, 128
  buffer_load_dwordx4 v8, s[24:27], s51 offen lds
  s_add_u32 m0, s45, 50176
  s_add_u32 s51, s43, 10368
  buffer_load_dwordx4 v9, s[24:27], s51 offen lds
  s_add_u32 m0, s45, 51200
  s_add_u32 s51, s43, 20608
  buffer_load_dwordx4 v8, s[24:27], s51 offen lds
  s_add_u32 m0, s45, 52224
  s_add_u32 s51, s43, 30848
  buffer_load_dwordx4 v9, s[24:27], s51 offen lds
  s_add_u32 m0, s45, 53248
  s_add_u32 s51, s43, 41088
  buffer_load_dwordx4 v8, s[24:27], s51 offen lds
  s_add_u32 m0, s45, 54272
  s_add_u32 s51, s43, 51328
  buffer_load_dwordx4 v9, s[24:27], s51 offen lds
  s_add_u32 m0, s45, 55296
  s_add_u32 s51, s43, 61568
  buffer_load_dwordx4 v8, s[24:27], s51 offen lds
  s_add_u32 m0, s45, 56320
  s_add_u32 s51, s43, 71808
  buffer_load_dwordx4 v9, s[24:27], s51 offen lds
  s_add_u32 s60, s20, 25165824
  s_addc_u32 s61, s21, 0
  s_and_b32 s61, s61, 0xffff
  s_mov_b32 s62, 65536
  s_mov_b32 s63, 0x00020000
  s_mov_b32 s47, 0
  s_waitcnt vmcnt(12)
  s_barrier
  s_mul_i32 s50, s48, 32
  s_add_u32 s50, s50, s44
  s_add_u32 m0, s46, 98304
  s_nop 0
  buffer_load_dwordx4 v10, s[28:31], s50 offen lds
  s_add_u32 m0, s46, 99328
  s_add_u32 s50, s50, s48
  buffer_load_dwordx4 v10, s[28:31], s50 offen lds
  s_add_u32 m0, s46, 100352
  s_add_u32 s50, s50, s48
  buffer_load_dwordx4 v11, s[28:31], s50 offen lds
  s_add_u32 m0, s46, 101376
  s_add_u32 s50, s50, s48
  buffer_load_dwordx4 v11, s[28:31], s50 offen lds
  s_add_u32 m0, s45, 98304
  s_add_u32 s51, s43, 256
  buffer_load_dwordx4 v8, s[24:27], s51 offen lds
  s_add_u32 m0, s45, 99328
  s_add_u32 s51, s43, 10496
  buffer_load_dwordx4 v9, s[24:27], s51 offen lds
  s_add_u32 m0, s45, 100352
  s_add_u32 s51, s43, 20736
  buffer_load_dwordx4 v8, s[24:27], s51 offen lds
  s_add_u32 m0, s45, 101376
  s_add_u32 s51, s43, 30976
  buffer_load_dwordx4 v9, s[24:27], s51 offen lds
  s_add_u32 m0, s45, 102400
  s_add_u32 s51, s43, 41216
  buffer_load_dwordx4 v8, s[24:27], s51 offen lds
  s_add_u32 m0, s45, 103424
  s_add_u32 s51, s43, 51456
  buffer_load_dwordx4 v9, s[24:27], s51 offen lds
  s_add_u32 m0, s45, 104448
  s_add_u32 s51, s43, 61696
  buffer_load_dwordx4 v8, s[24:27], s51 offen lds
  s_add_u32 m0, s45, 105472
  s_add_u32 s51, s43, 71936
  buffer_load_dwordx4 v9, s[24:27], s51 offen lds
  s_waitcnt vmcnt(12)
  s_barrier
  s_mul_i32 s50, s48, 48
  s_add_u32 s50, s50, s44
  s_add_u32 m0, s46, 0
  s_nop 0
  buffer_load_dwordx4 v10, s[28:31], s50 offen lds
  s_add_u32 m0, s46, 1024
  s_add_u32 s50, s50, s48
  buffer_load_dwordx4 v10, s[28:31], s50 offen lds
  s_add_u32 m0, s46, 2048
  s_add_u32 s50, s50, s48
  buffer_load_dwordx4 v11, s[28:31], s50 offen lds
  s_add_u32 m0, s46, 3072
  s_add_u32 s50, s50, s48
  buffer_load_dwordx4 v11, s[28:31], s50 offen lds
  s_add_u32 m0, s45, 0
  s_add_u32 s51, s43, 384
  buffer_load_dwordx4 v8, s[24:27], s51 offen lds
  s_add_u32 m0, s45, 1024
  s_add_u32 s51, s43, 10624
  buffer_load_dwordx4 v9, s[24:27], s51 offen lds
  s_add_u32 m0, s45, 2048
  s_add_u32 s51, s43, 20864
  buffer_load_dwordx4 v8, s[24:27], s51 offen lds
  s_add_u32 m0, s45, 3072
  s_add_u32 s51, s43, 31104
  buffer_load_dwordx4 v9, s[24:27], s51 offen lds
  s_add_u32 m0, s45, 4096
  s_add_u32 s51, s43, 41344
  buffer_load_dwordx4 v8, s[24:27], s51 offen lds
  s_add_u32 m0, s45, 5120
  s_add_u32 s51, s43, 51584
  buffer_load_dwordx4 v9, s[24:27], s51 offen lds
  s_add_u32 m0, s45, 6144
  s_add_u32 s51, s43, 61824
  buffer_load_dwordx4 v8, s[24:27], s51 offen lds
  s_add_u32 m0, s45, 7168
  s_add_u32 s51, s43, 72064
  buffer_load_dwordx4 v9, s[24:27], s51 offen lds
  s_waitcnt vmcnt(12)
  s_barrier
  s_mul_i32 s50, s48, 64
  s_add_u32 s50, s50, s44
  s_add_u32 m0, s46, 49152
  s_nop 0
  buffer_load_dwordx4 v10, s[28:31], s50 offen lds
  s_add_u32 m0, s46, 50176
  s_add_u32 s50, s50, s48
  buffer_load_dwordx4 v10, s[28:31], s50 offen lds
  s_add_u32 m0, s46, 51200
  s_add_u32 s50, s50, s48
  buffer_load_dwordx4 v11, s[28:31], s50 offen lds
  s_add_u32 m0, s46, 52224
  s_add_u32 s50, s50, s48
  buffer_load_dwordx4 v11, s[28:31], s50 offen lds
  s_add_u32 m0, s45, 49152
  s_add_u32 s51, s43, 512
  buffer_load_dwordx4 v8, s[24:27], s51 offen lds
  s_add_u32 m0, s45, 50176
  s_add_u32 s51, s43, 10752
  buffer_load_dwordx4 v9, s[24:27], s51 offen lds
  s_add_u32 m0, s45, 51200
  s_add_u32 s51, s43, 20992
  buffer_load_dwordx4 v8, s[24:27], s51 offen lds
  s_add_u32 m0, s45, 52224
  s_add_u32 s51, s43, 31232
  buffer_load_dwordx4 v9, s[24:27], s51 offen lds
  s_add_u32 m0, s45, 53248
  s_add_u32 s51, s43, 41472
  buffer_load_dwordx4 v8, s[24:27], s51 offen lds
  s_add_u32 m0, s45, 54272
  s_add_u32 s51, s43, 51712
  buffer_load_dwordx4 v9, s[24:27], s51 offen lds
  s_add_u32 m0, s45, 55296
  s_add_u32 s51, s43, 61952
  buffer_load_dwordx4 v8, s[24:27], s51 offen lds
  s_add_u32 m0, s45, 56320
  s_add_u32 s51, s43, 72192
  buffer_load_dwordx4 v9, s[24:27], s51 offen lds
  s_waitcnt vmcnt(12)
  s_barrier
  s_mul_i32 s50, s48, 80
  s_add_u32 s50, s50, s44
  s_add_u32 m0, s46, 98304
  s_nop 0
  buffer_load_dwordx4 v10, s[28:31], s50 offen lds
  s_add_u32 m0, s46, 99328
  s_add_u32 s50, s50, s48
  buffer_load_dwordx4 v10, s[28:31], s50 offen lds
  s_add_u32 m0, s46, 100352
  s_add_u32 s50, s50, s48
  buffer_load_dwordx4 v11, s[28:31], s50 offen lds
  s_add_u32 m0, s46, 101376
  s_add_u32 s50, s50, s48
  buffer_load_dwordx4 v11, s[28:31], s50 offen lds
  s_add_u32 m0, s45, 98304
  s_add_u32 s51, s43, 640
  buffer_load_dwordx4 v8, s[24:27], s51 offen lds
  s_add_u32 m0, s45, 99328
  s_add_u32 s51, s43, 10880
  buffer_load_dwordx4 v9, s[24:27], s51 offen lds
  s_add_u32 m0, s45, 100352
  s_add_u32 s51, s43, 21120
  buffer_load_dwordx4 v8, s[24:27], s51 offen lds
  s_add_u32 m0, s45, 101376
  s_add_u32 s51, s43, 31360
  buffer_load_dwordx4 v9, s[24:27], s51 offen lds
  s_add_u32 m0, s45, 102400
  s_add_u32 s51, s43, 41600
  buffer_load_dwordx4 v8, s[24:27], s51 offen lds
  s_add_u32 m0, s45, 103424
  s_add_u32 s51, s43, 51840
  buffer_load_dwordx4 v9, s[24:27], s51 offen lds
  s_add_u32 m0, s45, 104448
  s_add_u32 s51, s43, 62080
  buffer_load_dwordx4 v8, s[24:27], s51 offen lds
  s_add_u32 m0, s45, 105472
  s_add_u32 s51, s43, 72320
  buffer_load_dwordx4 v9, s[24:27], s51 offen lds
  s_waitcnt vmcnt(12)
  s_barrier
  s_mul_i32 s50, s48, 96
  s_add_u32 s50, s50, s44
  s_add_u32 m0, s46, 0
  s_nop 0
  buffer_load_dwordx4 v10, s[28:31], s50 offen lds
  s_add_u32 m0, s46, 1024
  s_add_u32 s50, s50, s48
  buffer_load_dwordx4 v10, s[28:31], s50 offen lds
  s_add_u32 m0, s46, 2048
  s_add_u32 s50, s50, s48
  buffer_load_dwordx4 v11, s[28:31], s50 offen lds
  s_add_u32 m0, s46, 3072
  s_add_u32 s50, s50, s48
  buffer_load_dwordx4 v11, s[28:31], s50 offen lds
  s_add_u32 m0, s45, 0
  s_add_u32 s51, s43, 768
  buffer_load_dwordx4 v8, s[24:27], s51 offen lds
  s_add_u32 m0, s45, 1024
  s_add_u32 s51, s43, 11008
  buffer_load_dwordx4 v9, s[24:27], s51 offen lds
  s_add_u32 m0, s45, 2048
  s_add_u32 s51, s43, 21248
  buffer_load_dwordx4 v8, s[24:27], s51 offen lds
  s_add_u32 m0, s45, 3072
  s_add_u32 s51, s43, 31488
  buffer_load_dwordx4 v9, s[24:27], s51 offen lds
  s_add_u32 m0, s45, 4096
  s_add_u32 s51, s43, 41728
  buffer_load_dwordx4 v8, s[24:27], s51 offen lds
  s_add_u32 m0, s45, 5120
  s_add_u32 s51, s43, 51968
  buffer_load_dwordx4 v9, s[24:27], s51 offen lds
  s_add_u32 m0, s45, 6144
  s_add_u32 s51, s43, 62208
  buffer_load_dwordx4 v8, s[24:27], s51 offen lds
  s_add_u32 m0, s45, 7168
  s_add_u32 s51, s43, 72448
  buffer_load_dwordx4 v9, s[24:27], s51 offen lds
  s_waitcnt vmcnt(12)
  s_barrier
  s_mul_i32 s50, s48, 112
  s_add_u32 s50, s50, s44
  s_add_u32 m0, s46, 49152
  s_nop 0
  buffer_load_dwordx4 v10, s[28:31], s50 offen lds
  s_add_u32 m0, s46, 50176
  s_add_u32 s50, s50, s48
  buffer_load_dwordx4 v10, s[28:31], s50 offen lds
  s_add_u32 m0, s46, 51200
  s_add_u32 s50, s50, s48
  buffer_load_dwordx4 v11, s[28:31], s50 offen lds
  s_add_u32 m0, s46, 52224
  s_add_u32 s50, s50, s48
  buffer_load_dwordx4 v11, s[28:31], s50 offen lds
  s_add_u32 m0, s45, 49152
  s_add_u32 s51, s43, 896
  buffer_load_dwordx4 v8, s[24:27], s51 offen lds
  s_add_u32 m0, s45, 50176
  s_add_u32 s51, s43, 11136
  buffer_load_dwordx4 v9, s[24:27], s51 offen lds
  s_add_u32 m0, s45, 51200
  s_add_u32 s51, s43, 21376
  buffer_load_dwordx4 v8, s[24:27], s51 offen lds
  s_add_u32 m0, s45, 52224
  s_add_u32 s51, s43, 31616
  buffer_load_dwordx4 v9, s[24:27], s51 offen lds
  s_add_u32 m0, s45, 53248
  s_add_u32 s51, s43, 41856
  buffer_load_dwordx4 v8, s[24:27], s51 offen lds
  s_add_u32 m0, s45, 54272
  s_add_u32 s51, s43, 52096
  buffer_load_dwordx4 v9, s[24:27], s51 offen lds
  s_add_u32 m0, s45, 55296
  s_add_u32 s51, s43, 62336
  buffer_load_dwordx4 v8, s[24:27], s51 offen lds
  s_add_u32 m0, s45, 56320
  s_add_u32 s51, s43, 72576
  buffer_load_dwordx4 v9, s[24:27], s51 offen lds
  s_waitcnt vmcnt(12)
  s_barrier
  s_mul_i32 s50, s48, 128
  s_add_u32 s50, s50, s44
  s_add_u32 m0, s46, 98304
  s_nop 0
  buffer_load_dwordx4 v10, s[28:31], s50 offen lds
  s_add_u32 m0, s46, 99328
  s_add_u32 s50, s50, s48
  buffer_load_dwordx4 v10, s[28:31], s50 offen lds
  s_add_u32 m0, s46, 100352
  s_add_u32 s50, s50, s48
  buffer_load_dwordx4 v11, s[28:31], s50 offen lds
  s_add_u32 m0, s46, 101376
  s_add_u32 s50, s50, s48
  buffer_load_dwordx4 v11, s[28:31], s50 offen lds
  s_add_u32 m0, s45, 98304
  s_add_u32 s51, s43, 1024
  buffer_load_dwordx4 v8, s[24:27], s51 offen lds
  s_add_u32 m0, s45, 99328
  s_add_u32 s51, s43, 11264
  buffer_load_dwordx4 v9, s[24:27], s51 offen lds
  s_add_u32 m0, s45, 100352
  s_add_u32 s51, s43, 21504
  buffer_load_dwordx4 v8, s[24:27], s51 offen lds
  s_add_u32 m0, s45, 101376
  s_add_u32 s51, s43, 31744
  buffer_load_dwordx4 v9, s[24:27], s51 offen lds
  s_add_u32 m0, s45, 102400
  s_add_u32 s51, s43, 41984
  buffer_load_dwordx4 v8, s[24:27], s51 offen lds
  s_add_u32 m0, s45, 103424
  s_add_u32 s51, s43, 52224
  buffer_load_dwordx4 v9, s[24:27], s51 offen lds
  s_add_u32 m0, s45, 104448
  s_add_u32 s51, s43, 62464
  buffer_load_dwordx4 v8, s[24:27], s51 offen lds
  s_add_u32 m0, s45, 105472
  s_add_u32 s51, s43, 72704
  buffer_load_dwordx4 v9, s[24:27], s51 offen lds
  s_waitcnt vmcnt(12)
  s_barrier
  s_cmp_lg_u32 s36, 4
  s_cbranch_scc1 K1_NP7
  v_mov_b32 v1, 0
  global_load_dword v12, v1, s[18:19] sc1
K1_NP7:
  s_mul_i32 s50, s48, 144
  s_add_u32 s50, s50, s44
  s_add_u32 m0, s46, 0
  s_nop 0
  buffer_load_dwordx4 v10, s[28:31], s50 offen lds
  s_add_u32 m0, s46, 1024
  s_add_u32 s50, s50, s48
  buffer_load_dwordx4 v10, s[28:31], s50 offen lds
  s_add_u32 m0, s46, 2048
  s_add_u32 s50, s50, s48
  buffer_load_dwordx4 v11, s[28:31], s50 offen lds
  s_add_u32 m0, s46, 3072
  s_add_u32 s50, s50, s48
  buffer_load_dwordx4 v11, s[28:31], s50 offen lds
  s_add_u32 m0, s45, 0
  s_add_u32 s51, s43, 1152
  buffer_load_dwordx4 v8, s[24:27], s51 offen lds
  s_add_u32 m0, s45, 1024
  s_add_u32 s51, s43, 11392
  buffer_load_dwordx4 v9, s[24:27], s51 offen lds
  s_add_u32 m0, s45, 2048
  s_add_u32 s51, s43, 21632
  buffer_load_dwordx4 v8, s[24:27], s51 offen lds
  s_add_u32 m0, s45, 3072
  s_add_u32 s51, s43, 31872
  buffer_load_dwordx4 v9, s[24:27], s51 offen lds
  s_add_u32 m0, s45, 4096
  s_add_u32 s51, s43, 42112
  buffer_load_dwordx4 v8, s[24:27], s51 offen lds
  s_add_u32 m0, s45, 5120
  s_add_u32 s51, s43, 52352
  buffer_load_dwordx4 v9, s[24:27], s51 offen lds
  s_add_u32 m0, s45, 6144
  s_add_u32 s51, s43, 62592
  buffer_load_dwordx4 v8, s[24:27], s51 offen lds
  s_add_u32 m0, s45, 7168
  s_add_u32 s51, s43, 72832
  buffer_load_dwordx4 v9, s[24:27], s51 offen lds
  s_waitcnt vmcnt(12)
  s_cmp_lg_u32 s36, 4
  s_cbranch_scc1 K1_NF8
  v_cmp_gt_u32 vcc, 40, v12
  s_nop 1
  s_cmp_eq_u64 vcc, 0
  s_cselect_b32 s49, 1, 0
  v_mov_b32 v1, 147456
  v_mov_b32 v2, s49
  ds_write_b32 v1, v2
  s_waitcnt lgkmcnt(0)
K1_NF8:
  s_barrier
  v_mov_b32 v1, 147456
  ds_read_b32 v2, v1
  s_waitcnt lgkmcnt(0)
  v_readfirstlane_b32 s47, v2
  s_nop 0
  s_cmp_eq_u32 s47, 0
  s_cbranch_scc1 K1_RP8
  s_lshl_b32 s3, s39, 8
  s_lshl_b32 s49, s42, 6
  s_add_u32 s3, s3, s49
  v_add_u32 v1, s3, v0
  v_lshlrev_b32 v1, 3, v1
  buffer_load_dwordx2 v[2:3], v1, s[60:63], 0 offen sc1
  s_lshl_b32 s3, s40, 7
  s_and_b32 s50, s42, 1
  s_lshl_b32 s50, s50, 6
  s_add_u32 s3, s3, s50
  v_add_u32 v4, s3, v0
  v_lshlrev_b32 v4, 2, v4
  v_add_u32 v4, 32768, v4
  buffer_load_dword v5, v4, s[60:63], 0 offen sc1
  v_add_u32 v1, s49, v0
  v_lshlrev_b32 v1, 2, v1
  v_add_u32 v1, 147520, v1
  v_add_u32 v4, s50, v0
  v_lshlrev_b32 v4, 2, v4
  v_add_u32 v4, 149568, v4
  s_waitcnt vmcnt(0)
  ds_write_b32 v1, v2
  ds_write_b32 v1, v3 offset:1024
  ds_write_b32 v4, v5
  s_waitcnt lgkmcnt(0)
  s_branch K1_NS8
K1_RP8:
  s_cmp_lg_u32 s36, 4
  s_cbranch_scc1 K1_NS8
  v_mov_b32 v1, 0
  global_load_dword v12, v1, s[18:19] sc1
K1_NS8:
  s_waitcnt vmcnt(0)
  s_cmp_lg_u32 s36, 4
  s_cbranch_scc1 K1_NF9
  s_cmp_lg_u32 s47, 0
  s_cbranch_scc1 K1_NF9
  v_cmp_gt_u32 vcc, 40, v12
  s_nop 1
  s_cmp_eq_u64 vcc, 0
  s_cselect_b32 s49, 1, 0
  v_mov_b32 v1, 147460
  v_mov_b32 v2, s49
  ds_write_b32 v1, v2
  s_waitcnt lgkmcnt(0)
K1_NF9:
  s_barrier
  s_cmp_lg_u32 s47, 0
  s_cbranch_scc1 K1_NS9
  v_mov_b32 v1, 147460
  ds_read_b32 v2, v1
  s_waitcnt lgkmcnt(0)
  v_readfirstlane_b32 s47, v2
  s_nop 0
  s_cmp_eq_u32 s47, 0
  s_cbranch_scc1 K1_RP9
  s_lshl_b32 s3, s39, 8
  s_lshl_b32 s49, s42, 6
  s_add_u32 s3, s3, s49
  v_add_u32 v1, s3, v0
  v_lshlrev_b32 v1, 3, v1
  buffer_load_dwordx2 v[2:3], v1, s[60:63], 0 offen sc1
  s_lshl_b32 s3, s40, 7
  s_and_b32 s50, s42, 1
  s_lshl_b32 s50, s50, 6
  s_add_u32 s3, s3, s50
  v_add_u32 v4, s3, v0
  v_lshlrev_b32 v4, 2, v4
  v_add_u32 v4, 32768, v4
  buffer_load_dword v5, v4, s[60:63], 0 offen sc1
  v_add_u32 v1, s49, v0
  v_lshlrev_b32 v1, 2, v1
  v_add_u32 v1, 147520, v1
  v_add_u32 v4, s50, v0
  v_lshlrev_b32 v4, 2, v4
  v_add_u32 v4, 149568, v4
  s_waitcnt vmcnt(0)
  ds_write_b32 v1, v2
  ds_write_b32 v1, v3 offset:1024
  ds_write_b32 v4, v5
  s_waitcnt lgkmcnt(0)
  s_branch K1_NS9
K1_RP9:
K1_NS9:
  s_barrier
  s_cmp_lg_u32 s47, 0
  s_cbranch_scc1 K1_LDONE
  s_cmp_lg_u32 s36, 4
  s_cbranch_scc1 K1_PB
  s_mov_b32 s53, 0x40000
K1_PL:
  v_mov_b32 v1, 0
  global_load_dword v12, v1, s[18:19] sc1
  s_waitcnt vmcnt(0)
  s_sub_u32 s53, s53, 1
  s_cmp_eq_u32 s53, 0
  s_cbranch_scc1 K1_PB
  v_cmp_gt_u32 vcc, 40, v12
  s_nop 1
  s_cmp_eq_u64 vcc, 0
  s_cselect_b32 s49, 1, 0
  s_cmp_lg_u32 s49, 0
  s_cbranch_scc1 K1_PB
  s_sleep 4
  s_branch K1_PL
K1_PB:
  s_barrier
  s_lshl_b32 s3, s39, 8
  s_lshl_b32 s49, s42, 6
  s_add_u32 s3, s3, s49
  v_add_u32 v1, s3, v0
  v_lshlrev_b32 v1, 3, v1
  buffer_load_dwordx2 v[2:3], v1, s[60:63], 0 offen sc1
  s_lshl_b32 s3, s40, 7
  s_and_b32 s50, s42, 1
  s_lshl_b32 s50, s50, 6
  s_add_u32 s3, s3, s50
  v_add_u32 v4, s3, v0
  v_lshlrev_b32 v4, 2, v4
  v_add_u32 v4, 32768, v4
  buffer_load_dword v5, v4, s[60:63], 0 offen sc1
  v_add_u32 v1, s49, v0
  v_lshlrev_b32 v1, 2, v1
  v_add_u32 v1, 147520, v1
  v_add_u32 v4, s50, v0
  v_lshlrev_b32 v4, 2, v4
  v_add_u32 v4, 149568, v4
  s_waitcnt vmcnt(0)
  ds_write_b32 v1, v2
  ds_write_b32 v1, v3 offset:1024
  ds_write_b32 v4, v5
  s_waitcnt lgkmcnt(0)
  s_barrier
K1_LDONE:
  s_branch K1_FIN
K1_COMP:
  s_lshr_b32 s37, s36, 1
  s_and_b32 s38, s36, 1
  v_and_b32 v1, 15, v0
  v_lshrrev_b32 v2, 4, v0
  s_lshl_b32 s3, s37, 7
  v_add_u32 v3, s3, v1
  v_lshlrev_b32 v3, 7, v3
  v_bfe_u32 v4, v1, 1, 3
  v_add_u32 v5, 0, v2
  v_xor_b32 v5, v5, v4
  v_lshl_add_u32 v8, v5, 4, v3
  v_add_u32 v10, 98304, v8
  v_add_u32 v5, 4, v2
  v_xor_b32 v5, v5, v4
  v_lshl_add_u32 v9, v5, 4, v3
  v_add_u32 v11, 98304, v9
  v_bfe_u32 v3, v0, 2, 2
  v_and_b32 v4, 3, v0
  v_and_b32 v5, 1, v2
  v_lshl_or_b32 v5, v5, 2, v3
  v_lshlrev_b32 v5, 1, v5
  v_lshl_add_u32 v6, v2, 3, v3
  v_lshlrev_b32 v6, 8, v6
  v_and_b32 v7, 1, v4
  v_lshl_add_u32 v6, v7, 3, v6
  v_add_u32 v6, 32768, v6
  v_lshrrev_b32 v4, 1, v4
  s_lshl_b32 s3, s38, 3
  v_add_u32 v4, s3, v4
  v_add_u32 v7, 0, v4
  v_xor_b32 v7, v7, v5
  v_lshl_add_u32 v12, v7, 4, v6
  v_add_u32 v16, 98304, v12
  v_add_u32 v7, 2, v4
  v_xor_b32 v7, v7, v5
  v_lshl_add_u32 v13, v7, 4, v6
  v_add_u32 v17, 98304, v13
  v_add_u32 v7, 4, v4
  v_xor_b32 v7, v7, v5
  v_lshl_add_u32 v14, v7, 4, v6
  v_add_u32 v18, 98304, v14
  v_add_u32 v7, 6, v4
  v_xor_b32 v7, v7, v5
  v_lshl_add_u32 v15, v7, 4, v6
  v_add_u32 v19, 98304, v15
  v_mov_b32 v128, 0
  v_mov_b32 v129, 0
  v_mov_b32 v130, 0
  v_mov_b32 v131, 0
  v_mov_b32 v132, 0
  v_mov_b32 v133, 0
  v_mov_b32 v134, 0
  v_mov_b32 v135, 0
  v_mov_b32 v136, 0
  v_mov_b32 v137, 0
  v_mov_b32 v138, 0
  v_mov_b32 v139, 0
  v_mov_b32 v140, 0
  v_mov_b32 v141, 0
  v_mov_b32 v142, 0
  v_mov_b32 v143, 0
  v_mov_b32 v144, 0
  v_mov_b32 v145, 0
  v_mov_b32 v146, 0
  v_mov_b32 v147, 0
  v_mov_b32 v148, 0
  v_mov_b32 v149, 0
  v_mov_b32 v150, 0
  v_mov_b32 v151, 0
  v_mov_b32 v152, 0
  v_mov_b32 v153, 0
  v_mov_b32 v154, 0
  v_mov_b32 v155, 0
  v_mov_b32 v156, 0
  v_mov_b32 v157, 0
  v_mov_b32 v158, 0
  v_mov_b32 v159, 0
  v_mov_b32 v160, 0
  v_mov_b32 v161, 0
  v_mov_b32 v162, 0
  v_mov_b32 v163, 0
  v_mov_b32 v164, 0
  v_mov_b32 v165, 0
  v_mov_b32 v166, 0
  v_mov_b32 v167, 0
  v_mov_b32 v168, 0
  v_mov_b32 v169, 0
  v_mov_b32 v170, 0
  v_mov_b32 v171, 0
  v_mov_b32 v172, 0
  v_mov_b32 v173, 0
  v_mov_b32 v174, 0
  v_mov_b32 v175, 0
  v_mov_b32 v176, 0
  v_mov_b32 v177, 0
  v_mov_b32 v178, 0
  v_mov_b32 v179, 0
  v_mov_b32 v180, 0
  v_mov_b32 v181, 0
  v_mov_b32 v182, 0
  v_mov_b32 v183, 0
  v_mov_b32 v184, 0
  v_mov_b32 v185, 0
  v_mov_b32 v186, 0
  v_mov_b32 v187, 0
  v_mov_b32 v188, 0
  v_mov_b32 v189, 0
  v_mov_b32 v190, 0
  v_mov_b32 v191, 0
  v_mov_b32 v192, 0
  v_mov_b32 v193, 0
  v_mov_b32 v194, 0
  v_mov_b32 v195, 0
  v_mov_b32 v196, 0
  v_mov_b32 v197, 0
  v_mov_b32 v198, 0
  v_mov_b32 v199, 0
  v_mov_b32 v200, 0
  v_mov_b32 v201, 0
  v_mov_b32 v202, 0
  v_mov_b32 v203, 0
  v_mov_b32 v204, 0
  v_mov_b32 v205, 0
  v_mov_b32 v206, 0
  v_mov_b32 v207, 0
  v_mov_b32 v208, 0
  v_mov_b32 v209, 0
  v_mov_b32 v210, 0
  v_mov_b32 v211, 0
  v_mov_b32 v212, 0
  v_mov_b32 v213, 0
  v_mov_b32 v214, 0
  v_mov_b32 v215, 0
  v_mov_b32 v216, 0
  v_mov_b32 v217, 0
  v_mov_b32 v218, 0
  v_mov_b32 v219, 0
  v_mov_b32 v220, 0
  v_mov_b32 v221, 0
  v_mov_b32 v222, 0
  v_mov_b32 v223, 0
  v_mov_b32 v224, 0
  v_mov_b32 v225, 0
  v_mov_b32 v226, 0
  v_mov_b32 v227, 0
  v_mov_b32 v228, 0
  v_mov_b32 v229, 0
  v_mov_b32 v230, 0
  v_mov_b32 v231, 0
  v_mov_b32 v232, 0
  v_mov_b32 v233, 0
  v_mov_b32 v234, 0
  v_mov_b32 v235, 0
  v_mov_b32 v236, 0
  v_mov_b32 v237, 0
  v_mov_b32 v238, 0
  v_mov_b32 v239, 0
  v_mov_b32 v240, 0
  v_mov_b32 v241, 0
  v_mov_b32 v242, 0
  v_mov_b32 v243, 0
  v_mov_b32 v244, 0
  v_mov_b32 v245, 0
  v_mov_b32 v246, 0
  v_mov_b32 v247, 0
  v_mov_b32 v248, 0
  v_mov_b32 v249, 0
  v_mov_b32 v250, 0
  v_mov_b32 v251, 0
  v_mov_b32 v252, 0
  v_mov_b32 v253, 0
  v_mov_b32 v254, 0
  v_mov_b32 v255, 0
  s_waitcnt lgkmcnt(0)
  s_cmp_ge_u32 s40, 15
  s_cbranch_scc1 K1_PRE_H
  s_cmp_ge_u32 s40, 10
  s_cbranch_scc1 K1_PRE_V
  s_cmp_ge_u32 s40, 5
  s_cbranch_scc1 K1_PRE_K
  s_mov_b32 s54, 81920
  s_mov_b32 s55, 16384
  s_mov_b32 s57, 1051011932
  s_add_u32 s32, s20, 5767168
  s_addc_u32 s33, s21, 0
  s_and_b32 s33, s33, 0xffff
  s_mov_b32 s34, 2621440
  s_mov_b32 s35, 0x00020000
  s_lshl_b32 s3, s39, 3
  s_lshl_b32 s49, s37, 2
  s_add_u32 s3, s3, s49
  s_lshl_b32 s56, s3, 8
  s_mov_b32 s59, s40
  s_branch K1_PRE_QK
K1_PRE_K:
  s_mov_b32 s54, 163840
  s_mov_b32 s55, 1024
  s_mov_b32 s57, 1.0
  s_add_u32 s32, s20, 0
  s_addc_u32 s33, s21, 0
  s_and_b32 s33, s33, 0xffff
  s_mov_b32 s34, 5242880
  s_mov_b32 s35, 0x00020000
  s_lshl_b32 s3, s39, 1
  s_add_u32 s3, s3, s37
  s_mul_i32 s56, s3, 10240
  s_sub_u32 s59, s40, 5
K1_PRE_QK:
  s_lshl_b32 s59, s59, 5
  s_lshl_b32 s3, s38, 4
  s_add_u32 s59, s59, s3
  s_add_u32 s3, s59, 0
  v_add_u32 v3, s3, v2
  v_mul_u32_u24 v4, 205, v3
  v_lshrrev_b32 v4, 10, v4
  v_mul_u32_u24 v5, 5, v4
  v_sub_u32 v5, v3, v5
  v_mul_u32_u24 v4, s54, v4
  v_mul_u32_u24 v5, s55, v5
  v_add_u32 v4, v4, v5
  v_lshl_add_u32 v20, v1, 4, v4
  s_add_u32 s3, s59, 4
  v_add_u32 v3, s3, v2
  v_mul_u32_u24 v4, 205, v3
  v_lshrrev_b32 v4, 10, v4
  v_mul_u32_u24 v5, 5, v4
  v_sub_u32 v5, v3, v5
  v_mul_u32_u24 v4, s54, v4
  v_mul_u32_u24 v5, s55, v5
  v_add_u32 v4, v4, v5
  v_lshl_add_u32 v21, v1, 4, v4
  s_add_u32 s3, s59, 8
  v_add_u32 v3, s3, v2
  v_mul_u32_u24 v4, 205, v3
  v_lshrrev_b32 v4, 10, v4
  v_mul_u32_u24 v5, 5, v4
  v_sub_u32 v5, v3, v5
  v_mul_u32_u24 v4, s54, v4
  v_mul_u32_u24 v5, s55, v5
  v_add_u32 v4, v4, v5
  v_lshl_add_u32 v22, v1, 4, v4
  s_add_u32 s3, s59, 12
  v_add_u32 v3, s3, v2
  v_mul_u32_u24 v4, 205, v3
  v_lshrrev_b32 v4, 10, v4
  v_mul_u32_u24 v5, 5, v4
  v_sub_u32 v5, v3, v5
  v_mul_u32_u24 v4, s54, v4
  v_mul_u32_u24 v5, s55, v5
  v_add_u32 v4, v4, v5
  v_lshl_add_u32 v23, v1, 4, v4
  s_branch K1_MAIN_N
K1_PRE_H:
  v_mov_b32 v20, 0
  v_mov_b32 v21, 0
  v_mov_b32 v22, 0
  v_mov_b32 v23, 0
  s_mov_b32 s56, 0
  s_mov_b32 s57, 0
  s_add_u32 s32, s20, 8388608
  s_addc_u32 s33, s21, 0
  s_and_b32 s33, s33, 0xffff
  s_mov_b32 s34, 6291456
  s_mov_b32 s35, 0x00020000
  s_branch K1_MAIN_N
K1_PRE_V:
  s_add_u32 s32, s20, 0
  s_addc_u32 s33, s21, 0
  s_and_b32 s33, s33, 0xffff
  s_mov_b32 s34, 5242880
  s_mov_b32 s35, 0x00020000
  s_lshl_b32 s3, s39, 1
  s_add_u32 s3, s3, s37
  s_mul_i32 s56, s3, 10240
  s_sub_u32 s59, s40, 10
  s_lshl_b32 s59, s59, 7
  s_lshl_b32 s3, s38, 6
  s_add_u32 s59, s59, s3
  v_mul_u32_u24 v6, 320, v2
  v_add_u32 v6, 5120, v6
  s_add_u32 s3, s59, 0
  v_add_u32 v3, s3, v1
  v_mul_u32_u24 v4, 3277, v3
  v_lshrrev_b32 v4, 16, v4
  v_mul_u32_u24 v5, 20, v4
  v_sub_u32 v5, v3, v5
  s_mov_b32 s3, 163840
  v_mul_lo_u32 v4, s3, v4
  v_lshl_add_u32 v4, v5, 4, v4
  v_add_u32 v20, v4, v6
  s_add_u32 s3, s59, 16
  v_add_u32 v3, s3, v1
  v_mul_u32_u24 v4, 3277, v3
  v_lshrrev_b32 v4, 16, v4
  v_mul_u32_u24 v5, 20, v4
  v_sub_u32 v5, v3, v5
  s_mov_b32 s3, 163840
  v_mul_lo_u32 v4, s3, v4
  v_lshl_add_u32 v4, v5, 4, v4
  v_add_u32 v21, v4, v6
  s_add_u32 s3, s59, 32
  v_add_u32 v3, s3, v1
  v_mul_u32_u24 v4, 3277, v3
  v_lshrrev_b32 v4, 16, v4
  v_mul_u32_u24 v5, 20, v4
  v_sub_u32 v5, v3, v5
  s_mov_b32 s3, 163840
  v_mul_lo_u32 v4, s3, v4
  v_lshl_add_u32 v4, v5, 4, v4
  v_add_u32 v22, v4, v6
  s_add_u32 s3, s59, 48
  v_add_u32 v3, s3, v1
  v_mul_u32_u24 v4, 3277, v3
  v_lshrrev_b32 v4, 16, v4
  v_mul_u32_u24 v5, 20, v4
  v_sub_u32 v5, v3, v5
  s_mov_b32 s3, 163840
  v_mul_lo_u32 v4, s3, v4
  v_lshl_add_u32 v4, v5, 4, v4
  v_add_u32 v23, v4, v6
  s_branch K1_MAIN_S
K1_MAIN_N:
  s_waitcnt lgkmcnt(0)
  s_barrier
  ds_read_b128 v[32:35], v8 offset:0
  ds_read_b64_tr_b16 v[64:65], v12 offset:0
  ds_read_b128 v[36:39], v8 offset:2048
  ds_read_b64_tr_b16 v[66:67], v12 offset:1024
  ds_read_b128 v[40:43], v8 offset:4096
  ds_read_b64_tr_b16 v[68:69], v13 offset:0
  ds_read_b128 v[44:47], v8 offset:6144
  ds_read_b64_tr_b16 v[70:71], v13 offset:1024
  ds_read_b128 v[48:51], v8 offset:8192
  ds_read_b64_tr_b16 v[72:73], v14 offset:0
  ds_read_b128 v[52:55], v8 offset:10240
  ds_read_b64_tr_b16 v[74:75], v14 offset:1024
  ds_read_b128 v[56:59], v8 offset:12288
  ds_read_b64_tr_b16 v[76:77], v15 offset:0
  ds_read_b128 v[60:63], v8 offset:14336
  ds_read_b64_tr_b16 v[78:79], v15 offset:1024
  s_waitcnt lgkmcnt(0)
  v_mfma_f32_16x16x32_bf16 v[128:131], v[64:67], v[32:35], v[128:131]
  ds_read_b128 v[80:83], v9 offset:0
  v_mfma_f32_16x16x32_bf16 v[160:163], v[68:71], v[32:35], v[160:163]
  v_mfma_f32_16x16x32_bf16 v[192:195], v[72:75], v[32:35], v[192:195]
  ds_read_b64_tr_b16 v[112:113], v12 offset:8192
  v_mfma_f32_16x16x32_bf16 v[224:227], v[76:79], v[32:35], v[224:227]
  v_mfma_f32_16x16x32_bf16 v[132:135], v[64:67], v[36:39], v[132:135]
  ds_read_b128 v[84:87], v9 offset:2048
  v_mfma_f32_16x16x32_bf16 v[164:167], v[68:71], v[36:39], v[164:167]
  v_mfma_f32_16x16x32_bf16 v[196:199], v[72:75], v[36:39], v[196:199]
  ds_read_b64_tr_b16 v[114:115], v12 offset:9216
  v_mfma_f32_16x16x32_bf16 v[228:231], v[76:79], v[36:39], v[228:231]
  v_mfma_f32_16x16x32_bf16 v[136:139], v[64:67], v[40:43], v[136:139]
  ds_read_b128 v[88:91], v9 offset:4096
  v_mfma_f32_16x16x32_bf16 v[168:171], v[68:71], v[40:43], v[168:171]
  v_mfma_f32_16x16x32_bf16 v[200:203], v[72:75], v[40:43], v[200:203]
  ds_read_b64_tr_b16 v[116:117], v13 offset:8192
  v_mfma_f32_16x16x32_bf16 v[232:235], v[76:79], v[40:43], v[232:235]
  v_mfma_f32_16x16x32_bf16 v[140:143], v[64:67], v[44:47], v[140:143]
  ds_read_b128 v[92:95], v9 offset:6144
  v_mfma_f32_16x16x32_bf16 v[172:175], v[68:71], v[44:47], v[172:175]
  v_mfma_f32_16x16x32_bf16 v[204:207], v[72:75], v[44:47], v[204:207]
  ds_read_b64_tr_b16 v[118:119], v13 offset:9216
  v_mfma_f32_16x16x32_bf16 v[236:239], v[76:79], v[44:47], v[236:239]
  v_mfma_f32_16x16x32_bf16 v[144:147], v[64:67], v[48:51], v[144:147]
  ds_read_b128 v[96:99], v9 offset:8192
  v_mfma_f32_16x16x32_bf16 v[176:179], v[68:71], v[48:51], v[176:179]
  v_mfma_f32_16x16x32_bf16 v[208:211], v[72:75], v[48:51], v[208:211]
  ds_read_b64_tr_b16 v[120:121], v14 offset:8192
  v_mfma_f32_16x16x32_bf16 v[240:243], v[76:79], v[48:51], v[240:243]
  v_mfma_f32_16x16x32_bf16 v[148:151], v[64:67], v[52:55], v[148:151]
  ds_read_b128 v[100:103], v9 offset:10240
  v_mfma_f32_16x16x32_bf16 v[180:183], v[68:71], v[52:55], v[180:183]
  v_mfma_f32_16x16x32_bf16 v[212:215], v[72:75], v[52:55], v[212:215]
  ds_read_b64_tr_b16 v[122:123], v14 offset:9216
  v_mfma_f32_16x16x32_bf16 v[244:247], v[76:79], v[52:55], v[244:247]
  v_mfma_f32_16x16x32_bf16 v[152:155], v[64:67], v[56:59], v[152:155]
  ds_read_b128 v[104:107], v9 offset:12288
  v_mfma_f32_16x16x32_bf16 v[184:187], v[68:71], v[56:59], v[184:187]
  v_mfma_f32_16x16x32_bf16 v[216:219], v[72:75], v[56:59], v[216:219]
  ds_read_b64_tr_b16 v[124:125], v15 offset:8192
  v_mfma_f32_16x16x32_bf16 v[248:251], v[76:79], v[56:59], v[248:251]
  v_mfma_f32_16x16x32_bf16 v[156:159], v[64:67], v[60:63], v[156:159]
  ds_read_b128 v[108:111], v9 offset:14336
  v_mfma_f32_16x16x32_bf16 v[188:191], v[68:71], v[60:63], v[188:191]
  v_mfma_f32_16x16x32_bf16 v[220:223], v[72:75], v[60:63], v[220:223]
  ds_read_b64_tr_b16 v[126:127], v15 offset:9216
  v_mfma_f32_16x16x32_bf16 v[252:255], v[76:79], v[60:63], v[252:255]
  s_waitcnt lgkmcnt(0)
  s_barrier
  s_waitcnt lgkmcnt(0)
  v_mfma_f32_16x16x32_bf16 v[128:131], v[112:115], v[80:83], v[128:131]
  ds_read_b128 v[32:35], v8 offset:49152
  v_mfma_f32_16x16x32_bf16 v[160:163], v[116:119], v[80:83], v[160:163]
  v_mfma_f32_16x16x32_bf16 v[192:195], v[120:123], v[80:83], v[192:195]
  ds_read_b64_tr_b16 v[64:65], v12 offset:49152
  v_mfma_f32_16x16x32_bf16 v[224:227], v[124:127], v[80:83], v[224:227]
  v_mfma_f32_16x16x32_bf16 v[132:135], v[112:115], v[84:87], v[132:135]
  ds_read_b128 v[36:39], v8 offset:51200
  v_mfma_f32_16x16x32_bf16 v[164:167], v[116:119], v[84:87], v[164:167]
  v_mfma_f32_16x16x32_bf16 v[196:199], v[120:123], v[84:87], v[196:199]
  ds_read_b64_tr_b16 v[66:67], v12 offset:50176
  v_mfma_f32_16x16x32_bf16 v[228:231], v[124:127], v[84:87], v[228:231]
  v_mfma_f32_16x16x32_bf16 v[136:139], v[112:115], v[88:91], v[136:139]
  ds_read_b128 v[40:43], v8 offset:53248
  v_mfma_f32_16x16x32_bf16 v[168:171], v[116:119], v[88:91], v[168:171]
  v_mfma_f32_16x16x32_bf16 v[200:203], v[120:123], v[88:91], v[200:203]
  ds_read_b64_tr_b16 v[68:69], v13 offset:49152
  v_mfma_f32_16x16x32_bf16 v[232:235], v[124:127], v[88:91], v[232:235]
  v_mfma_f32_16x16x32_bf16 v[140:143], v[112:115], v[92:95], v[140:143]
  ds_read_b128 v[44:47], v8 offset:55296
  v_mfma_f32_16x16x32_bf16 v[172:175], v[116:119], v[92:95], v[172:175]
  v_mfma_f32_16x16x32_bf16 v[204:207], v[120:123], v[92:95], v[204:207]
  ds_read_b64_tr_b16 v[70:71], v13 offset:50176
  v_mfma_f32_16x16x32_bf16 v[236:239], v[124:127], v[92:95], v[236:239]
  v_mfma_f32_16x16x32_bf16 v[144:147], v[112:115], v[96:99], v[144:147]
  ds_read_b128 v[48:51], v8 offset:57344
  v_mfma_f32_16x16x32_bf16 v[176:179], v[116:119], v[96:99], v[176:179]
  v_mfma_f32_16x16x32_bf16 v[208:211], v[120:123], v[96:99], v[208:211]
  ds_read_b64_tr_b16 v[72:73], v14 offset:49152
  v_mfma_f32_16x16x32_bf16 v[240:243], v[124:127], v[96:99], v[240:243]
  v_mfma_f32_16x16x32_bf16 v[148:151], v[112:115], v[100:103], v[148:151]
  ds_read_b128 v[52:55], v8 offset:59392
  v_mfma_f32_16x16x32_bf16 v[180:183], v[116:119], v[100:103], v[180:183]
  v_mfma_f32_16x16x32_bf16 v[212:215], v[120:123], v[100:103], v[212:215]
  ds_read_b64_tr_b16 v[74:75], v14 offset:50176
  v_mfma_f32_16x16x32_bf16 v[244:247], v[124:127], v[100:103], v[244:247]
  v_mfma_f32_16x16x32_bf16 v[152:155], v[112:115], v[104:107], v[152:155]
  ds_read_b128 v[56:59], v8 offset:61440
  v_mfma_f32_16x16x32_bf16 v[184:187], v[116:119], v[104:107], v[184:187]
  v_mfma_f32_16x16x32_bf16 v[216:219], v[120:123], v[104:107], v[216:219]
  ds_read_b64_tr_b16 v[76:77], v15 offset:49152
  v_mfma_f32_16x16x32_bf16 v[248:251], v[124:127], v[104:107], v[248:251]
  v_mfma_f32_16x16x32_bf16 v[156:159], v[112:115], v[108:111], v[156:159]
  ds_read_b128 v[60:63], v8 offset:63488
  v_mfma_f32_16x16x32_bf16 v[188:191], v[116:119], v[108:111], v[188:191]
  v_mfma_f32_16x16x32_bf16 v[220:223], v[120:123], v[108:111], v[220:223]
  ds_read_b64_tr_b16 v[78:79], v15 offset:50176
  v_mfma_f32_16x16x32_bf16 v[252:255], v[124:127], v[108:111], v[252:255]
  s_waitcnt lgkmcnt(0)
  v_mfma_f32_16x16x32_bf16 v[128:131], v[64:67], v[32:35], v[128:131]
  ds_read_b128 v[80:83], v9 offset:49152
  v_mfma_f32_16x16x32_bf16 v[160:163], v[68:71], v[32:35], v[160:163]
  v_mfma_f32_16x16x32_bf16 v[192:195], v[72:75], v[32:35], v[192:195]
  ds_read_b64_tr_b16 v[112:113], v12 offset:57344
  v_mfma_f32_16x16x32_bf16 v[224:227], v[76:79], v[32:35], v[224:227]
  v_mfma_f32_16x16x32_bf16 v[132:135], v[64:67], v[36:39], v[132:135]
  ds_read_b128 v[84:87], v9 offset:51200
  v_mfma_f32_16x16x32_bf16 v[164:167], v[68:71], v[36:39], v[164:167]
  v_mfma_f32_16x16x32_bf16 v[196:199], v[72:75], v[36:39], v[196:199]
  ds_read_b64_tr_b16 v[114:115], v12 offset:58368
  v_mfma_f32_16x16x32_bf16 v[228:231], v[76:79], v[36:39], v[228:231]
  v_mfma_f32_16x16x32_bf16 v[136:139], v[64:67], v[40:43], v[136:139]
  ds_read_b128 v[88:91], v9 offset:53248
  v_mfma_f32_16x16x32_bf16 v[168:171], v[68:71], v[40:43], v[168:171]
  v_mfma_f32_16x16x32_bf16 v[200:203], v[72:75], v[40:43], v[200:203]
  ds_read_b64_tr_b16 v[116:117], v13 offset:57344
  v_mfma_f32_16x16x32_bf16 v[232:235], v[76:79], v[40:43], v[232:235]
  v_mfma_f32_16x16x32_bf16 v[140:143], v[64:67], v[44:47], v[140:143]
  ds_read_b128 v[92:95], v9 offset:55296
  v_mfma_f32_16x16x32_bf16 v[172:175], v[68:71], v[44:47], v[172:175]
  v_mfma_f32_16x16x32_bf16 v[204:207], v[72:75], v[44:47], v[204:207]
  ds_read_b64_tr_b16 v[118:119], v13 offset:58368
  v_mfma_f32_16x16x32_bf16 v[236:239], v[76:79], v[44:47], v[236:239]
  v_mfma_f32_16x16x32_bf16 v[144:147], v[64:67], v[48:51], v[144:147]
  ds_read_b128 v[96:99], v9 offset:57344
  v_mfma_f32_16x16x32_bf16 v[176:179], v[68:71], v[48:51], v[176:179]
  v_mfma_f32_16x16x32_bf16 v[208:211], v[72:75], v[48:51], v[208:211]
  ds_read_b64_tr_b16 v[120:121], v14 offset:57344
  v_mfma_f32_16x16x32_bf16 v[240:243], v[76:79], v[48:51], v[240:243]
  v_mfma_f32_16x16x32_bf16 v[148:151], v[64:67], v[52:55], v[148:151]
  ds_read_b128 v[100:103], v9 offset:59392
  v_mfma_f32_16x16x32_bf16 v[180:183], v[68:71], v[52:55], v[180:183]
  v_mfma_f32_16x16x32_bf16 v[212:215], v[72:75], v[52:55], v[212:215]
  ds_read_b64_tr_b16 v[122:123], v14 offset:58368
  v_mfma_f32_16x16x32_bf16 v[244:247], v[76:79], v[52:55], v[244:247]
  v_mfma_f32_16x16x32_bf16 v[152:155], v[64:67], v[56:59], v[152:155]
  ds_read_b128 v[104:107], v9 offset:61440
  v_mfma_f32_16x16x32_bf16 v[184:187], v[68:71], v[56:59], v[184:187]
  v_mfma_f32_16x16x32_bf16 v[216:219], v[72:75], v[56:59], v[216:219]
  ds_read_b64_tr_b16 v[124:125], v15 offset:57344
  v_mfma_f32_16x16x32_bf16 v[248:251], v[76:79], v[56:59], v[248:251]
  v_mfma_f32_16x16x32_bf16 v[156:159], v[64:67], v[60:63], v[156:159]
  ds_read_b128 v[108:111], v9 offset:63488
  v_mfma_f32_16x16x32_bf16 v[188:191], v[68:71], v[60:63], v[188:191]
  v_mfma_f32_16x16x32_bf16 v[220:223], v[72:75], v[60:63], v[220:223]
  ds_read_b64_tr_b16 v[126:127], v15 offset:58368
  v_mfma_f32_16x16x32_bf16 v[252:255], v[76:79], v[60:63], v[252:255]
  s_waitcnt lgkmcnt(0)
  s_barrier
  s_waitcnt lgkmcnt(0)
  v_mfma_f32_16x16x32_bf16 v[128:131], v[112:115], v[80:83], v[128:131]
  ds_read_b128 v[32:35], v10 offset:0
  v_mfma_f32_16x16x32_bf16 v[160:163], v[116:119], v[80:83], v[160:163]
  v_mfma_f32_16x16x32_bf16 v[192:195], v[120:123], v[80:83], v[192:195]
  ds_read_b64_tr_b16 v[64:65], v16 offset:0
  v_mfma_f32_16x16x32_bf16 v[224:227], v[124:127], v[80:83], v[224:227]
  v_mfma_f32_16x16x32_bf16 v[132:135], v[112:115], v[84:87], v[132:135]
  ds_read_b128 v[36:39], v10 offset:2048
  v_mfma_f32_16x16x32_bf16 v[164:167], v[116:119], v[84:87], v[164:167]
  v_mfma_f32_16x16x32_bf16 v[196:199], v[120:123], v[84:87], v[196:199]
  ds_read_b64_tr_b16 v[66:67], v16 offset:1024
  v_mfma_f32_16x16x32_bf16 v[228:231], v[124:127], v[84:87], v[228:231]
  v_mfma_f32_16x16x32_bf16 v[136:139], v[112:115], v[88:91], v[136:139]
  ds_read_b128 v[40:43], v10 offset:4096
  v_mfma_f32_16x16x32_bf16 v[168:171], v[116:119], v[88:91], v[168:171]
  v_mfma_f32_16x16x32_bf16 v[200:203], v[120:123], v[88:91], v[200:203]
  ds_read_b64_tr_b16 v[68:69], v17 offset:0
  v_mfma_f32_16x16x32_bf16 v[232:235], v[124:127], v[88:91], v[232:235]
  v_mfma_f32_16x16x32_bf16 v[140:143], v[112:115], v[92:95], v[140:143]
  ds_read_b128 v[44:47], v10 offset:6144
  v_mfma_f32_16x16x32_bf16 v[172:175], v[116:119], v[92:95], v[172:175]
  v_mfma_f32_16x16x32_bf16 v[204:207], v[120:123], v[92:95], v[204:207]
  ds_read_b64_tr_b16 v[70:71], v17 offset:1024
  v_mfma_f32_16x16x32_bf16 v[236:239], v[124:127], v[92:95], v[236:239]
  v_mfma_f32_16x16x32_bf16 v[144:147], v[112:115], v[96:99], v[144:147]
  ds_read_b128 v[48:51], v10 offset:8192
  v_mfma_f32_16x16x32_bf16 v[176:179], v[116:119], v[96:99], v[176:179]
  v_mfma_f32_16x16x32_bf16 v[208:211], v[120:123], v[96:99], v[208:211]
  ds_read_b64_tr_b16 v[72:73], v18 offset:0
  v_mfma_f32_16x16x32_bf16 v[240:243], v[124:127], v[96:99], v[240:243]
  v_mfma_f32_16x16x32_bf16 v[148:151], v[112:115], v[100:103], v[148:151]
  ds_read_b128 v[52:55], v10 offset:10240
  v_mfma_f32_16x16x32_bf16 v[180:183], v[116:119], v[100:103], v[180:183]
  v_mfma_f32_16x16x32_bf16 v[212:215], v[120:123], v[100:103], v[212:215]
  ds_read_b64_tr_b16 v[74:75], v18 offset:1024
  v_mfma_f32_16x16x32_bf16 v[244:247], v[124:127], v[100:103], v[244:247]
  v_mfma_f32_16x16x32_bf16 v[152:155], v[112:115], v[104:107], v[152:155]
  ds_read_b128 v[56:59], v10 offset:12288
  v_mfma_f32_16x16x32_bf16 v[184:187], v[116:119], v[104:107], v[184:187]
  v_mfma_f32_16x16x32_bf16 v[216:219], v[120:123], v[104:107], v[216:219]
  ds_read_b64_tr_b16 v[76:77], v19 offset:0
  v_mfma_f32_16x16x32_bf16 v[248:251], v[124:127], v[104:107], v[248:251]
  v_mfma_f32_16x16x32_bf16 v[156:159], v[112:115], v[108:111], v[156:159]
  ds_read_b128 v[60:63], v10 offset:14336
  v_mfma_f32_16x16x32_bf16 v[188:191], v[116:119], v[108:111], v[188:191]
  v_mfma_f32_16x16x32_bf16 v[220:223], v[120:123], v[108:111], v[220:223]
  ds_read_b64_tr_b16 v[78:79], v19 offset:1024
  v_mfma_f32_16x16x32_bf16 v[252:255], v[124:127], v[108:111], v[252:255]
  s_waitcnt lgkmcnt(0)
  v_mfma_f32_16x16x32_bf16 v[128:131], v[64:67], v[32:35], v[128:131]
  ds_read_b128 v[80:83], v11 offset:0
  v_mfma_f32_16x16x32_bf16 v[160:163], v[68:71], v[32:35], v[160:163]
  v_mfma_f32_16x16x32_bf16 v[192:195], v[72:75], v[32:35], v[192:195]
  ds_read_b64_tr_b16 v[112:113], v16 offset:8192
  v_mfma_f32_16x16x32_bf16 v[224:227], v[76:79], v[32:35], v[224:227]
  v_mfma_f32_16x16x32_bf16 v[132:135], v[64:67], v[36:39], v[132:135]
  ds_read_b128 v[84:87], v11 offset:2048
  v_mfma_f32_16x16x32_bf16 v[164:167], v[68:71], v[36:39], v[164:167]
  v_mfma_f32_16x16x32_bf16 v[196:199], v[72:75], v[36:39], v[196:199]
  ds_read_b64_tr_b16 v[114:115], v16 offset:9216
  v_mfma_f32_16x16x32_bf16 v[228:231], v[76:79], v[36:39], v[228:231]
  v_mfma_f32_16x16x32_bf16 v[136:139], v[64:67], v[40:43], v[136:139]
  ds_read_b128 v[88:91], v11 offset:4096
  v_mfma_f32_16x16x32_bf16 v[168:171], v[68:71], v[40:43], v[168:171]
  v_mfma_f32_16x16x32_bf16 v[200:203], v[72:75], v[40:43], v[200:203]
  ds_read_b64_tr_b16 v[116:117], v17 offset:8192
  v_mfma_f32_16x16x32_bf16 v[232:235], v[76:79], v[40:43], v[232:235]
  v_mfma_f32_16x16x32_bf16 v[140:143], v[64:67], v[44:47], v[140:143]
  ds_read_b128 v[92:95], v11 offset:6144
  v_mfma_f32_16x16x32_bf16 v[172:175], v[68:71], v[44:47], v[172:175]
  v_mfma_f32_16x16x32_bf16 v[204:207], v[72:75], v[44:47], v[204:207]
  ds_read_b64_tr_b16 v[118:119], v17 offset:9216
  v_mfma_f32_16x16x32_bf16 v[236:239], v[76:79], v[44:47], v[236:239]
  v_mfma_f32_16x16x32_bf16 v[144:147], v[64:67], v[48:51], v[144:147]
  ds_read_b128 v[96:99], v11 offset:8192
  v_mfma_f32_16x16x32_bf16 v[176:179], v[68:71], v[48:51], v[176:179]
  v_mfma_f32_16x16x32_bf16 v[208:211], v[72:75], v[48:51], v[208:211]
  ds_read_b64_tr_b16 v[120:121], v18 offset:8192
  v_mfma_f32_16x16x32_bf16 v[240:243], v[76:79], v[48:51], v[240:243]
  v_mfma_f32_16x16x32_bf16 v[148:151], v[64:67], v[52:55], v[148:151]
  ds_read_b128 v[100:103], v11 offset:10240
  v_mfma_f32_16x16x32_bf16 v[180:183], v[68:71], v[52:55], v[180:183]
  v_mfma_f32_16x16x32_bf16 v[212:215], v[72:75], v[52:55], v[212:215]
  ds_read_b64_tr_b16 v[122:123], v18 offset:9216
  v_mfma_f32_16x16x32_bf16 v[244:247], v[76:79], v[52:55], v[244:247]
  v_mfma_f32_16x16x32_bf16 v[152:155], v[64:67], v[56:59], v[152:155]
  ds_read_b128 v[104:107], v11 offset:12288
  v_mfma_f32_16x16x32_bf16 v[184:187], v[68:71], v[56:59], v[184:187]
  v_mfma_f32_16x16x32_bf16 v[216:219], v[72:75], v[56:59], v[216:219]
  ds_read_b64_tr_b16 v[124:125], v19 offset:8192
  v_mfma_f32_16x16x32_bf16 v[248:251], v[76:79], v[56:59], v[248:251]
  v_mfma_f32_16x16x32_bf16 v[156:159], v[64:67], v[60:63], v[156:159]
  ds_read_b128 v[108:111], v11 offset:14336
  v_mfma_f32_16x16x32_bf16 v[188:191], v[68:71], v[60:63], v[188:191]
  v_mfma_f32_16x16x32_bf16 v[220:223], v[72:75], v[60:63], v[220:223]
  ds_read_b64_tr_b16 v[126:127], v19 offset:9216
  v_mfma_f32_16x16x32_bf16 v[252:255], v[76:79], v[60:63], v[252:255]
  s_waitcnt lgkmcnt(0)
  s_barrier
  s_waitcnt lgkmcnt(0)
  v_mfma_f32_16x16x32_bf16 v[128:131], v[112:115], v[80:83], v[128:131]
  ds_read_b128 v[32:35], v8 offset:0
  v_mfma_f32_16x16x32_bf16 v[160:163], v[116:119], v[80:83], v[160:163]
  v_mfma_f32_16x16x32_bf16 v[192:195], v[120:123], v[80:83], v[192:195]
  ds_read_b64_tr_b16 v[64:65], v12 offset:0
  v_mfma_f32_16x16x32_bf16 v[224:227], v[124:127], v[80:83], v[224:227]
  v_mfma_f32_16x16x32_bf16 v[132:135], v[112:115], v[84:87], v[132:135]
  ds_read_b128 v[36:39], v8 offset:2048
  v_mfma_f32_16x16x32_bf16 v[164:167], v[116:119], v[84:87], v[164:167]
  v_mfma_f32_16x16x32_bf16 v[196:199], v[120:123], v[84:87], v[196:199]
  ds_read_b64_tr_b16 v[66:67], v12 offset:1024
  v_mfma_f32_16x16x32_bf16 v[228:231], v[124:127], v[84:87], v[228:231]
  v_mfma_f32_16x16x32_bf16 v[136:139], v[112:115], v[88:91], v[136:139]
  ds_read_b128 v[40:43], v8 offset:4096
  v_mfma_f32_16x16x32_bf16 v[168:171], v[116:119], v[88:91], v[168:171]
  v_mfma_f32_16x16x32_bf16 v[200:203], v[120:123], v[88:91], v[200:203]
  ds_read_b64_tr_b16 v[68:69], v13 offset:0
  v_mfma_f32_16x16x32_bf16 v[232:235], v[124:127], v[88:91], v[232:235]
  v_mfma_f32_16x16x32_bf16 v[140:143], v[112:115], v[92:95], v[140:143]
  ds_read_b128 v[44:47], v8 offset:6144
  v_mfma_f32_16x16x32_bf16 v[172:175], v[116:119], v[92:95], v[172:175]
  v_mfma_f32_16x16x32_bf16 v[204:207], v[120:123], v[92:95], v[204:207]
  ds_read_b64_tr_b16 v[70:71], v13 offset:1024
  v_mfma_f32_16x16x32_bf16 v[236:239], v[124:127], v[92:95], v[236:239]
  v_mfma_f32_16x16x32_bf16 v[144:147], v[112:115], v[96:99], v[144:147]
  ds_read_b128 v[48:51], v8 offset:8192
  v_mfma_f32_16x16x32_bf16 v[176:179], v[116:119], v[96:99], v[176:179]
  v_mfma_f32_16x16x32_bf16 v[208:211], v[120:123], v[96:99], v[208:211]
  ds_read_b64_tr_b16 v[72:73], v14 offset:0
  v_mfma_f32_16x16x32_bf16 v[240:243], v[124:127], v[96:99], v[240:243]
  v_mfma_f32_16x16x32_bf16 v[148:151], v[112:115], v[100:103], v[148:151]
  ds_read_b128 v[52:55], v8 offset:10240
  v_mfma_f32_16x16x32_bf16 v[180:183], v[116:119], v[100:103], v[180:183]
  v_mfma_f32_16x16x32_bf16 v[212:215], v[120:123], v[100:103], v[212:215]
  ds_read_b64_tr_b16 v[74:75], v14 offset:1024
  v_mfma_f32_16x16x32_bf16 v[244:247], v[124:127], v[100:103], v[244:247]
  v_mfma_f32_16x16x32_bf16 v[152:155], v[112:115], v[104:107], v[152:155]
  ds_read_b128 v[56:59], v8 offset:12288
  v_mfma_f32_16x16x32_bf16 v[184:187], v[116:119], v[104:107], v[184:187]
  v_mfma_f32_16x16x32_bf16 v[216:219], v[120:123], v[104:107], v[216:219]
  ds_read_b64_tr_b16 v[76:77], v15 offset:0
  v_mfma_f32_16x16x32_bf16 v[248:251], v[124:127], v[104:107], v[248:251]
  v_mfma_f32_16x16x32_bf16 v[156:159], v[112:115], v[108:111], v[156:159]
  ds_read_b128 v[60:63], v8 offset:14336
  v_mfma_f32_16x16x32_bf16 v[188:191], v[116:119], v[108:111], v[188:191]
  v_mfma_f32_16x16x32_bf16 v[220:223], v[120:123], v[108:111], v[220:223]
  ds_read_b64_tr_b16 v[78:79], v15 offset:1024
  v_mfma_f32_16x16x32_bf16 v[252:255], v[124:127], v[108:111], v[252:255]
  s_waitcnt lgkmcnt(0)
  v_mfma_f32_16x16x32_bf16 v[128:131], v[64:67], v[32:35], v[128:131]
  ds_read_b128 v[80:83], v9 offset:0
  v_mfma_f32_16x16x32_bf16 v[160:163], v[68:71], v[32:35], v[160:163]
  v_mfma_f32_16x16x32_bf16 v[192:195], v[72:75], v[32:35], v[192:195]
  ds_read_b64_tr_b16 v[112:113], v12 offset:8192
  v_mfma_f32_16x16x32_bf16 v[224:227], v[76:79], v[32:35], v[224:227]
  v_mfma_f32_16x16x32_bf16 v[132:135], v[64:67], v[36:39], v[132:135]
  ds_read_b128 v[84:87], v9 offset:2048
  v_mfma_f32_16x16x32_bf16 v[164:167], v[68:71], v[36:39], v[164:167]
  v_mfma_f32_16x16x32_bf16 v[196:199], v[72:75], v[36:39], v[196:199]
  ds_read_b64_tr_b16 v[114:115], v12 offset:9216
  v_mfma_f32_16x16x32_bf16 v[228:231], v[76:79], v[36:39], v[228:231]
  v_mfma_f32_16x16x32_bf16 v[136:139], v[64:67], v[40:43], v[136:139]
  ds_read_b128 v[88:91], v9 offset:4096
  v_mfma_f32_16x16x32_bf16 v[168:171], v[68:71], v[40:43], v[168:171]
  v_mfma_f32_16x16x32_bf16 v[200:203], v[72:75], v[40:43], v[200:203]
  ds_read_b64_tr_b16 v[116:117], v13 offset:8192
  v_mfma_f32_16x16x32_bf16 v[232:235], v[76:79], v[40:43], v[232:235]
  v_mfma_f32_16x16x32_bf16 v[140:143], v[64:67], v[44:47], v[140:143]
  ds_read_b128 v[92:95], v9 offset:6144
  v_mfma_f32_16x16x32_bf16 v[172:175], v[68:71], v[44:47], v[172:175]
  v_mfma_f32_16x16x32_bf16 v[204:207], v[72:75], v[44:47], v[204:207]
  ds_read_b64_tr_b16 v[118:119], v13 offset:9216
  v_mfma_f32_16x16x32_bf16 v[236:239], v[76:79], v[44:47], v[236:239]
  v_mfma_f32_16x16x32_bf16 v[144:147], v[64:67], v[48:51], v[144:147]
  ds_read_b128 v[96:99], v9 offset:8192
  v_mfma_f32_16x16x32_bf16 v[176:179], v[68:71], v[48:51], v[176:179]
  v_mfma_f32_16x16x32_bf16 v[208:211], v[72:75], v[48:51], v[208:211]
  ds_read_b64_tr_b16 v[120:121], v14 offset:8192
  v_mfma_f32_16x16x32_bf16 v[240:243], v[76:79], v[48:51], v[240:243]
  v_mfma_f32_16x16x32_bf16 v[148:151], v[64:67], v[52:55], v[148:151]
  ds_read_b128 v[100:103], v9 offset:10240
  v_mfma_f32_16x16x32_bf16 v[180:183], v[68:71], v[52:55], v[180:183]
  v_mfma_f32_16x16x32_bf16 v[212:215], v[72:75], v[52:55], v[212:215]
  ds_read_b64_tr_b16 v[122:123], v14 offset:9216
  v_mfma_f32_16x16x32_bf16 v[244:247], v[76:79], v[52:55], v[244:247]
  v_mfma_f32_16x16x32_bf16 v[152:155], v[64:67], v[56:59], v[152:155]
  ds_read_b128 v[104:107], v9 offset:12288
  v_mfma_f32_16x16x32_bf16 v[184:187], v[68:71], v[56:59], v[184:187]
  v_mfma_f32_16x16x32_bf16 v[216:219], v[72:75], v[56:59], v[216:219]
  ds_read_b64_tr_b16 v[124:125], v15 offset:8192
  v_mfma_f32_16x16x32_bf16 v[248:251], v[76:79], v[56:59], v[248:251]
  v_mfma_f32_16x16x32_bf16 v[156:159], v[64:67], v[60:63], v[156:159]
  ds_read_b128 v[108:111], v9 offset:14336
  v_mfma_f32_16x16x32_bf16 v[188:191], v[68:71], v[60:63], v[188:191]
  v_mfma_f32_16x16x32_bf16 v[220:223], v[72:75], v[60:63], v[220:223]
  ds_read_b64_tr_b16 v[126:127], v15 offset:9216
  v_mfma_f32_16x16x32_bf16 v[252:255], v[76:79], v[60:63], v[252:255]
  s_waitcnt lgkmcnt(0)
  s_barrier
  s_waitcnt lgkmcnt(0)
  v_mfma_f32_16x16x32_bf16 v[128:131], v[112:115], v[80:83], v[128:131]
  ds_read_b128 v[32:35], v8 offset:49152
  v_mfma_f32_16x16x32_bf16 v[160:163], v[116:119], v[80:83], v[160:163]
  v_mfma_f32_16x16x32_bf16 v[192:195], v[120:123], v[80:83], v[192:195]
  ds_read_b64_tr_b16 v[64:65], v12 offset:49152
  v_mfma_f32_16x16x32_bf16 v[224:227], v[124:127], v[80:83], v[224:227]
  v_mfma_f32_16x16x32_bf16 v[132:135], v[112:115], v[84:87], v[132:135]
  ds_read_b128 v[36:39], v8 offset:51200
  v_mfma_f32_16x16x32_bf16 v[164:167], v[116:119], v[84:87], v[164:167]
  v_mfma_f32_16x16x32_bf16 v[196:199], v[120:123], v[84:87], v[196:199]
  ds_read_b64_tr_b16 v[66:67], v12 offset:50176
  v_mfma_f32_16x16x32_bf16 v[228:231], v[124:127], v[84:87], v[228:231]
  v_mfma_f32_16x16x32_bf16 v[136:139], v[112:115], v[88:91], v[136:139]
  ds_read_b128 v[40:43], v8 offset:53248
  v_mfma_f32_16x16x32_bf16 v[168:171], v[116:119], v[88:91], v[168:171]
  v_mfma_f32_16x16x32_bf16 v[200:203], v[120:123], v[88:91], v[200:203]
  ds_read_b64_tr_b16 v[68:69], v13 offset:49152
  v_mfma_f32_16x16x32_bf16 v[232:235], v[124:127], v[88:91], v[232:235]
  v_mfma_f32_16x16x32_bf16 v[140:143], v[112:115], v[92:95], v[140:143]
  ds_read_b128 v[44:47], v8 offset:55296
  v_mfma_f32_16x16x32_bf16 v[172:175], v[116:119], v[92:95], v[172:175]
  v_mfma_f32_16x16x32_bf16 v[204:207], v[120:123], v[92:95], v[204:207]
  ds_read_b64_tr_b16 v[70:71], v13 offset:50176
  v_mfma_f32_16x16x32_bf16 v[236:239], v[124:127], v[92:95], v[236:239]
  v_mfma_f32_16x16x32_bf16 v[144:147], v[112:115], v[96:99], v[144:147]
  ds_read_b128 v[48:51], v8 offset:57344
  v_mfma_f32_16x16x32_bf16 v[176:179], v[116:119], v[96:99], v[176:179]
  v_mfma_f32_16x16x32_bf16 v[208:211], v[120:123], v[96:99], v[208:211]
  ds_read_b64_tr_b16 v[72:73], v14 offset:49152
  v_mfma_f32_16x16x32_bf16 v[240:243], v[124:127], v[96:99], v[240:243]
  v_mfma_f32_16x16x32_bf16 v[148:151], v[112:115], v[100:103], v[148:151]
  ds_read_b128 v[52:55], v8 offset:59392
  v_mfma_f32_16x16x32_bf16 v[180:183], v[116:119], v[100:103], v[180:183]
  v_mfma_f32_16x16x32_bf16 v[212:215], v[120:123], v[100:103], v[212:215]
  ds_read_b64_tr_b16 v[74:75], v14 offset:50176
  v_mfma_f32_16x16x32_bf16 v[244:247], v[124:127], v[100:103], v[244:247]
  v_mfma_f32_16x16x32_bf16 v[152:155], v[112:115], v[104:107], v[152:155]
  ds_read_b128 v[56:59], v8 offset:61440
  v_mfma_f32_16x16x32_bf16 v[184:187], v[116:119], v[104:107], v[184:187]
  v_mfma_f32_16x16x32_bf16 v[216:219], v[120:123], v[104:107], v[216:219]
  ds_read_b64_tr_b16 v[76:77], v15 offset:49152
  v_mfma_f32_16x16x32_bf16 v[248:251], v[124:127], v[104:107], v[248:251]
  v_mfma_f32_16x16x32_bf16 v[156:159], v[112:115], v[108:111], v[156:159]
  ds_read_b128 v[60:63], v8 offset:63488
  v_mfma_f32_16x16x32_bf16 v[188:191], v[116:119], v[108:111], v[188:191]
  v_mfma_f32_16x16x32_bf16 v[220:223], v[120:123], v[108:111], v[220:223]
  ds_read_b64_tr_b16 v[78:79], v15 offset:50176
  v_mfma_f32_16x16x32_bf16 v[252:255], v[124:127], v[108:111], v[252:255]
  s_waitcnt lgkmcnt(0)
  v_mfma_f32_16x16x32_bf16 v[128:131], v[64:67], v[32:35], v[128:131]
  ds_read_b128 v[80:83], v9 offset:49152
  v_mfma_f32_16x16x32_bf16 v[160:163], v[68:71], v[32:35], v[160:163]
  v_mfma_f32_16x16x32_bf16 v[192:195], v[72:75], v[32:35], v[192:195]
  ds_read_b64_tr_b16 v[112:113], v12 offset:57344
  v_mfma_f32_16x16x32_bf16 v[224:227], v[76:79], v[32:35], v[224:227]
  v_mfma_f32_16x16x32_bf16 v[132:135], v[64:67], v[36:39], v[132:135]
  ds_read_b128 v[84:87], v9 offset:51200
  v_mfma_f32_16x16x32_bf16 v[164:167], v[68:71], v[36:39], v[164:167]
  v_mfma_f32_16x16x32_bf16 v[196:199], v[72:75], v[36:39], v[196:199]
  ds_read_b64_tr_b16 v[114:115], v12 offset:58368
  v_mfma_f32_16x16x32_bf16 v[228:231], v[76:79], v[36:39], v[228:231]
  v_mfma_f32_16x16x32_bf16 v[136:139], v[64:67], v[40:43], v[136:139]
  ds_read_b128 v[88:91], v9 offset:53248
  v_mfma_f32_16x16x32_bf16 v[168:171], v[68:71], v[40:43], v[168:171]
  v_mfma_f32_16x16x32_bf16 v[200:203], v[72:75], v[40:43], v[200:203]
  ds_read_b64_tr_b16 v[116:117], v13 offset:57344
  v_mfma_f32_16x16x32_bf16 v[232:235], v[76:79], v[40:43], v[232:235]
  v_mfma_f32_16x16x32_bf16 v[140:143], v[64:67], v[44:47], v[140:143]
  ds_read_b128 v[92:95], v9 offset:55296
  v_mfma_f32_16x16x32_bf16 v[172:175], v[68:71], v[44:47], v[172:175]
  v_mfma_f32_16x16x32_bf16 v[204:207], v[72:75], v[44:47], v[204:207]
  ds_read_b64_tr_b16 v[118:119], v13 offset:58368
  v_mfma_f32_16x16x32_bf16 v[236:239], v[76:79], v[44:47], v[236:239]
  v_mfma_f32_16x16x32_bf16 v[144:147], v[64:67], v[48:51], v[144:147]
  ds_read_b128 v[96:99], v9 offset:57344
  v_mfma_f32_16x16x32_bf16 v[176:179], v[68:71], v[48:51], v[176:179]
  v_mfma_f32_16x16x32_bf16 v[208:211], v[72:75], v[48:51], v[208:211]
  ds_read_b64_tr_b16 v[120:121], v14 offset:57344
  v_mfma_f32_16x16x32_bf16 v[240:243], v[76:79], v[48:51], v[240:243]
  v_mfma_f32_16x16x32_bf16 v[148:151], v[64:67], v[52:55], v[148:151]
  ds_read_b128 v[100:103], v9 offset:59392
  v_mfma_f32_16x16x32_bf16 v[180:183], v[68:71], v[52:55], v[180:183]
  v_mfma_f32_16x16x32_bf16 v[212:215], v[72:75], v[52:55], v[212:215]
  ds_read_b64_tr_b16 v[122:123], v14 offset:58368
  v_mfma_f32_16x16x32_bf16 v[244:247], v[76:79], v[52:55], v[244:247]
  v_mfma_f32_16x16x32_bf16 v[152:155], v[64:67], v[56:59], v[152:155]
  ds_read_b128 v[104:107], v9 offset:61440
  v_mfma_f32_16x16x32_bf16 v[184:187], v[68:71], v[56:59], v[184:187]
  v_mfma_f32_16x16x32_bf16 v[216:219], v[72:75], v[56:59], v[216:219]
  ds_read_b64_tr_b16 v[124:125], v15 offset:57344
  v_mfma_f32_16x16x32_bf16 v[248:251], v[76:79], v[56:59], v[248:251]
  v_mfma_f32_16x16x32_bf16 v[156:159], v[64:67], v[60:63], v[156:159]
  ds_read_b128 v[108:111], v9 offset:63488
  v_mfma_f32_16x16x32_bf16 v[188:191], v[68:71], v[60:63], v[188:191]
  v_mfma_f32_16x16x32_bf16 v[220:223], v[72:75], v[60:63], v[220:223]
  ds_read_b64_tr_b16 v[126:127], v15 offset:58368
  v_mfma_f32_16x16x32_bf16 v[252:255], v[76:79], v[60:63], v[252:255]
  s_waitcnt lgkmcnt(0)
  s_barrier
  s_waitcnt lgkmcnt(0)
  v_mfma_f32_16x16x32_bf16 v[128:131], v[112:115], v[80:83], v[128:131]
  ds_read_b128 v[32:35], v10 offset:0
  v_mfma_f32_16x16x32_bf16 v[160:163], v[116:119], v[80:83], v[160:163]
  v_mfma_f32_16x16x32_bf16 v[192:195], v[120:123], v[80:83], v[192:195]
  ds_read_b64_tr_b16 v[64:65], v16 offset:0
  v_mfma_f32_16x16x32_bf16 v[224:227], v[124:127], v[80:83], v[224:227]
  v_mfma_f32_16x16x32_bf16 v[132:135], v[112:115], v[84:87], v[132:135]
  ds_read_b128 v[36:39], v10 offset:2048
  v_mfma_f32_16x16x32_bf16 v[164:167], v[116:119], v[84:87], v[164:167]
  v_mfma_f32_16x16x32_bf16 v[196:199], v[120:123], v[84:87], v[196:199]
  ds_read_b64_tr_b16 v[66:67], v16 offset:1024
  v_mfma_f32_16x16x32_bf16 v[228:231], v[124:127], v[84:87], v[228:231]
  v_mfma_f32_16x16x32_bf16 v[136:139], v[112:115], v[88:91], v[136:139]
  ds_read_b128 v[40:43], v10 offset:4096
  v_mfma_f32_16x16x32_bf16 v[168:171], v[116:119], v[88:91], v[168:171]
  v_mfma_f32_16x16x32_bf16 v[200:203], v[120:123], v[88:91], v[200:203]
  ds_read_b64_tr_b16 v[68:69], v17 offset:0
  v_mfma_f32_16x16x32_bf16 v[232:235], v[124:127], v[88:91], v[232:235]
  v_mfma_f32_16x16x32_bf16 v[140:143], v[112:115], v[92:95], v[140:143]
  ds_read_b128 v[44:47], v10 offset:6144
  v_mfma_f32_16x16x32_bf16 v[172:175], v[116:119], v[92:95], v[172:175]
  v_mfma_f32_16x16x32_bf16 v[204:207], v[120:123], v[92:95], v[204:207]
  ds_read_b64_tr_b16 v[70:71], v17 offset:1024
  v_mfma_f32_16x16x32_bf16 v[236:239], v[124:127], v[92:95], v[236:239]
  v_mfma_f32_16x16x32_bf16 v[144:147], v[112:115], v[96:99], v[144:147]
  ds_read_b128 v[48:51], v10 offset:8192
  v_mfma_f32_16x16x32_bf16 v[176:179], v[116:119], v[96:99], v[176:179]
  v_mfma_f32_16x16x32_bf16 v[208:211], v[120:123], v[96:99], v[208:211]
  ds_read_b64_tr_b16 v[72:73], v18 offset:0
  v_mfma_f32_16x16x32_bf16 v[240:243], v[124:127], v[96:99], v[240:243]
  v_mfma_f32_16x16x32_bf16 v[148:151], v[112:115], v[100:103], v[148:151]
  ds_read_b128 v[52:55], v10 offset:10240
  v_mfma_f32_16x16x32_bf16 v[180:183], v[116:119], v[100:103], v[180:183]
  v_mfma_f32_16x16x32_bf16 v[212:215], v[120:123], v[100:103], v[212:215]
  ds_read_b64_tr_b16 v[74:75], v18 offset:1024
  v_mfma_f32_16x16x32_bf16 v[244:247], v[124:127], v[100:103], v[244:247]
  v_mfma_f32_16x16x32_bf16 v[152:155], v[112:115], v[104:107], v[152:155]
  ds_read_b128 v[56:59], v10 offset:12288
  v_mfma_f32_16x16x32_bf16 v[184:187], v[116:119], v[104:107], v[184:187]
  v_mfma_f32_16x16x32_bf16 v[216:219], v[120:123], v[104:107], v[216:219]
  ds_read_b64_tr_b16 v[76:77], v19 offset:0
  v_mfma_f32_16x16x32_bf16 v[248:251], v[124:127], v[104:107], v[248:251]
  v_mfma_f32_16x16x32_bf16 v[156:159], v[112:115], v[108:111], v[156:159]
  ds_read_b128 v[60:63], v10 offset:14336
  v_mfma_f32_16x16x32_bf16 v[188:191], v[116:119], v[108:111], v[188:191]
  v_mfma_f32_16x16x32_bf16 v[220:223], v[120:123], v[108:111], v[220:223]
  ds_read_b64_tr_b16 v[78:79], v19 offset:1024
  v_mfma_f32_16x16x32_bf16 v[252:255], v[124:127], v[108:111], v[252:255]
  s_waitcnt lgkmcnt(0)
  v_mfma_f32_16x16x32_bf16 v[128:131], v[64:67], v[32:35], v[128:131]
  ds_read_b128 v[80:83], v11 offset:0
  v_mfma_f32_16x16x32_bf16 v[160:163], v[68:71], v[32:35], v[160:163]
  v_mfma_f32_16x16x32_bf16 v[192:195], v[72:75], v[32:35], v[192:195]
  ds_read_b64_tr_b16 v[112:113], v16 offset:8192
  v_mfma_f32_16x16x32_bf16 v[224:227], v[76:79], v[32:35], v[224:227]
  v_mfma_f32_16x16x32_bf16 v[132:135], v[64:67], v[36:39], v[132:135]
  ds_read_b128 v[84:87], v11 offset:2048
  v_mfma_f32_16x16x32_bf16 v[164:167], v[68:71], v[36:39], v[164:167]
  v_mfma_f32_16x16x32_bf16 v[196:199], v[72:75], v[36:39], v[196:199]
  ds_read_b64_tr_b16 v[114:115], v16 offset:9216
  v_mfma_f32_16x16x32_bf16 v[228:231], v[76:79], v[36:39], v[228:231]
  v_mfma_f32_16x16x32_bf16 v[136:139], v[64:67], v[40:43], v[136:139]
  ds_read_b128 v[88:91], v11 offset:4096
  v_mfma_f32_16x16x32_bf16 v[168:171], v[68:71], v[40:43], v[168:171]
  v_mfma_f32_16x16x32_bf16 v[200:203], v[72:75], v[40:43], v[200:203]
  ds_read_b64_tr_b16 v[116:117], v17 offset:8192
  v_mfma_f32_16x16x32_bf16 v[232:235], v[76:79], v[40:43], v[232:235]
  v_mfma_f32_16x16x32_bf16 v[140:143], v[64:67], v[44:47], v[140:143]
  ds_read_b128 v[92:95], v11 offset:6144
  v_mfma_f32_16x16x32_bf16 v[172:175], v[68:71], v[44:47], v[172:175]
  v_mfma_f32_16x16x32_bf16 v[204:207], v[72:75], v[44:47], v[204:207]
  ds_read_b64_tr_b16 v[118:119], v17 offset:9216
  v_mfma_f32_16x16x32_bf16 v[236:239], v[76:79], v[44:47], v[236:239]
  v_mfma_f32_16x16x32_bf16 v[144:147], v[64:67], v[48:51], v[144:147]
  ds_read_b128 v[96:99], v11 offset:8192
  v_mfma_f32_16x16x32_bf16 v[176:179], v[68:71], v[48:51], v[176:179]
  v_mfma_f32_16x16x32_bf16 v[208:211], v[72:75], v[48:51], v[208:211]
  ds_read_b64_tr_b16 v[120:121], v18 offset:8192
  v_mfma_f32_16x16x32_bf16 v[240:243], v[76:79], v[48:51], v[240:243]
  v_mfma_f32_16x16x32_bf16 v[148:151], v[64:67], v[52:55], v[148:151]
  ds_read_b128 v[100:103], v11 offset:10240
  v_mfma_f32_16x16x32_bf16 v[180:183], v[68:71], v[52:55], v[180:183]
  v_mfma_f32_16x16x32_bf16 v[212:215], v[72:75], v[52:55], v[212:215]
  ds_read_b64_tr_b16 v[122:123], v18 offset:9216
  v_mfma_f32_16x16x32_bf16 v[244:247], v[76:79], v[52:55], v[244:247]
  v_mfma_f32_16x16x32_bf16 v[152:155], v[64:67], v[56:59], v[152:155]
  ds_read_b128 v[104:107], v11 offset:12288
  v_mfma_f32_16x16x32_bf16 v[184:187], v[68:71], v[56:59], v[184:187]
  v_mfma_f32_16x16x32_bf16 v[216:219], v[72:75], v[56:59], v[216:219]
  ds_read_b64_tr_b16 v[124:125], v19 offset:8192
  v_mfma_f32_16x16x32_bf16 v[248:251], v[76:79], v[56:59], v[248:251]
  v_mfma_f32_16x16x32_bf16 v[156:159], v[64:67], v[60:63], v[156:159]
  ds_read_b128 v[108:111], v11 offset:14336
  v_mfma_f32_16x16x32_bf16 v[188:191], v[68:71], v[60:63], v[188:191]
  v_mfma_f32_16x16x32_bf16 v[220:223], v[72:75], v[60:63], v[220:223]
  ds_read_b64_tr_b16 v[126:127], v19 offset:9216
  v_mfma_f32_16x16x32_bf16 v[252:255], v[76:79], v[60:63], v[252:255]
  s_waitcnt lgkmcnt(0)
  s_barrier
  s_waitcnt lgkmcnt(0)
  v_mfma_f32_16x16x32_bf16 v[128:131], v[112:115], v[80:83], v[128:131]
  ds_read_b128 v[32:35], v8 offset:0
  v_mfma_f32_16x16x32_bf16 v[160:163], v[116:119], v[80:83], v[160:163]
  v_mfma_f32_16x16x32_bf16 v[192:195], v[120:123], v[80:83], v[192:195]
  ds_read_b64_tr_b16 v[64:65], v12 offset:0
  v_mfma_f32_16x16x32_bf16 v[224:227], v[124:127], v[80:83], v[224:227]
  v_mfma_f32_16x16x32_bf16 v[132:135], v[112:115], v[84:87], v[132:135]
  ds_read_b128 v[36:39], v8 offset:2048
  v_mfma_f32_16x16x32_bf16 v[164:167], v[116:119], v[84:87], v[164:167]
  v_mfma_f32_16x16x32_bf16 v[196:199], v[120:123], v[84:87], v[196:199]
  ds_read_b64_tr_b16 v[66:67], v12 offset:1024
  v_mfma_f32_16x16x32_bf16 v[228:231], v[124:127], v[84:87], v[228:231]
  v_mfma_f32_16x16x32_bf16 v[136:139], v[112:115], v[88:91], v[136:139]
  ds_read_b128 v[40:43], v8 offset:4096
  v_mfma_f32_16x16x32_bf16 v[168:171], v[116:119], v[88:91], v[168:171]
  v_mfma_f32_16x16x32_bf16 v[200:203], v[120:123], v[88:91], v[200:203]
  ds_read_b64_tr_b16 v[68:69], v13 offset:0
  v_mfma_f32_16x16x32_bf16 v[232:235], v[124:127], v[88:91], v[232:235]
  v_mfma_f32_16x16x32_bf16 v[140:143], v[112:115], v[92:95], v[140:143]
  ds_read_b128 v[44:47], v8 offset:6144
  v_mfma_f32_16x16x32_bf16 v[172:175], v[116:119], v[92:95], v[172:175]
  v_mfma_f32_16x16x32_bf16 v[204:207], v[120:123], v[92:95], v[204:207]
  ds_read_b64_tr_b16 v[70:71], v13 offset:1024
  v_mfma_f32_16x16x32_bf16 v[236:239], v[124:127], v[92:95], v[236:239]
  v_mfma_f32_16x16x32_bf16 v[144:147], v[112:115], v[96:99], v[144:147]
  ds_read_b128 v[48:51], v8 offset:8192
  v_mfma_f32_16x16x32_bf16 v[176:179], v[116:119], v[96:99], v[176:179]
  v_mfma_f32_16x16x32_bf16 v[208:211], v[120:123], v[96:99], v[208:211]
  ds_read_b64_tr_b16 v[72:73], v14 offset:0
  v_mfma_f32_16x16x32_bf16 v[240:243], v[124:127], v[96:99], v[240:243]
  v_mfma_f32_16x16x32_bf16 v[148:151], v[112:115], v[100:103], v[148:151]
  ds_read_b128 v[52:55], v8 offset:10240
  v_mfma_f32_16x16x32_bf16 v[180:183], v[116:119], v[100:103], v[180:183]
  v_mfma_f32_16x16x32_bf16 v[212:215], v[120:123], v[100:103], v[212:215]
  ds_read_b64_tr_b16 v[74:75], v14 offset:1024
  v_mfma_f32_16x16x32_bf16 v[244:247], v[124:127], v[100:103], v[244:247]
  v_mfma_f32_16x16x32_bf16 v[152:155], v[112:115], v[104:107], v[152:155]
  ds_read_b128 v[56:59], v8 offset:12288
  v_mfma_f32_16x16x32_bf16 v[184:187], v[116:119], v[104:107], v[184:187]
  v_mfma_f32_16x16x32_bf16 v[216:219], v[120:123], v[104:107], v[216:219]
  ds_read_b64_tr_b16 v[76:77], v15 offset:0
  v_mfma_f32_16x16x32_bf16 v[248:251], v[124:127], v[104:107], v[248:251]
  v_mfma_f32_16x16x32_bf16 v[156:159], v[112:115], v[108:111], v[156:159]
  ds_read_b128 v[60:63], v8 offset:14336
  v_mfma_f32_16x16x32_bf16 v[188:191], v[116:119], v[108:111], v[188:191]
  v_mfma_f32_16x16x32_bf16 v[220:223], v[120:123], v[108:111], v[220:223]
  ds_read_b64_tr_b16 v[78:79], v15 offset:1024
  v_mfma_f32_16x16x32_bf16 v[252:255], v[124:127], v[108:111], v[252:255]
  s_waitcnt lgkmcnt(0)
  v_mfma_f32_16x16x32_bf16 v[128:131], v[64:67], v[32:35], v[128:131]
  ds_read_b128 v[80:83], v9 offset:0
  v_mfma_f32_16x16x32_bf16 v[160:163], v[68:71], v[32:35], v[160:163]
  v_mfma_f32_16x16x32_bf16 v[192:195], v[72:75], v[32:35], v[192:195]
  ds_read_b64_tr_b16 v[112:113], v12 offset:8192
  v_mfma_f32_16x16x32_bf16 v[224:227], v[76:79], v[32:35], v[224:227]
  v_mfma_f32_16x16x32_bf16 v[132:135], v[64:67], v[36:39], v[132:135]
  ds_read_b128 v[84:87], v9 offset:2048
  v_mfma_f32_16x16x32_bf16 v[164:167], v[68:71], v[36:39], v[164:167]
  v_mfma_f32_16x16x32_bf16 v[196:199], v[72:75], v[36:39], v[196:199]
  ds_read_b64_tr_b16 v[114:115], v12 offset:9216
  v_mfma_f32_16x16x32_bf16 v[228:231], v[76:79], v[36:39], v[228:231]
  v_mfma_f32_16x16x32_bf16 v[136:139], v[64:67], v[40:43], v[136:139]
  ds_read_b128 v[88:91], v9 offset:4096
  v_mfma_f32_16x16x32_bf16 v[168:171], v[68:71], v[40:43], v[168:171]
  v_mfma_f32_16x16x32_bf16 v[200:203], v[72:75], v[40:43], v[200:203]
  ds_read_b64_tr_b16 v[116:117], v13 offset:8192
  v_mfma_f32_16x16x32_bf16 v[232:235], v[76:79], v[40:43], v[232:235]
  v_mfma_f32_16x16x32_bf16 v[140:143], v[64:67], v[44:47], v[140:143]
  ds_read_b128 v[92:95], v9 offset:6144
  v_mfma_f32_16x16x32_bf16 v[172:175], v[68:71], v[44:47], v[172:175]
  v_mfma_f32_16x16x32_bf16 v[204:207], v[72:75], v[44:47], v[204:207]
  ds_read_b64_tr_b16 v[118:119], v13 offset:9216
  v_mfma_f32_16x16x32_bf16 v[236:239], v[76:79], v[44:47], v[236:239]
  v_mfma_f32_16x16x32_bf16 v[144:147], v[64:67], v[48:51], v[144:147]
  ds_read_b128 v[96:99], v9 offset:8192
  v_mfma_f32_16x16x32_bf16 v[176:179], v[68:71], v[48:51], v[176:179]
  v_mfma_f32_16x16x32_bf16 v[208:211], v[72:75], v[48:51], v[208:211]
  ds_read_b64_tr_b16 v[120:121], v14 offset:8192
  v_mfma_f32_16x16x32_bf16 v[240:243], v[76:79], v[48:51], v[240:243]
  v_mfma_f32_16x16x32_bf16 v[148:151], v[64:67], v[52:55], v[148:151]
  ds_read_b128 v[100:103], v9 offset:10240
  v_mfma_f32_16x16x32_bf16 v[180:183], v[68:71], v[52:55], v[180:183]
  v_mfma_f32_16x16x32_bf16 v[212:215], v[72:75], v[52:55], v[212:215]
  ds_read_b64_tr_b16 v[122:123], v14 offset:9216
  v_mfma_f32_16x16x32_bf16 v[244:247], v[76:79], v[52:55], v[244:247]
  v_mfma_f32_16x16x32_bf16 v[152:155], v[64:67], v[56:59], v[152:155]
  ds_read_b128 v[104:107], v9 offset:12288
  v_mfma_f32_16x16x32_bf16 v[184:187], v[68:71], v[56:59], v[184:187]
  v_mfma_f32_16x16x32_bf16 v[216:219], v[72:75], v[56:59], v[216:219]
  ds_read_b64_tr_b16 v[124:125], v15 offset:8192
  v_mfma_f32_16x16x32_bf16 v[248:251], v[76:79], v[56:59], v[248:251]
  v_mfma_f32_16x16x32_bf16 v[156:159], v[64:67], v[60:63], v[156:159]
  ds_read_b128 v[108:111], v9 offset:14336
  v_mfma_f32_16x16x32_bf16 v[188:191], v[68:71], v[60:63], v[188:191]
  v_mfma_f32_16x16x32_bf16 v[220:223], v[72:75], v[60:63], v[220:223]
  ds_read_b64_tr_b16 v[126:127], v15 offset:9216
  v_mfma_f32_16x16x32_bf16 v[252:255], v[76:79], v[60:63], v[252:255]
  s_waitcnt lgkmcnt(0)
  s_barrier
  s_waitcnt lgkmcnt(0)
  v_mfma_f32_16x16x32_bf16 v[128:131], v[112:115], v[80:83], v[128:131]
  ds_read_b128 v[32:35], v8 offset:49152
  v_mfma_f32_16x16x32_bf16 v[160:163], v[116:119], v[80:83], v[160:163]
  v_mfma_f32_16x16x32_bf16 v[192:195], v[120:123], v[80:83], v[192:195]
  ds_read_b64_tr_b16 v[64:65], v12 offset:49152
  v_mfma_f32_16x16x32_bf16 v[224:227], v[124:127], v[80:83], v[224:227]
  v_mfma_f32_16x16x32_bf16 v[132:135], v[112:115], v[84:87], v[132:135]
  ds_read_b128 v[36:39], v8 offset:51200
  v_mfma_f32_16x16x32_bf16 v[164:167], v[116:119], v[84:87], v[164:167]
  v_mfma_f32_16x16x32_bf16 v[196:199], v[120:123], v[84:87], v[196:199]
  ds_read_b64_tr_b16 v[66:67], v12 offset:50176
  v_mfma_f32_16x16x32_bf16 v[228:231], v[124:127], v[84:87], v[228:231]
  v_mfma_f32_16x16x32_bf16 v[136:139], v[112:115], v[88:91], v[136:139]
  ds_read_b128 v[40:43], v8 offset:53248
  v_mfma_f32_16x16x32_bf16 v[168:171], v[116:119], v[88:91], v[168:171]
  v_mfma_f32_16x16x32_bf16 v[200:203], v[120:123], v[88:91], v[200:203]
  ds_read_b64_tr_b16 v[68:69], v13 offset:49152
  v_mfma_f32_16x16x32_bf16 v[232:235], v[124:127], v[88:91], v[232:235]
  v_mfma_f32_16x16x32_bf16 v[140:143], v[112:115], v[92:95], v[140:143]
  ds_read_b128 v[44:47], v8 offset:55296
  v_mfma_f32_16x16x32_bf16 v[172:175], v[116:119], v[92:95], v[172:175]
  v_mfma_f32_16x16x32_bf16 v[204:207], v[120:123], v[92:95], v[204:207]
  ds_read_b64_tr_b16 v[70:71], v13 offset:50176
  v_mfma_f32_16x16x32_bf16 v[236:239], v[124:127], v[92:95], v[236:239]
  v_mfma_f32_16x16x32_bf16 v[144:147], v[112:115], v[96:99], v[144:147]
  ds_read_b128 v[48:51], v8 offset:57344
  v_mfma_f32_16x16x32_bf16 v[176:179], v[116:119], v[96:99], v[176:179]
  v_mfma_f32_16x16x32_bf16 v[208:211], v[120:123], v[96:99], v[208:211]
  ds_read_b64_tr_b16 v[72:73], v14 offset:49152
  v_mfma_f32_16x16x32_bf16 v[240:243], v[124:127], v[96:99], v[240:243]
  v_mfma_f32_16x16x32_bf16 v[148:151], v[112:115], v[100:103], v[148:151]
  ds_read_b128 v[52:55], v8 offset:59392
  v_mfma_f32_16x16x32_bf16 v[180:183], v[116:119], v[100:103], v[180:183]
  v_mfma_f32_16x16x32_bf16 v[212:215], v[120:123], v[100:103], v[212:215]
  ds_read_b64_tr_b16 v[74:75], v14 offset:50176
  v_mfma_f32_16x16x32_bf16 v[244:247], v[124:127], v[100:103], v[244:247]
  v_mfma_f32_16x16x32_bf16 v[152:155], v[112:115], v[104:107], v[152:155]
  ds_read_b128 v[56:59], v8 offset:61440
  v_mfma_f32_16x16x32_bf16 v[184:187], v[116:119], v[104:107], v[184:187]
  v_mfma_f32_16x16x32_bf16 v[216:219], v[120:123], v[104:107], v[216:219]
  ds_read_b64_tr_b16 v[76:77], v15 offset:49152
  v_mfma_f32_16x16x32_bf16 v[248:251], v[124:127], v[104:107], v[248:251]
  v_mfma_f32_16x16x32_bf16 v[156:159], v[112:115], v[108:111], v[156:159]
  ds_read_b128 v[60:63], v8 offset:63488
  v_mfma_f32_16x16x32_bf16 v[188:191], v[116:119], v[108:111], v[188:191]
  v_mfma_f32_16x16x32_bf16 v[220:223], v[120:123], v[108:111], v[220:223]
  ds_read_b64_tr_b16 v[78:79], v15 offset:50176
  v_mfma_f32_16x16x32_bf16 v[252:255], v[124:127], v[108:111], v[252:255]
  s_waitcnt lgkmcnt(0)
  v_mfma_f32_16x16x32_bf16 v[128:131], v[64:67], v[32:35], v[128:131]
  ds_read_b128 v[80:83], v9 offset:49152
  v_mfma_f32_16x16x32_bf16 v[160:163], v[68:71], v[32:35], v[160:163]
  v_mfma_f32_16x16x32_bf16 v[192:195], v[72:75], v[32:35], v[192:195]
  ds_read_b64_tr_b16 v[112:113], v12 offset:57344
  v_mfma_f32_16x16x32_bf16 v[224:227], v[76:79], v[32:35], v[224:227]
  v_mfma_f32_16x16x32_bf16 v[132:135], v[64:67], v[36:39], v[132:135]
  ds_read_b128 v[84:87], v9 offset:51200
  v_mfma_f32_16x16x32_bf16 v[164:167], v[68:71], v[36:39], v[164:167]
  v_mfma_f32_16x16x32_bf16 v[196:199], v[72:75], v[36:39], v[196:199]
  ds_read_b64_tr_b16 v[114:115], v12 offset:58368
  v_mfma_f32_16x16x32_bf16 v[228:231], v[76:79], v[36:39], v[228:231]
  v_mfma_f32_16x16x32_bf16 v[136:139], v[64:67], v[40:43], v[136:139]
  ds_read_b128 v[88:91], v9 offset:53248
  v_mfma_f32_16x16x32_bf16 v[168:171], v[68:71], v[40:43], v[168:171]
  v_mfma_f32_16x16x32_bf16 v[200:203], v[72:75], v[40:43], v[200:203]
  ds_read_b64_tr_b16 v[116:117], v13 offset:57344
  v_mfma_f32_16x16x32_bf16 v[232:235], v[76:79], v[40:43], v[232:235]
  v_mfma_f32_16x16x32_bf16 v[140:143], v[64:67], v[44:47], v[140:143]
  ds_read_b128 v[92:95], v9 offset:55296
  v_mfma_f32_16x16x32_bf16 v[172:175], v[68:71], v[44:47], v[172:175]
  v_mfma_f32_16x16x32_bf16 v[204:207], v[72:75], v[44:47], v[204:207]
  ds_read_b64_tr_b16 v[118:119], v13 offset:58368
  v_mfma_f32_16x16x32_bf16 v[236:239], v[76:79], v[44:47], v[236:239]
  v_mfma_f32_16x16x32_bf16 v[144:147], v[64:67], v[48:51], v[144:147]
  ds_read_b128 v[96:99], v9 offset:57344
  v_mfma_f32_16x16x32_bf16 v[176:179], v[68:71], v[48:51], v[176:179]
  v_mfma_f32_16x16x32_bf16 v[208:211], v[72:75], v[48:51], v[208:211]
  ds_read_b64_tr_b16 v[120:121], v14 offset:57344
  v_mfma_f32_16x16x32_bf16 v[240:243], v[76:79], v[48:51], v[240:243]
  v_mfma_f32_16x16x32_bf16 v[148:151], v[64:67], v[52:55], v[148:151]
  ds_read_b128 v[100:103], v9 offset:59392
  v_mfma_f32_16x16x32_bf16 v[180:183], v[68:71], v[52:55], v[180:183]
  v_mfma_f32_16x16x32_bf16 v[212:215], v[72:75], v[52:55], v[212:215]
  ds_read_b64_tr_b16 v[122:123], v14 offset:58368
  v_mfma_f32_16x16x32_bf16 v[244:247], v[76:79], v[52:55], v[244:247]
  v_mfma_f32_16x16x32_bf16 v[152:155], v[64:67], v[56:59], v[152:155]
  ds_read_b128 v[104:107], v9 offset:61440
  v_mfma_f32_16x16x32_bf16 v[184:187], v[68:71], v[56:59], v[184:187]
  v_mfma_f32_16x16x32_bf16 v[216:219], v[72:75], v[56:59], v[216:219]
  ds_read_b64_tr_b16 v[124:125], v15 offset:57344
  v_mfma_f32_16x16x32_bf16 v[248:251], v[76:79], v[56:59], v[248:251]
  v_mfma_f32_16x16x32_bf16 v[156:159], v[64:67], v[60:63], v[156:159]
  ds_read_b128 v[108:111], v9 offset:63488
  v_mfma_f32_16x16x32_bf16 v[188:191], v[68:71], v[60:63], v[188:191]
  v_mfma_f32_16x16x32_bf16 v[220:223], v[72:75], v[60:63], v[220:223]
  ds_read_b64_tr_b16 v[126:127], v15 offset:58368
  v_mfma_f32_16x16x32_bf16 v[252:255], v[76:79], v[60:63], v[252:255]
  s_waitcnt lgkmcnt(0)
  s_barrier
  v_mov_b32 v3, 147456
  ds_read_b32 v4, v3
  s_waitcnt lgkmcnt(0)
  v_mfma_f32_16x16x32_bf16 v[128:131], v[112:115], v[80:83], v[128:131]
  ds_read_b128 v[32:35], v10 offset:0
  v_mfma_f32_16x16x32_bf16 v[160:163], v[116:119], v[80:83], v[160:163]
  v_mfma_f32_16x16x32_bf16 v[192:195], v[120:123], v[80:83], v[192:195]
  ds_read_b64_tr_b16 v[64:65], v16 offset:0
  v_mfma_f32_16x16x32_bf16 v[224:227], v[124:127], v[80:83], v[224:227]
  v_mfma_f32_16x16x32_bf16 v[132:135], v[112:115], v[84:87], v[132:135]
  ds_read_b128 v[36:39], v10 offset:2048
  v_mfma_f32_16x16x32_bf16 v[164:167], v[116:119], v[84:87], v[164:167]
  v_mfma_f32_16x16x32_bf16 v[196:199], v[120:123], v[84:87], v[196:199]
  ds_read_b64_tr_b16 v[66:67], v16 offset:1024
  v_mfma_f32_16x16x32_bf16 v[228:231], v[124:127], v[84:87], v[228:231]
  v_mfma_f32_16x16x32_bf16 v[136:139], v[112:115], v[88:91], v[136:139]
  ds_read_b128 v[40:43], v10 offset:4096
  v_mfma_f32_16x16x32_bf16 v[168:171], v[116:119], v[88:91], v[168:171]
  v_mfma_f32_16x16x32_bf16 v[200:203], v[120:123], v[88:91], v[200:203]
  ds_read_b64_tr_b16 v[68:69], v17 offset:0
  v_mfma_f32_16x16x32_bf16 v[232:235], v[124:127], v[88:91], v[232:235]
  v_mfma_f32_16x16x32_bf16 v[140:143], v[112:115], v[92:95], v[140:143]
  ds_read_b128 v[44:47], v10 offset:6144
  v_mfma_f32_16x16x32_bf16 v[172:175], v[116:119], v[92:95], v[172:175]
  v_mfma_f32_16x16x32_bf16 v[204:207], v[120:123], v[92:95], v[204:207]
  ds_read_b64_tr_b16 v[70:71], v17 offset:1024
  v_mfma_f32_16x16x32_bf16 v[236:239], v[124:127], v[92:95], v[236:239]
  v_mfma_f32_16x16x32_bf16 v[144:147], v[112:115], v[96:99], v[144:147]
  ds_read_b128 v[48:51], v10 offset:8192
  v_mfma_f32_16x16x32_bf16 v[176:179], v[116:119], v[96:99], v[176:179]
  v_mfma_f32_16x16x32_bf16 v[208:211], v[120:123], v[96:99], v[208:211]
  ds_read_b64_tr_b16 v[72:73], v18 offset:0
  v_mfma_f32_16x16x32_bf16 v[240:243], v[124:127], v[96:99], v[240:243]
  v_mfma_f32_16x16x32_bf16 v[148:151], v[112:115], v[100:103], v[148:151]
  ds_read_b128 v[52:55], v10 offset:10240
  v_mfma_f32_16x16x32_bf16 v[180:183], v[116:119], v[100:103], v[180:183]
  v_mfma_f32_16x16x32_bf16 v[212:215], v[120:123], v[100:103], v[212:215]
  ds_read_b64_tr_b16 v[74:75], v18 offset:1024
  v_mfma_f32_16x16x32_bf16 v[244:247], v[124:127], v[100:103], v[244:247]
  v_mfma_f32_16x16x32_bf16 v[152:155], v[112:115], v[104:107], v[152:155]
  ds_read_b128 v[56:59], v10 offset:12288
  v_mfma_f32_16x16x32_bf16 v[184:187], v[116:119], v[104:107], v[184:187]
  v_mfma_f32_16x16x32_bf16 v[216:219], v[120:123], v[104:107], v[216:219]
  ds_read_b64_tr_b16 v[76:77], v19 offset:0
  v_mfma_f32_16x16x32_bf16 v[248:251], v[124:127], v[104:107], v[248:251]
  v_mfma_f32_16x16x32_bf16 v[156:159], v[112:115], v[108:111], v[156:159]
  ds_read_b128 v[60:63], v10 offset:14336
  v_mfma_f32_16x16x32_bf16 v[188:191], v[116:119], v[108:111], v[188:191]
  v_mfma_f32_16x16x32_bf16 v[220:223], v[120:123], v[108:111], v[220:223]
  ds_read_b64_tr_b16 v[78:79], v19 offset:1024
  v_mfma_f32_16x16x32_bf16 v[252:255], v[124:127], v[108:111], v[252:255]
  v_readfirstlane_b32 s47, v4
  s_waitcnt lgkmcnt(0)
  v_mfma_f32_16x16x32_bf16 v[128:131], v[64:67], v[32:35], v[128:131]
  ds_read_b128 v[80:83], v11 offset:0
  v_mfma_f32_16x16x32_bf16 v[160:163], v[68:71], v[32:35], v[160:163]
  v_mfma_f32_16x16x32_bf16 v[192:195], v[72:75], v[32:35], v[192:195]
  ds_read_b64_tr_b16 v[112:113], v16 offset:8192
  v_mfma_f32_16x16x32_bf16 v[224:227], v[76:79], v[32:35], v[224:227]
  v_mfma_f32_16x16x32_bf16 v[132:135], v[64:67], v[36:39], v[132:135]
  ds_read_b128 v[84:87], v11 offset:2048
  v_mfma_f32_16x16x32_bf16 v[164:167], v[68:71], v[36:39], v[164:167]
  v_mfma_f32_16x16x32_bf16 v[196:199], v[72:75], v[36:39], v[196:199]
  ds_read_b64_tr_b16 v[114:115], v16 offset:9216
  v_mfma_f32_16x16x32_bf16 v[228:231], v[76:79], v[36:39], v[228:231]
  v_mfma_f32_16x16x32_bf16 v[136:139], v[64:67], v[40:43], v[136:139]
  ds_read_b128 v[88:91], v11 offset:4096
  v_mfma_f32_16x16x32_bf16 v[168:171], v[68:71], v[40:43], v[168:171]
  v_mfma_f32_16x16x32_bf16 v[200:203], v[72:75], v[40:43], v[200:203]
  ds_read_b64_tr_b16 v[116:117], v17 offset:8192
  v_mfma_f32_16x16x32_bf16 v[232:235], v[76:79], v[40:43], v[232:235]
  v_mfma_f32_16x16x32_bf16 v[140:143], v[64:67], v[44:47], v[140:143]
  ds_read_b128 v[92:95], v11 offset:6144
  v_mfma_f32_16x16x32_bf16 v[172:175], v[68:71], v[44:47], v[172:175]
  v_mfma_f32_16x16x32_bf16 v[204:207], v[72:75], v[44:47], v[204:207]
  ds_read_b64_tr_b16 v[118:119], v17 offset:9216
  v_mfma_f32_16x16x32_bf16 v[236:239], v[76:79], v[44:47], v[236:239]
  v_mfma_f32_16x16x32_bf16 v[144:147], v[64:67], v[48:51], v[144:147]
  ds_read_b128 v[96:99], v11 offset:8192
  v_mfma_f32_16x16x32_bf16 v[176:179], v[68:71], v[48:51], v[176:179]
  v_mfma_f32_16x16x32_bf16 v[208:211], v[72:75], v[48:51], v[208:211]
  ds_read_b64_tr_b16 v[120:121], v18 offset:8192
  v_mfma_f32_16x16x32_bf16 v[240:243], v[76:79], v[48:51], v[240:243]
  v_mfma_f32_16x16x32_bf16 v[148:151], v[64:67], v[52:55], v[148:151]
  ds_read_b128 v[100:103], v11 offset:10240
  v_mfma_f32_16x16x32_bf16 v[180:183], v[68:71], v[52:55], v[180:183]
  v_mfma_f32_16x16x32_bf16 v[212:215], v[72:75], v[52:55], v[212:215]
  ds_read_b64_tr_b16 v[122:123], v18 offset:9216
  v_mfma_f32_16x16x32_bf16 v[244:247], v[76:79], v[52:55], v[244:247]
  v_mfma_f32_16x16x32_bf16 v[152:155], v[64:67], v[56:59], v[152:155]
  ds_read_b128 v[104:107], v11 offset:12288
  v_mfma_f32_16x16x32_bf16 v[184:187], v[68:71], v[56:59], v[184:187]
  v_mfma_f32_16x16x32_bf16 v[216:219], v[72:75], v[56:59], v[216:219]
  ds_read_b64_tr_b16 v[124:125], v19 offset:8192
  v_mfma_f32_16x16x32_bf16 v[248:251], v[76:79], v[56:59], v[248:251]
  v_mfma_f32_16x16x32_bf16 v[156:159], v[64:67], v[60:63], v[156:159]
  ds_read_b128 v[108:111], v11 offset:14336
  v_mfma_f32_16x16x32_bf16 v[188:191], v[68:71], v[60:63], v[188:191]
  v_mfma_f32_16x16x32_bf16 v[220:223], v[72:75], v[60:63], v[220:223]
  ds_read_b64_tr_b16 v[126:127], v19 offset:9216
  v_mfma_f32_16x16x32_bf16 v[252:255], v[76:79], v[60:63], v[252:255]
  s_waitcnt lgkmcnt(0)
  s_barrier
  v_mov_b32 v3, 147460
  ds_read_b32 v4, v3
  s_waitcnt lgkmcnt(0)
  v_mfma_f32_16x16x32_bf16 v[128:131], v[112:115], v[80:83], v[128:131]
  ds_read_b128 v[32:35], v8 offset:0
  v_mfma_f32_16x16x32_bf16 v[160:163], v[116:119], v[80:83], v[160:163]
  v_mfma_f32_16x16x32_bf16 v[192:195], v[120:123], v[80:83], v[192:195]
  ds_read_b64_tr_b16 v[64:65], v12 offset:0
  v_mfma_f32_16x16x32_bf16 v[224:227], v[124:127], v[80:83], v[224:227]
  v_mfma_f32_16x16x32_bf16 v[132:135], v[112:115], v[84:87], v[132:135]
  ds_read_b128 v[36:39], v8 offset:2048
  v_mfma_f32_16x16x32_bf16 v[164:167], v[116:119], v[84:87], v[164:167]
  v_mfma_f32_16x16x32_bf16 v[196:199], v[120:123], v[84:87], v[196:199]
  ds_read_b64_tr_b16 v[66:67], v12 offset:1024
  v_mfma_f32_16x16x32_bf16 v[228:231], v[124:127], v[84:87], v[228:231]
  v_mfma_f32_16x16x32_bf16 v[136:139], v[112:115], v[88:91], v[136:139]
  ds_read_b128 v[40:43], v8 offset:4096
  v_mfma_f32_16x16x32_bf16 v[168:171], v[116:119], v[88:91], v[168:171]
  v_mfma_f32_16x16x32_bf16 v[200:203], v[120:123], v[88:91], v[200:203]
  ds_read_b64_tr_b16 v[68:69], v13 offset:0
  v_mfma_f32_16x16x32_bf16 v[232:235], v[124:127], v[88:91], v[232:235]
  v_mfma_f32_16x16x32_bf16 v[140:143], v[112:115], v[92:95], v[140:143]
  ds_read_b128 v[44:47], v8 offset:6144
  v_mfma_f32_16x16x32_bf16 v[172:175], v[116:119], v[92:95], v[172:175]
  v_mfma_f32_16x16x32_bf16 v[204:207], v[120:123], v[92:95], v[204:207]
  ds_read_b64_tr_b16 v[70:71], v13 offset:1024
  v_mfma_f32_16x16x32_bf16 v[236:239], v[124:127], v[92:95], v[236:239]
  v_mfma_f32_16x16x32_bf16 v[144:147], v[112:115], v[96:99], v[144:147]
  ds_read_b128 v[48:51], v8 offset:8192
  v_mfma_f32_16x16x32_bf16 v[176:179], v[116:119], v[96:99], v[176:179]
  v_mfma_f32_16x16x32_bf16 v[208:211], v[120:123], v[96:99], v[208:211]
  ds_read_b64_tr_b16 v[72:73], v14 offset:0
  v_mfma_f32_16x16x32_bf16 v[240:243], v[124:127], v[96:99], v[240:243]
  v_mfma_f32_16x16x32_bf16 v[148:151], v[112:115], v[100:103], v[148:151]
  ds_read_b128 v[52:55], v8 offset:10240
  v_mfma_f32_16x16x32_bf16 v[180:183], v[116:119], v[100:103], v[180:183]
  v_mfma_f32_16x16x32_bf16 v[212:215], v[120:123], v[100:103], v[212:215]
  ds_read_b64_tr_b16 v[74:75], v14 offset:1024
  v_mfma_f32_16x16x32_bf16 v[244:247], v[124:127], v[100:103], v[244:247]
  v_mfma_f32_16x16x32_bf16 v[152:155], v[112:115], v[104:107], v[152:155]
  ds_read_b128 v[56:59], v8 offset:12288
  v_mfma_f32_16x16x32_bf16 v[184:187], v[116:119], v[104:107], v[184:187]
  v_mfma_f32_16x16x32_bf16 v[216:219], v[120:123], v[104:107], v[216:219]
  ds_read_b64_tr_b16 v[76:77], v15 offset:0
  v_mfma_f32_16x16x32_bf16 v[248:251], v[124:127], v[104:107], v[248:251]
  v_mfma_f32_16x16x32_bf16 v[156:159], v[112:115], v[108:111], v[156:159]
  ds_read_b128 v[60:63], v8 offset:14336
  v_mfma_f32_16x16x32_bf16 v[188:191], v[116:119], v[108:111], v[188:191]
  v_mfma_f32_16x16x32_bf16 v[220:223], v[120:123], v[108:111], v[220:223]
  ds_read_b64_tr_b16 v[78:79], v15 offset:1024
  v_mfma_f32_16x16x32_bf16 v[252:255], v[124:127], v[108:111], v[252:255]
  v_readfirstlane_b32 s49, v4
  s_nop 0
  s_cmp_lg_u32 s47, 0
  s_cselect_b32 s47, 1, s49
  s_waitcnt lgkmcnt(0)
  v_mfma_f32_16x16x32_bf16 v[128:131], v[64:67], v[32:35], v[128:131]
  ds_read_b128 v[80:83], v9 offset:0
  v_mfma_f32_16x16x32_bf16 v[160:163], v[68:71], v[32:35], v[160:163]
  v_mfma_f32_16x16x32_bf16 v[192:195], v[72:75], v[32:35], v[192:195]
  ds_read_b64_tr_b16 v[112:113], v12 offset:8192
  v_mfma_f32_16x16x32_bf16 v[224:227], v[76:79], v[32:35], v[224:227]
  v_mfma_f32_16x16x32_bf16 v[132:135], v[64:67], v[36:39], v[132:135]
  ds_read_b128 v[84:87], v9 offset:2048
  v_mfma_f32_16x16x32_bf16 v[164:167], v[68:71], v[36:39], v[164:167]
  v_mfma_f32_16x16x32_bf16 v[196:199], v[72:75], v[36:39], v[196:199]
  ds_read_b64_tr_b16 v[114:115], v12 offset:9216
  v_mfma_f32_16x16x32_bf16 v[228:231], v[76:79], v[36:39], v[228:231]
  v_mfma_f32_16x16x32_bf16 v[136:139], v[64:67], v[40:43], v[136:139]
  ds_read_b128 v[88:91], v9 offset:4096
  v_mfma_f32_16x16x32_bf16 v[168:171], v[68:71], v[40:43], v[168:171]
  v_mfma_f32_16x16x32_bf16 v[200:203], v[72:75], v[40:43], v[200:203]
  ds_read_b64_tr_b16 v[116:117], v13 offset:8192
  v_mfma_f32_16x16x32_bf16 v[232:235], v[76:79], v[40:43], v[232:235]
  v_mfma_f32_16x16x32_bf16 v[140:143], v[64:67], v[44:47], v[140:143]
  ds_read_b128 v[92:95], v9 offset:6144
  v_mfma_f32_16x16x32_bf16 v[172:175], v[68:71], v[44:47], v[172:175]
  v_mfma_f32_16x16x32_bf16 v[204:207], v[72:75], v[44:47], v[204:207]
  ds_read_b64_tr_b16 v[118:119], v13 offset:9216
  v_mfma_f32_16x16x32_bf16 v[236:239], v[76:79], v[44:47], v[236:239]
  v_mfma_f32_16x16x32_bf16 v[144:147], v[64:67], v[48:51], v[144:147]
  ds_read_b128 v[96:99], v9 offset:8192
  v_mfma_f32_16x16x32_bf16 v[176:179], v[68:71], v[48:51], v[176:179]
  v_mfma_f32_16x16x32_bf16 v[208:211], v[72:75], v[48:51], v[208:211]
  ds_read_b64_tr_b16 v[120:121], v14 offset:8192
  v_mfma_f32_16x16x32_bf16 v[240:243], v[76:79], v[48:51], v[240:243]
  v_mfma_f32_16x16x32_bf16 v[148:151], v[64:67], v[52:55], v[148:151]
  ds_read_b128 v[100:103], v9 offset:10240
  v_mfma_f32_16x16x32_bf16 v[180:183], v[68:71], v[52:55], v[180:183]
  v_mfma_f32_16x16x32_bf16 v[212:215], v[72:75], v[52:55], v[212:215]
  ds_read_b64_tr_b16 v[122:123], v14 offset:9216
  v_mfma_f32_16x16x32_bf16 v[244:247], v[76:79], v[52:55], v[244:247]
  v_mfma_f32_16x16x32_bf16 v[152:155], v[64:67], v[56:59], v[152:155]
  ds_read_b128 v[104:107], v9 offset:12288
  v_mfma_f32_16x16x32_bf16 v[184:187], v[68:71], v[56:59], v[184:187]
  v_mfma_f32_16x16x32_bf16 v[216:219], v[72:75], v[56:59], v[216:219]
  ds_read_b64_tr_b16 v[124:125], v15 offset:8192
  v_mfma_f32_16x16x32_bf16 v[248:251], v[76:79], v[56:59], v[248:251]
  v_mfma_f32_16x16x32_bf16 v[156:159], v[64:67], v[60:63], v[156:159]
  ds_read_b128 v[108:111], v9 offset:14336
  v_mfma_f32_16x16x32_bf16 v[188:191], v[68:71], v[60:63], v[188:191]
  v_mfma_f32_16x16x32_bf16 v[220:223], v[72:75], v[60:63], v[220:223]
  ds_read_b64_tr_b16 v[126:127], v15 offset:9216
  v_mfma_f32_16x16x32_bf16 v[252:255], v[76:79], v[60:63], v[252:255]
  s_waitcnt lgkmcnt(0)
  v_mfma_f32_16x16x32_bf16 v[128:131], v[112:115], v[80:83], v[128:131]
  v_mfma_f32_16x16x32_bf16 v[160:163], v[116:119], v[80:83], v[160:163]
  v_mfma_f32_16x16x32_bf16 v[192:195], v[120:123], v[80:83], v[192:195]
  v_mfma_f32_16x16x32_bf16 v[224:227], v[124:127], v[80:83], v[224:227]
  v_mfma_f32_16x16x32_bf16 v[132:135], v[112:115], v[84:87], v[132:135]
  v_mfma_f32_16x16x32_bf16 v[164:167], v[116:119], v[84:87], v[164:167]
  v_mfma_f32_16x16x32_bf16 v[196:199], v[120:123], v[84:87], v[196:199]
  v_mfma_f32_16x16x32_bf16 v[228:231], v[124:127], v[84:87], v[228:231]
  v_mfma_f32_16x16x32_bf16 v[136:139], v[112:115], v[88:91], v[136:139]
  v_mfma_f32_16x16x32_bf16 v[168:171], v[116:119], v[88:91], v[168:171]
  v_mfma_f32_16x16x32_bf16 v[200:203], v[120:123], v[88:91], v[200:203]
  v_mfma_f32_16x16x32_bf16 v[232:235], v[124:127], v[88:91], v[232:235]
  v_mfma_f32_16x16x32_bf16 v[140:143], v[112:115], v[92:95], v[140:143]
  v_mfma_f32_16x16x32_bf16 v[172:175], v[116:119], v[92:95], v[172:175]
  v_mfma_f32_16x16x32_bf16 v[204:207], v[120:123], v[92:95], v[204:207]
  v_mfma_f32_16x16x32_bf16 v[236:239], v[124:127], v[92:95], v[236:239]
  v_mfma_f32_16x16x32_bf16 v[144:147], v[112:115], v[96:99], v[144:147]
  v_mfma_f32_16x16x32_bf16 v[176:179], v[116:119], v[96:99], v[176:179]
  v_mfma_f32_16x16x32_bf16 v[208:211], v[120:123], v[96:99], v[208:211]
  v_mfma_f32_16x16x32_bf16 v[240:243], v[124:127], v[96:99], v[240:243]
  v_mfma_f32_16x16x32_bf16 v[148:151], v[112:115], v[100:103], v[148:151]
  v_mfma_f32_16x16x32_bf16 v[180:183], v[116:119], v[100:103], v[180:183]
  v_mfma_f32_16x16x32_bf16 v[212:215], v[120:123], v[100:103], v[212:215]
  v_mfma_f32_16x16x32_bf16 v[244:247], v[124:127], v[100:103], v[244:247]
  v_mfma_f32_16x16x32_bf16 v[152:155], v[112:115], v[104:107], v[152:155]
  v_mfma_f32_16x16x32_bf16 v[184:187], v[116:119], v[104:107], v[184:187]
  v_mfma_f32_16x16x32_bf16 v[216:219], v[120:123], v[104:107], v[216:219]
  v_mfma_f32_16x16x32_bf16 v[248:251], v[124:127], v[104:107], v[248:251]
  v_mfma_f32_16x16x32_bf16 v[156:159], v[112:115], v[108:111], v[156:159]
  v_mfma_f32_16x16x32_bf16 v[188:191], v[116:119], v[108:111], v[188:191]
  v_mfma_f32_16x16x32_bf16 v[220:223], v[120:123], v[108:111], v[220:223]
  v_mfma_f32_16x16x32_bf16 v[252:255], v[124:127], v[108:111], v[252:255]
  s_barrier
  s_cmp_lg_u32 s47, 0
  s_cbranch_scc1 K1_RDY_N
  s_barrier
  s_barrier
K1_RDY_N:
  v_and_b32 v1, 15, v0
  v_lshrrev_b32 v2, 4, v0
  s_lshl_b32 s3, s37, 9
  s_add_u32 s3, s3, 147520
  v_lshlrev_b32 v3, 2, v1
  v_add_u32 v3, s3, v3
  s_lshl_b32 s3, s38, 8
  s_add_u32 s3, s3, 149568
  v_lshlrev_b32 v4, 4, v2
  v_add_u32 v4, s3, v4
  ds_read_b128 v[32:35], v4 offset:0
  ds_read_b128 v[36:39], v4 offset:64
  ds_read_b128 v[40:43], v4 offset:128
  ds_read_b128 v[44:47], v4 offset:192
  ds_read_b32 v48, v3 offset:0
  ds_read_b32 v80, v3 offset:1024
  ds_read_b32 v50, v3 offset:64
  ds_read_b32 v82, v3 offset:1088
  ds_read_b32 v52, v3 offset:128
  ds_read_b32 v84, v3 offset:1152
  ds_read_b32 v54, v3 offset:192
  ds_read_b32 v86, v3 offset:1216
  ds_read_b32 v56, v3 offset:256
  ds_read_b32 v88, v3 offset:1280
  ds_read_b32 v58, v3 offset:320
  ds_read_b32 v90, v3 offset:1344
  ds_read_b32 v60, v3 offset:384
  ds_read_b32 v92, v3 offset:1408
  ds_read_b32 v62, v3 offset:448
  ds_read_b32 v94, v3 offset:1472
  s_waitcnt lgkmcnt(0)
  s_cmp_ge_u32 s40, 15
  s_cbranch_scc1 K1_EPI_H
  v_mul_f32 v80, s57, v80
  v_mul_f32 v82, s57, v82
  v_mul_f32 v84, s57, v84
  v_mul_f32 v86, s57, v86
  v_mul_f32 v88, s57, v88
  v_mul_f32 v90, s57, v90
  v_mul_f32 v92, s57, v92
  v_mul_f32 v94, s57, v94
  v_pk_fma_f32 v[128:129], v[32:33], v[48:49], v[128:129] op_sel_hi:[1,0,1]
  v_pk_fma_f32 v[130:131], v[34:35], v[48:49], v[130:131] op_sel_hi:[1,0,1]
  v_pk_mul_f32 v[128:129], v[128:129], v[80:81] op_sel_hi:[1,0]
  v_pk_mul_f32 v[130:131], v[130:131], v[80:81] op_sel_hi:[1,0]
  v_cvt_pk_bf16_f32 v112, v128, v129
  v_cvt_pk_bf16_f32 v113, v130, v131
  v_pk_fma_f32 v[132:133], v[32:33], v[50:51], v[132:133] op_sel_hi:[1,0,1]
  v_pk_fma_f32 v[134:135], v[34:35], v[50:51], v[134:135] op_sel_hi:[1,0,1]
  v_pk_mul_f32 v[132:133], v[132:133], v[82:83] op_sel_hi:[1,0]
  v_pk_mul_f32 v[134:135], v[134:135], v[82:83] op_sel_hi:[1,0]
  v_cvt_pk_bf16_f32 v114, v132, v133
  v_cvt_pk_bf16_f32 v115, v134, v135
  buffer_store_dwordx4 v[112:115], v20, s[32:35], s56 offen offset:0
  v_pk_fma_f32 v[160:161], v[36:37], v[48:49], v[160:161] op_sel_hi:[1,0,1]
  v_pk_fma_f32 v[162:163], v[38:39], v[48:49], v[162:163] op_sel_hi:[1,0,1]
  v_pk_mul_f32 v[160:161], v[160:161], v[80:81] op_sel_hi:[1,0]
  v_pk_mul_f32 v[162:163], v[162:163], v[80:81] op_sel_hi:[1,0]
  v_cvt_pk_bf16_f32 v116, v160, v161
  v_cvt_pk_bf16_f32 v117, v162, v163
  v_pk_fma_f32 v[164:165], v[36:37], v[50:51], v[164:165] op_sel_hi:[1,0,1]
  v_pk_fma_f32 v[166:167], v[38:39], v[50:51], v[166:167] op_sel_hi:[1,0,1]
  v_pk_mul_f32 v[164:165], v[164:165], v[82:83] op_sel_hi:[1,0]
  v_pk_mul_f32 v[166:167], v[166:167], v[82:83] op_sel_hi:[1,0]
  v_cvt_pk_bf16_f32 v118, v164, v165
  v_cvt_pk_bf16_f32 v119, v166, v167
  buffer_store_dwordx4 v[116:119], v21, s[32:35], s56 offen offset:0
  v_pk_fma_f32 v[192:193], v[40:41], v[48:49], v[192:193] op_sel_hi:[1,0,1]
  v_pk_fma_f32 v[194:195], v[42:43], v[48:49], v[194:195] op_sel_hi:[1,0,1]
  v_pk_mul_f32 v[192:193], v[192:193], v[80:81] op_sel_hi:[1,0]
  v_pk_mul_f32 v[194:195], v[194:195], v[80:81] op_sel_hi:[1,0]
  v_cvt_pk_bf16_f32 v120, v192, v193
  v_cvt_pk_bf16_f32 v121, v194, v195
  v_pk_fma_f32 v[196:197], v[40:41], v[50:51], v[196:197] op_sel_hi:[1,0,1]
  v_pk_fma_f32 v[198:199], v[42:43], v[50:51], v[198:199] op_sel_hi:[1,0,1]
  v_pk_mul_f32 v[196:197], v[196:197], v[82:83] op_sel_hi:[1,0]
  v_pk_mul_f32 v[198:199], v[198:199], v[82:83] op_sel_hi:[1,0]
  v_cvt_pk_bf16_f32 v122, v196, v197
  v_cvt_pk_bf16_f32 v123, v198, v199
  buffer_store_dwordx4 v[120:123], v22, s[32:35], s56 offen offset:0
  v_pk_fma_f32 v[224:225], v[44:45], v[48:49], v[224:225] op_sel_hi:[1,0,1]
  v_pk_fma_f32 v[226:227], v[46:47], v[48:49], v[226:227] op_sel_hi:[1,0,1]
  v_pk_mul_f32 v[224:225], v[224:225], v[80:81] op_sel_hi:[1,0]
  v_pk_mul_f32 v[226:227], v[226:227], v[80:81] op_sel_hi:[1,0]
  v_cvt_pk_bf16_f32 v124, v224, v225
  v_cvt_pk_bf16_f32 v125, v226, v227
  v_pk_fma_f32 v[228:229], v[44:45], v[50:51], v[228:229] op_sel_hi:[1,0,1]
  v_pk_fma_f32 v[230:231], v[46:47], v[50:51], v[230:231] op_sel_hi:[1,0,1]
  v_pk_mul_f32 v[228:229], v[228:229], v[82:83] op_sel_hi:[1,0]
  v_pk_mul_f32 v[230:231], v[230:231], v[82:83] op_sel_hi:[1,0]
  v_cvt_pk_bf16_f32 v126, v228, v229
  v_cvt_pk_bf16_f32 v127, v230, v231
  buffer_store_dwordx4 v[124:127], v23, s[32:35], s56 offen offset:0
  v_pk_fma_f32 v[136:137], v[32:33], v[52:53], v[136:137] op_sel_hi:[1,0,1]
  v_pk_fma_f32 v[138:139], v[34:35], v[52:53], v[138:139] op_sel_hi:[1,0,1]
  v_pk_mul_f32 v[136:137], v[136:137], v[84:85] op_sel_hi:[1,0]
  v_pk_mul_f32 v[138:139], v[138:139], v[84:85] op_sel_hi:[1,0]
  v_cvt_pk_bf16_f32 v112, v136, v137
  v_cvt_pk_bf16_f32 v113, v138, v139
  v_pk_fma_f32 v[140:141], v[32:33], v[54:55], v[140:141] op_sel_hi:[1,0,1]
  v_pk_fma_f32 v[142:143], v[34:35], v[54:55], v[142:143] op_sel_hi:[1,0,1]
  v_pk_mul_f32 v[140:141], v[140:141], v[86:87] op_sel_hi:[1,0]
  v_pk_mul_f32 v[142:143], v[142:143], v[86:87] op_sel_hi:[1,0]
  v_cvt_pk_bf16_f32 v114, v140, v141
  v_cvt_pk_bf16_f32 v115, v142, v143
  buffer_store_dwordx4 v[112:115], v20, s[32:35], s56 offen offset:256
  v_pk_fma_f32 v[168:169], v[36:37], v[52:53], v[168:169] op_sel_hi:[1,0,1]
  v_pk_fma_f32 v[170:171], v[38:39], v[52:53], v[170:171] op_sel_hi:[1,0,1]
  v_pk_mul_f32 v[168:169], v[168:169], v[84:85] op_sel_hi:[1,0]
  v_pk_mul_f32 v[170:171], v[170:171], v[84:85] op_sel_hi:[1,0]
  v_cvt_pk_bf16_f32 v116, v168, v169
  v_cvt_pk_bf16_f32 v117, v170, v171
  v_pk_fma_f32 v[172:173], v[36:37], v[54:55], v[172:173] op_sel_hi:[1,0,1]
  v_pk_fma_f32 v[174:175], v[38:39], v[54:55], v[174:175] op_sel_hi:[1,0,1]
  v_pk_mul_f32 v[172:173], v[172:173], v[86:87] op_sel_hi:[1,0]
  v_pk_mul_f32 v[174:175], v[174:175], v[86:87] op_sel_hi:[1,0]
  v_cvt_pk_bf16_f32 v118, v172, v173
  v_cvt_pk_bf16_f32 v119, v174, v175
  buffer_store_dwordx4 v[116:119], v21, s[32:35], s56 offen offset:256
  v_pk_fma_f32 v[200:201], v[40:41], v[52:53], v[200:201] op_sel_hi:[1,0,1]
  v_pk_fma_f32 v[202:203], v[42:43], v[52:53], v[202:203] op_sel_hi:[1,0,1]
  v_pk_mul_f32 v[200:201], v[200:201], v[84:85] op_sel_hi:[1,0]
  v_pk_mul_f32 v[202:203], v[202:203], v[84:85] op_sel_hi:[1,0]
  v_cvt_pk_bf16_f32 v120, v200, v201
  v_cvt_pk_bf16_f32 v121, v202, v203
  v_pk_fma_f32 v[204:205], v[40:41], v[54:55], v[204:205] op_sel_hi:[1,0,1]
  v_pk_fma_f32 v[206:207], v[42:43], v[54:55], v[206:207] op_sel_hi:[1,0,1]
  v_pk_mul_f32 v[204:205], v[204:205], v[86:87] op_sel_hi:[1,0]
  v_pk_mul_f32 v[206:207], v[206:207], v[86:87] op_sel_hi:[1,0]
  v_cvt_pk_bf16_f32 v122, v204, v205
  v_cvt_pk_bf16_f32 v123, v206, v207
  buffer_store_dwordx4 v[120:123], v22, s[32:35], s56 offen offset:256
  v_pk_fma_f32 v[232:233], v[44:45], v[52:53], v[232:233] op_sel_hi:[1,0,1]
  v_pk_fma_f32 v[234:235], v[46:47], v[52:53], v[234:235] op_sel_hi:[1,0,1]
  v_pk_mul_f32 v[232:233], v[232:233], v[84:85] op_sel_hi:[1,0]
  v_pk_mul_f32 v[234:235], v[234:235], v[84:85] op_sel_hi:[1,0]
  v_cvt_pk_bf16_f32 v124, v232, v233
  v_cvt_pk_bf16_f32 v125, v234, v235
  v_pk_fma_f32 v[236:237], v[44:45], v[54:55], v[236:237] op_sel_hi:[1,0,1]
  v_pk_fma_f32 v[238:239], v[46:47], v[54:55], v[238:239] op_sel_hi:[1,0,1]
  v_pk_mul_f32 v[236:237], v[236:237], v[86:87] op_sel_hi:[1,0]
  v_pk_mul_f32 v[238:239], v[238:239], v[86:87] op_sel_hi:[1,0]
  v_cvt_pk_bf16_f32 v126, v236, v237
  v_cvt_pk_bf16_f32 v127, v238, v239
  buffer_store_dwordx4 v[124:127], v23, s[32:35], s56 offen offset:256
  v_pk_fma_f32 v[144:145], v[32:33], v[56:57], v[144:145] op_sel_hi:[1,0,1]
  v_pk_fma_f32 v[146:147], v[34:35], v[56:57], v[146:147] op_sel_hi:[1,0,1]
  v_pk_mul_f32 v[144:145], v[144:145], v[88:89] op_sel_hi:[1,0]
  v_pk_mul_f32 v[146:147], v[146:147], v[88:89] op_sel_hi:[1,0]
  v_cvt_pk_bf16_f32 v112, v144, v145
  v_cvt_pk_bf16_f32 v113, v146, v147
  v_pk_fma_f32 v[148:149], v[32:33], v[58:59], v[148:149] op_sel_hi:[1,0,1]
  v_pk_fma_f32 v[150:151], v[34:35], v[58:59], v[150:151] op_sel_hi:[1,0,1]
  v_pk_mul_f32 v[148:149], v[148:149], v[90:91] op_sel_hi:[1,0]
  v_pk_mul_f32 v[150:151], v[150:151], v[90:91] op_sel_hi:[1,0]
  v_cvt_pk_bf16_f32 v114, v148, v149
  v_cvt_pk_bf16_f32 v115, v150, v151
  buffer_store_dwordx4 v[112:115], v20, s[32:35], s56 offen offset:512
  v_pk_fma_f32 v[176:177], v[36:37], v[56:57], v[176:177] op_sel_hi:[1,0,1]
  v_pk_fma_f32 v[178:179], v[38:39], v[56:57], v[178:179] op_sel_hi:[1,0,1]
  v_pk_mul_f32 v[176:177], v[176:177], v[88:89] op_sel_hi:[1,0]
  v_pk_mul_f32 v[178:179], v[178:179], v[88:89] op_sel_hi:[1,0]
  v_cvt_pk_bf16_f32 v116, v176, v177
  v_cvt_pk_bf16_f32 v117, v178, v179
  v_pk_fma_f32 v[180:181], v[36:37], v[58:59], v[180:181] op_sel_hi:[1,0,1]
  v_pk_fma_f32 v[182:183], v[38:39], v[58:59], v[182:183] op_sel_hi:[1,0,1]
  v_pk_mul_f32 v[180:181], v[180:181], v[90:91] op_sel_hi:[1,0]
  v_pk_mul_f32 v[182:183], v[182:183], v[90:91] op_sel_hi:[1,0]
  v_cvt_pk_bf16_f32 v118, v180, v181
  v_cvt_pk_bf16_f32 v119, v182, v183
  buffer_store_dwordx4 v[116:119], v21, s[32:35], s56 offen offset:512
  v_pk_fma_f32 v[208:209], v[40:41], v[56:57], v[208:209] op_sel_hi:[1,0,1]
  v_pk_fma_f32 v[210:211], v[42:43], v[56:57], v[210:211] op_sel_hi:[1,0,1]
  v_pk_mul_f32 v[208:209], v[208:209], v[88:89] op_sel_hi:[1,0]
  v_pk_mul_f32 v[210:211], v[210:211], v[88:89] op_sel_hi:[1,0]
  v_cvt_pk_bf16_f32 v120, v208, v209
  v_cvt_pk_bf16_f32 v121, v210, v211
  v_pk_fma_f32 v[212:213], v[40:41], v[58:59], v[212:213] op_sel_hi:[1,0,1]
  v_pk_fma_f32 v[214:215], v[42:43], v[58:59], v[214:215] op_sel_hi:[1,0,1]
  v_pk_mul_f32 v[212:213], v[212:213], v[90:91] op_sel_hi:[1,0]
  v_pk_mul_f32 v[214:215], v[214:215], v[90:91] op_sel_hi:[1,0]
  v_cvt_pk_bf16_f32 v122, v212, v213
  v_cvt_pk_bf16_f32 v123, v214, v215
  buffer_store_dwordx4 v[120:123], v22, s[32:35], s56 offen offset:512
  v_pk_fma_f32 v[240:241], v[44:45], v[56:57], v[240:241] op_sel_hi:[1,0,1]
  v_pk_fma_f32 v[242:243], v[46:47], v[56:57], v[242:243] op_sel_hi:[1,0,1]
  v_pk_mul_f32 v[240:241], v[240:241], v[88:89] op_sel_hi:[1,0]
  v_pk_mul_f32 v[242:243], v[242:243], v[88:89] op_sel_hi:[1,0]
  v_cvt_pk_bf16_f32 v124, v240, v241
  v_cvt_pk_bf16_f32 v125, v242, v243
  v_pk_fma_f32 v[244:245], v[44:45], v[58:59], v[244:245] op_sel_hi:[1,0,1]
  v_pk_fma_f32 v[246:247], v[46:47], v[58:59], v[246:247] op_sel_hi:[1,0,1]
  v_pk_mul_f32 v[244:245], v[244:245], v[90:91] op_sel_hi:[1,0]
  v_pk_mul_f32 v[246:247], v[246:247], v[90:91] op_sel_hi:[1,0]
  v_cvt_pk_bf16_f32 v126, v244, v245
  v_cvt_pk_bf16_f32 v127, v246, v247
  buffer_store_dwordx4 v[124:127], v23, s[32:35], s56 offen offset:512
  v_pk_fma_f32 v[152:153], v[32:33], v[60:61], v[152:153] op_sel_hi:[1,0,1]
  v_pk_fma_f32 v[154:155], v[34:35], v[60:61], v[154:155] op_sel_hi:[1,0,1]
  v_pk_mul_f32 v[152:153], v[152:153], v[92:93] op_sel_hi:[1,0]
  v_pk_mul_f32 v[154:155], v[154:155], v[92:93] op_sel_hi:[1,0]
  v_cvt_pk_bf16_f32 v112, v152, v153
  v_cvt_pk_bf16_f32 v113, v154, v155
  v_pk_fma_f32 v[156:157], v[32:33], v[62:63], v[156:157] op_sel_hi:[1,0,1]
  v_pk_fma_f32 v[158:159], v[34:35], v[62:63], v[158:159] op_sel_hi:[1,0,1]
  v_pk_mul_f32 v[156:157], v[156:157], v[94:95] op_sel_hi:[1,0]
  v_pk_mul_f32 v[158:159], v[158:159], v[94:95] op_sel_hi:[1,0]
  v_cvt_pk_bf16_f32 v114, v156, v157
  v_cvt_pk_bf16_f32 v115, v158, v159
  buffer_store_dwordx4 v[112:115], v20, s[32:35], s56 offen offset:768
  v_pk_fma_f32 v[184:185], v[36:37], v[60:61], v[184:185] op_sel_hi:[1,0,1]
  v_pk_fma_f32 v[186:187], v[38:39], v[60:61], v[186:187] op_sel_hi:[1,0,1]
  v_pk_mul_f32 v[184:185], v[184:185], v[92:93] op_sel_hi:[1,0]
  v_pk_mul_f32 v[186:187], v[186:187], v[92:93] op_sel_hi:[1,0]
  v_cvt_pk_bf16_f32 v116, v184, v185
  v_cvt_pk_bf16_f32 v117, v186, v187
  v_pk_fma_f32 v[188:189], v[36:37], v[62:63], v[188:189] op_sel_hi:[1,0,1]
  v_pk_fma_f32 v[190:191], v[38:39], v[62:63], v[190:191] op_sel_hi:[1,0,1]
  v_pk_mul_f32 v[188:189], v[188:189], v[94:95] op_sel_hi:[1,0]
  v_pk_mul_f32 v[190:191], v[190:191], v[94:95] op_sel_hi:[1,0]
  v_cvt_pk_bf16_f32 v118, v188, v189
  v_cvt_pk_bf16_f32 v119, v190, v191
  buffer_store_dwordx4 v[116:119], v21, s[32:35], s56 offen offset:768
  v_pk_fma_f32 v[216:217], v[40:41], v[60:61], v[216:217] op_sel_hi:[1,0,1]
  v_pk_fma_f32 v[218:219], v[42:43], v[60:61], v[218:219] op_sel_hi:[1,0,1]
  v_pk_mul_f32 v[216:217], v[216:217], v[92:93] op_sel_hi:[1,0]
  v_pk_mul_f32 v[218:219], v[218:219], v[92:93] op_sel_hi:[1,0]
  v_cvt_pk_bf16_f32 v120, v216, v217
  v_cvt_pk_bf16_f32 v121, v218, v219
  v_pk_fma_f32 v[220:221], v[40:41], v[62:63], v[220:221] op_sel_hi:[1,0,1]
  v_pk_fma_f32 v[222:223], v[42:43], v[62:63], v[222:223] op_sel_hi:[1,0,1]
  v_pk_mul_f32 v[220:221], v[220:221], v[94:95] op_sel_hi:[1,0]
  v_pk_mul_f32 v[222:223], v[222:223], v[94:95] op_sel_hi:[1,0]
  v_cvt_pk_bf16_f32 v122, v220, v221
  v_cvt_pk_bf16_f32 v123, v222, v223
  buffer_store_dwordx4 v[120:123], v22, s[32:35], s56 offen offset:768
  v_pk_fma_f32 v[248:249], v[44:45], v[60:61], v[248:249] op_sel_hi:[1,0,1]
  v_pk_fma_f32 v[250:251], v[46:47], v[60:61], v[250:251] op_sel_hi:[1,0,1]
  v_pk_mul_f32 v[248:249], v[248:249], v[92:93] op_sel_hi:[1,0]
  v_pk_mul_f32 v[250:251], v[250:251], v[92:93] op_sel_hi:[1,0]
  v_cvt_pk_bf16_f32 v124, v248, v249
  v_cvt_pk_bf16_f32 v125, v250, v251
  v_pk_fma_f32 v[252:253], v[44:45], v[62:63], v[252:253] op_sel_hi:[1,0,1]
  v_pk_fma_f32 v[254:255], v[46:47], v[62:63], v[254:255] op_sel_hi:[1,0,1]
  v_pk_mul_f32 v[252:253], v[252:253], v[94:95] op_sel_hi:[1,0]
  v_pk_mul_f32 v[254:255], v[254:255], v[94:95] op_sel_hi:[1,0]
  v_cvt_pk_bf16_f32 v126, v252, v253
  v_cvt_pk_bf16_f32 v127, v254, v255
  buffer_store_dwordx4 v[124:127], v23, s[32:35], s56 offen offset:768
  s_branch K1_FIN
K1_EPI_H:
  v_lshlrev_b32 v1, 4, v0
  s_lshl_b32 s3, s39, 4
  s_lshl_b32 s49, s37, 3
  s_add_u32 s3, s3, s49
  s_mul_i32 s3, s3, 48
  s_sub_u32 s49, s40, 15
  s_lshl_b32 s49, s49, 2
  s_add_u32 s3, s3, s49
  s_lshl_b32 s49, s38, 1
  s_add_u32 s3, s3, s49
  s_lshl_b32 s54, s3, 10
  v_pk_fma_f32 v[128:129], v[32:33], v[48:49], v[128:129] op_sel_hi:[1,0,1]
  v_pk_fma_f32 v[130:131], v[34:35], v[48:49], v[130:131] op_sel_hi:[1,0,1]
  v_cvt_pk_bf16_f32 v112, v128, v129
  v_cvt_pk_bf16_f32 v113, v130, v131
  v_pk_fma_f32 v[160:161], v[36:37], v[48:49], v[160:161] op_sel_hi:[1,0,1]
  v_pk_fma_f32 v[162:163], v[38:39], v[48:49], v[162:163] op_sel_hi:[1,0,1]
  v_cvt_pk_bf16_f32 v114, v160, v161
  v_cvt_pk_bf16_f32 v115, v162, v163
  v_pk_max_i16 v112, v112, 0
  v_pk_max_i16 v113, v113, 0
  v_pk_max_i16 v114, v114, 0
  v_pk_max_i16 v115, v115, 0
  buffer_store_dwordx4 v[112:115], v1, s[32:35], s54 offen offset:0
  v_pk_fma_f32 v[192:193], v[40:41], v[48:49], v[192:193] op_sel_hi:[1,0,1]
  v_pk_fma_f32 v[194:195], v[42:43], v[48:49], v[194:195] op_sel_hi:[1,0,1]
  v_cvt_pk_bf16_f32 v116, v192, v193
  v_cvt_pk_bf16_f32 v117, v194, v195
  v_pk_fma_f32 v[224:225], v[44:45], v[48:49], v[224:225] op_sel_hi:[1,0,1]
  v_pk_fma_f32 v[226:227], v[46:47], v[48:49], v[226:227] op_sel_hi:[1,0,1]
  v_cvt_pk_bf16_f32 v118, v224, v225
  v_cvt_pk_bf16_f32 v119, v226, v227
  v_pk_max_i16 v116, v116, 0
  v_pk_max_i16 v117, v117, 0
  v_pk_max_i16 v118, v118, 0
  v_pk_max_i16 v119, v119, 0
  buffer_store_dwordx4 v[116:119], v1, s[32:35], s54 offen offset:1024
  s_add_u32 s54, s54, 49152
  v_pk_fma_f32 v[132:133], v[32:33], v[50:51], v[132:133] op_sel_hi:[1,0,1]
  v_pk_fma_f32 v[134:135], v[34:35], v[50:51], v[134:135] op_sel_hi:[1,0,1]
  v_cvt_pk_bf16_f32 v120, v132, v133
  v_cvt_pk_bf16_f32 v121, v134, v135
  v_pk_fma_f32 v[164:165], v[36:37], v[50:51], v[164:165] op_sel_hi:[1,0,1]
  v_pk_fma_f32 v[166:167], v[38:39], v[50:51], v[166:167] op_sel_hi:[1,0,1]
  v_cvt_pk_bf16_f32 v122, v164, v165
  v_cvt_pk_bf16_f32 v123, v166, v167
  v_pk_max_i16 v120, v120, 0
  v_pk_max_i16 v121, v121, 0
  v_pk_max_i16 v122, v122, 0
  v_pk_max_i16 v123, v123, 0
  buffer_store_dwordx4 v[120:123], v1, s[32:35], s54 offen offset:0
  v_pk_fma_f32 v[196:197], v[40:41], v[50:51], v[196:197] op_sel_hi:[1,0,1]
  v_pk_fma_f32 v[198:199], v[42:43], v[50:51], v[198:199] op_sel_hi:[1,0,1]
  v_cvt_pk_bf16_f32 v124, v196, v197
  v_cvt_pk_bf16_f32 v125, v198, v199
  v_pk_fma_f32 v[228:229], v[44:45], v[50:51], v[228:229] op_sel_hi:[1,0,1]
  v_pk_fma_f32 v[230:231], v[46:47], v[50:51], v[230:231] op_sel_hi:[1,0,1]
  v_cvt_pk_bf16_f32 v126, v228, v229
  v_cvt_pk_bf16_f32 v127, v230, v231
  v_pk_max_i16 v124, v124, 0
  v_pk_max_i16 v125, v125, 0
  v_pk_max_i16 v126, v126, 0
  v_pk_max_i16 v127, v127, 0
  buffer_store_dwordx4 v[124:127], v1, s[32:35], s54 offen offset:1024
  s_add_u32 s54, s54, 49152
  v_pk_fma_f32 v[136:137], v[32:33], v[52:53], v[136:137] op_sel_hi:[1,0,1]
  v_pk_fma_f32 v[138:139], v[34:35], v[52:53], v[138:139] op_sel_hi:[1,0,1]
  v_cvt_pk_bf16_f32 v112, v136, v137
  v_cvt_pk_bf16_f32 v113, v138, v139
  v_pk_fma_f32 v[168:169], v[36:37], v[52:53], v[168:169] op_sel_hi:[1,0,1]
  v_pk_fma_f32 v[170:171], v[38:39], v[52:53], v[170:171] op_sel_hi:[1,0,1]
  v_cvt_pk_bf16_f32 v114, v168, v169
  v_cvt_pk_bf16_f32 v115, v170, v171
  v_pk_max_i16 v112, v112, 0
  v_pk_max_i16 v113, v113, 0
  v_pk_max_i16 v114, v114, 0
  v_pk_max_i16 v115, v115, 0
  buffer_store_dwordx4 v[112:115], v1, s[32:35], s54 offen offset:0
  v_pk_fma_f32 v[200:201], v[40:41], v[52:53], v[200:201] op_sel_hi:[1,0,1]
  v_pk_fma_f32 v[202:203], v[42:43], v[52:53], v[202:203] op_sel_hi:[1,0,1]
  v_cvt_pk_bf16_f32 v116, v200, v201
  v_cvt_pk_bf16_f32 v117, v202, v203
  v_pk_fma_f32 v[232:233], v[44:45], v[52:53], v[232:233] op_sel_hi:[1,0,1]
  v_pk_fma_f32 v[234:235], v[46:47], v[52:53], v[234:235] op_sel_hi:[1,0,1]
  v_cvt_pk_bf16_f32 v118, v232, v233
  v_cvt_pk_bf16_f32 v119, v234, v235
  v_pk_max_i16 v116, v116, 0
  v_pk_max_i16 v117, v117, 0
  v_pk_max_i16 v118, v118, 0
  v_pk_max_i16 v119, v119, 0
  buffer_store_dwordx4 v[116:119], v1, s[32:35], s54 offen offset:1024
  s_add_u32 s54, s54, 49152
  v_pk_fma_f32 v[140:141], v[32:33], v[54:55], v[140:141] op_sel_hi:[1,0,1]
  v_pk_fma_f32 v[142:143], v[34:35], v[54:55], v[142:143] op_sel_hi:[1,0,1]
  v_cvt_pk_bf16_f32 v120, v140, v141
  v_cvt_pk_bf16_f32 v121, v142, v143
  v_pk_fma_f32 v[172:173], v[36:37], v[54:55], v[172:173] op_sel_hi:[1,0,1]
  v_pk_fma_f32 v[174:175], v[38:39], v[54:55], v[174:175] op_sel_hi:[1,0,1]
  v_cvt_pk_bf16_f32 v122, v172, v173
  v_cvt_pk_bf16_f32 v123, v174, v175
  v_pk_max_i16 v120, v120, 0
  v_pk_max_i16 v121, v121, 0
  v_pk_max_i16 v122, v122, 0
  v_pk_max_i16 v123, v123, 0
  buffer_store_dwordx4 v[120:123], v1, s[32:35], s54 offen offset:0
  v_pk_fma_f32 v[204:205], v[40:41], v[54:55], v[204:205] op_sel_hi:[1,0,1]
  v_pk_fma_f32 v[206:207], v[42:43], v[54:55], v[206:207] op_sel_hi:[1,0,1]
  v_cvt_pk_bf16_f32 v124, v204, v205
  v_cvt_pk_bf16_f32 v125, v206, v207
  v_pk_fma_f32 v[236:237], v[44:45], v[54:55], v[236:237] op_sel_hi:[1,0,1]
  v_pk_fma_f32 v[238:239], v[46:47], v[54:55], v[238:239] op_sel_hi:[1,0,1]
  v_cvt_pk_bf16_f32 v126, v236, v237
  v_cvt_pk_bf16_f32 v127, v238, v239
  v_pk_max_i16 v124, v124, 0
  v_pk_max_i16 v125, v125, 0
  v_pk_max_i16 v126, v126, 0
  v_pk_max_i16 v127, v127, 0
  buffer_store_dwordx4 v[124:127], v1, s[32:35], s54 offen offset:1024
  s_add_u32 s54, s54, 49152
  v_pk_fma_f32 v[144:145], v[32:33], v[56:57], v[144:145] op_sel_hi:[1,0,1]
  v_pk_fma_f32 v[146:147], v[34:35], v[56:57], v[146:147] op_sel_hi:[1,0,1]
  v_cvt_pk_bf16_f32 v112, v144, v145
  v_cvt_pk_bf16_f32 v113, v146, v147
  v_pk_fma_f32 v[176:177], v[36:37], v[56:57], v[176:177] op_sel_hi:[1,0,1]
  v_pk_fma_f32 v[178:179], v[38:39], v[56:57], v[178:179] op_sel_hi:[1,0,1]
  v_cvt_pk_bf16_f32 v114, v176, v177
  v_cvt_pk_bf16_f32 v115, v178, v179
  v_pk_max_i16 v112, v112, 0
  v_pk_max_i16 v113, v113, 0
  v_pk_max_i16 v114, v114, 0
  v_pk_max_i16 v115, v115, 0
  buffer_store_dwordx4 v[112:115], v1, s[32:35], s54 offen offset:0
  v_pk_fma_f32 v[208:209], v[40:41], v[56:57], v[208:209] op_sel_hi:[1,0,1]
  v_pk_fma_f32 v[210:211], v[42:43], v[56:57], v[210:211] op_sel_hi:[1,0,1]
  v_cvt_pk_bf16_f32 v116, v208, v209
  v_cvt_pk_bf16_f32 v117, v210, v211
  v_pk_fma_f32 v[240:241], v[44:45], v[56:57], v[240:241] op_sel_hi:[1,0,1]
  v_pk_fma_f32 v[242:243], v[46:47], v[56:57], v[242:243] op_sel_hi:[1,0,1]
  v_cvt_pk_bf16_f32 v118, v240, v241
  v_cvt_pk_bf16_f32 v119, v242, v243
  v_pk_max_i16 v116, v116, 0
  v_pk_max_i16 v117, v117, 0
  v_pk_max_i16 v118, v118, 0
  v_pk_max_i16 v119, v119, 0
  buffer_store_dwordx4 v[116:119], v1, s[32:35], s54 offen offset:1024
  s_add_u32 s54, s54, 49152
  v_pk_fma_f32 v[148:149], v[32:33], v[58:59], v[148:149] op_sel_hi:[1,0,1]
  v_pk_fma_f32 v[150:151], v[34:35], v[58:59], v[150:151] op_sel_hi:[1,0,1]
  v_cvt_pk_bf16_f32 v120, v148, v149
  v_cvt_pk_bf16_f32 v121, v150, v151
  v_pk_fma_f32 v[180:181], v[36:37], v[58:59], v[180:181] op_sel_hi:[1,0,1]
  v_pk_fma_f32 v[182:183], v[38:39], v[58:59], v[182:183] op_sel_hi:[1,0,1]
  v_cvt_pk_bf16_f32 v122, v180, v181
  v_cvt_pk_bf16_f32 v123, v182, v183
  v_pk_max_i16 v120, v120, 0
  v_pk_max_i16 v121, v121, 0
  v_pk_max_i16 v122, v122, 0
  v_pk_max_i16 v123, v123, 0
  buffer_store_dwordx4 v[120:123], v1, s[32:35], s54 offen offset:0
  v_pk_fma_f32 v[212:213], v[40:41], v[58:59], v[212:213] op_sel_hi:[1,0,1]
  v_pk_fma_f32 v[214:215], v[42:43], v[58:59], v[214:215] op_sel_hi:[1,0,1]
  v_cvt_pk_bf16_f32 v124, v212, v213
  v_cvt_pk_bf16_f32 v125, v214, v215
  v_pk_fma_f32 v[244:245], v[44:45], v[58:59], v[244:245] op_sel_hi:[1,0,1]
  v_pk_fma_f32 v[246:247], v[46:47], v[58:59], v[246:247] op_sel_hi:[1,0,1]
  v_cvt_pk_bf16_f32 v126, v244, v245
  v_cvt_pk_bf16_f32 v127, v246, v247
  v_pk_max_i16 v124, v124, 0
  v_pk_max_i16 v125, v125, 0
  v_pk_max_i16 v126, v126, 0
  v_pk_max_i16 v127, v127, 0
  buffer_store_dwordx4 v[124:127], v1, s[32:35], s54 offen offset:1024
  s_add_u32 s54, s54, 49152
  v_pk_fma_f32 v[152:153], v[32:33], v[60:61], v[152:153] op_sel_hi:[1,0,1]
  v_pk_fma_f32 v[154:155], v[34:35], v[60:61], v[154:155] op_sel_hi:[1,0,1]
  v_cvt_pk_bf16_f32 v112, v152, v153
  v_cvt_pk_bf16_f32 v113, v154, v155
  v_pk_fma_f32 v[184:185], v[36:37], v[60:61], v[184:185] op_sel_hi:[1,0,1]
  v_pk_fma_f32 v[186:187], v[38:39], v[60:61], v[186:187] op_sel_hi:[1,0,1]
  v_cvt_pk_bf16_f32 v114, v184, v185
  v_cvt_pk_bf16_f32 v115, v186, v187
  v_pk_max_i16 v112, v112, 0
  v_pk_max_i16 v113, v113, 0
  v_pk_max_i16 v114, v114, 0
  v_pk_max_i16 v115, v115, 0
  buffer_store_dwordx4 v[112:115], v1, s[32:35], s54 offen offset:0
  v_pk_fma_f32 v[216:217], v[40:41], v[60:61], v[216:217] op_sel_hi:[1,0,1]
  v_pk_fma_f32 v[218:219], v[42:43], v[60:61], v[218:219] op_sel_hi:[1,0,1]
  v_cvt_pk_bf16_f32 v116, v216, v217
  v_cvt_pk_bf16_f32 v117, v218, v219
  v_pk_fma_f32 v[248:249], v[44:45], v[60:61], v[248:249] op_sel_hi:[1,0,1]
  v_pk_fma_f32 v[250:251], v[46:47], v[60:61], v[250:251] op_sel_hi:[1,0,1]
  v_cvt_pk_bf16_f32 v118, v248, v249
  v_cvt_pk_bf16_f32 v119, v250, v251
  v_pk_max_i16 v116, v116, 0
  v_pk_max_i16 v117, v117, 0
  v_pk_max_i16 v118, v118, 0
  v_pk_max_i16 v119, v119, 0
  buffer_store_dwordx4 v[116:119], v1, s[32:35], s54 offen offset:1024
  s_add_u32 s54, s54, 49152
  v_pk_fma_f32 v[156:157], v[32:33], v[62:63], v[156:157] op_sel_hi:[1,0,1]
  v_pk_fma_f32 v[158:159], v[34:35], v[62:63], v[158:159] op_sel_hi:[1,0,1]
  v_cvt_pk_bf16_f32 v120, v156, v157
  v_cvt_pk_bf16_f32 v121, v158, v159
  v_pk_fma_f32 v[188:189], v[36:37], v[62:63], v[188:189] op_sel_hi:[1,0,1]
  v_pk_fma_f32 v[190:191], v[38:39], v[62:63], v[190:191] op_sel_hi:[1,0,1]
  v_cvt_pk_bf16_f32 v122, v188, v189
  v_cvt_pk_bf16_f32 v123, v190, v191
  v_pk_max_i16 v120, v120, 0
  v_pk_max_i16 v121, v121, 0
  v_pk_max_i16 v122, v122, 0
  v_pk_max_i16 v123, v123, 0
  buffer_store_dwordx4 v[120:123], v1, s[32:35], s54 offen offset:0
  v_pk_fma_f32 v[220:221], v[40:41], v[62:63], v[220:221] op_sel_hi:[1,0,1]
  v_pk_fma_f32 v[222:223], v[42:43], v[62:63], v[222:223] op_sel_hi:[1,0,1]
  v_cvt_pk_bf16_f32 v124, v220, v221
  v_cvt_pk_bf16_f32 v125, v222, v223
  v_pk_fma_f32 v[252:253], v[44:45], v[62:63], v[252:253] op_sel_hi:[1,0,1]
  v_pk_fma_f32 v[254:255], v[46:47], v[62:63], v[254:255] op_sel_hi:[1,0,1]
  v_cvt_pk_bf16_f32 v126, v252, v253
  v_cvt_pk_bf16_f32 v127, v254, v255
  v_pk_max_i16 v124, v124, 0
  v_pk_max_i16 v125, v125, 0
  v_pk_max_i16 v126, v126, 0
  v_pk_max_i16 v127, v127, 0
  buffer_store_dwordx4 v[124:127], v1, s[32:35], s54 offen offset:1024
  s_branch K1_FIN
K1_MAIN_S:
  s_waitcnt lgkmcnt(0)
  s_barrier
  ds_read_b128 v[32:35], v8 offset:0
  ds_read_b64_tr_b16 v[64:65], v12 offset:0
  ds_read_b128 v[36:39], v8 offset:2048
  ds_read_b64_tr_b16 v[66:67], v12 offset:1024
  ds_read_b128 v[40:43], v8 offset:4096
  ds_read_b64_tr_b16 v[68:69], v13 offset:0
  ds_read_b128 v[44:47], v8 offset:6144
  ds_read_b64_tr_b16 v[70:71], v13 offset:1024
  ds_read_b128 v[48:51], v8 offset:8192
  ds_read_b64_tr_b16 v[72:73], v14 offset:0
  ds_read_b128 v[52:55], v8 offset:10240
  ds_read_b64_tr_b16 v[74:75], v14 offset:1024
  ds_read_b128 v[56:59], v8 offset:12288
  ds_read_b64_tr_b16 v[76:77], v15 offset:0
  ds_read_b128 v[60:63], v8 offset:14336
  ds_read_b64_tr_b16 v[78:79], v15 offset:1024
  s_waitcnt lgkmcnt(0)
  v_mfma_f32_16x16x32_bf16 v[128:131], v[32:35], v[64:67], v[128:131]
  ds_read_b128 v[80:83], v9 offset:0
  v_mfma_f32_16x16x32_bf16 v[160:163], v[32:35], v[68:71], v[160:163]
  v_mfma_f32_16x16x32_bf16 v[192:195], v[32:35], v[72:75], v[192:195]
  ds_read_b64_tr_b16 v[112:113], v12 offset:8192
  v_mfma_f32_16x16x32_bf16 v[224:227], v[32:35], v[76:79], v[224:227]
  v_mfma_f32_16x16x32_bf16 v[132:135], v[36:39], v[64:67], v[132:135]
  ds_read_b128 v[84:87], v9 offset:2048
  v_mfma_f32_16x16x32_bf16 v[164:167], v[36:39], v[68:71], v[164:167]
  v_mfma_f32_16x16x32_bf16 v[196:199], v[36:39], v[72:75], v[196:199]
  ds_read_b64_tr_b16 v[114:115], v12 offset:9216
  v_mfma_f32_16x16x32_bf16 v[228:231], v[36:39], v[76:79], v[228:231]
  v_mfma_f32_16x16x32_bf16 v[136:139], v[40:43], v[64:67], v[136:139]
  ds_read_b128 v[88:91], v9 offset:4096
  v_mfma_f32_16x16x32_bf16 v[168:171], v[40:43], v[68:71], v[168:171]
  v_mfma_f32_16x16x32_bf16 v[200:203], v[40:43], v[72:75], v[200:203]
  ds_read_b64_tr_b16 v[116:117], v13 offset:8192
  v_mfma_f32_16x16x32_bf16 v[232:235], v[40:43], v[76:79], v[232:235]
  v_mfma_f32_16x16x32_bf16 v[140:143], v[44:47], v[64:67], v[140:143]
  ds_read_b128 v[92:95], v9 offset:6144
  v_mfma_f32_16x16x32_bf16 v[172:175], v[44:47], v[68:71], v[172:175]
  v_mfma_f32_16x16x32_bf16 v[204:207], v[44:47], v[72:75], v[204:207]
  ds_read_b64_tr_b16 v[118:119], v13 offset:9216
  v_mfma_f32_16x16x32_bf16 v[236:239], v[44:47], v[76:79], v[236:239]
  v_mfma_f32_16x16x32_bf16 v[144:147], v[48:51], v[64:67], v[144:147]
  ds_read_b128 v[96:99], v9 offset:8192
  v_mfma_f32_16x16x32_bf16 v[176:179], v[48:51], v[68:71], v[176:179]
  v_mfma_f32_16x16x32_bf16 v[208:211], v[48:51], v[72:75], v[208:211]
  ds_read_b64_tr_b16 v[120:121], v14 offset:8192
  v_mfma_f32_16x16x32_bf16 v[240:243], v[48:51], v[76:79], v[240:243]
  v_mfma_f32_16x16x32_bf16 v[148:151], v[52:55], v[64:67], v[148:151]
  ds_read_b128 v[100:103], v9 offset:10240
  v_mfma_f32_16x16x32_bf16 v[180:183], v[52:55], v[68:71], v[180:183]
  v_mfma_f32_16x16x32_bf16 v[212:215], v[52:55], v[72:75], v[212:215]
  ds_read_b64_tr_b16 v[122:123], v14 offset:9216
  v_mfma_f32_16x16x32_bf16 v[244:247], v[52:55], v[76:79], v[244:247]
  v_mfma_f32_16x16x32_bf16 v[152:155], v[56:59], v[64:67], v[152:155]
  ds_read_b128 v[104:107], v9 offset:12288
  v_mfma_f32_16x16x32_bf16 v[184:187], v[56:59], v[68:71], v[184:187]
  v_mfma_f32_16x16x32_bf16 v[216:219], v[56:59], v[72:75], v[216:219]
  ds_read_b64_tr_b16 v[124:125], v15 offset:8192
  v_mfma_f32_16x16x32_bf16 v[248:251], v[56:59], v[76:79], v[248:251]
  v_mfma_f32_16x16x32_bf16 v[156:159], v[60:63], v[64:67], v[156:159]
  ds_read_b128 v[108:111], v9 offset:14336
  v_mfma_f32_16x16x32_bf16 v[188:191], v[60:63], v[68:71], v[188:191]
  v_mfma_f32_16x16x32_bf16 v[220:223], v[60:63], v[72:75], v[220:223]
  ds_read_b64_tr_b16 v[126:127], v15 offset:9216
  v_mfma_f32_16x16x32_bf16 v[252:255], v[60:63], v[76:79], v[252:255]
  s_waitcnt lgkmcnt(0)
  s_barrier
  s_waitcnt lgkmcnt(0)
  v_mfma_f32_16x16x32_bf16 v[128:131], v[80:83], v[112:115], v[128:131]
  ds_read_b128 v[32:35], v8 offset:49152
  v_mfma_f32_16x16x32_bf16 v[160:163], v[80:83], v[116:119], v[160:163]
  v_mfma_f32_16x16x32_bf16 v[192:195], v[80:83], v[120:123], v[192:195]
  ds_read_b64_tr_b16 v[64:65], v12 offset:49152
  v_mfma_f32_16x16x32_bf16 v[224:227], v[80:83], v[124:127], v[224:227]
  v_mfma_f32_16x16x32_bf16 v[132:135], v[84:87], v[112:115], v[132:135]
  ds_read_b128 v[36:39], v8 offset:51200
  v_mfma_f32_16x16x32_bf16 v[164:167], v[84:87], v[116:119], v[164:167]
  v_mfma_f32_16x16x32_bf16 v[196:199], v[84:87], v[120:123], v[196:199]
  ds_read_b64_tr_b16 v[66:67], v12 offset:50176
  v_mfma_f32_16x16x32_bf16 v[228:231], v[84:87], v[124:127], v[228:231]
  v_mfma_f32_16x16x32_bf16 v[136:139], v[88:91], v[112:115], v[136:139]
  ds_read_b128 v[40:43], v8 offset:53248
  v_mfma_f32_16x16x32_bf16 v[168:171], v[88:91], v[116:119], v[168:171]
  v_mfma_f32_16x16x32_bf16 v[200:203], v[88:91], v[120:123], v[200:203]
  ds_read_b64_tr_b16 v[68:69], v13 offset:49152
  v_mfma_f32_16x16x32_bf16 v[232:235], v[88:91], v[124:127], v[232:235]
  v_mfma_f32_16x16x32_bf16 v[140:143], v[92:95], v[112:115], v[140:143]
  ds_read_b128 v[44:47], v8 offset:55296
  v_mfma_f32_16x16x32_bf16 v[172:175], v[92:95], v[116:119], v[172:175]
  v_mfma_f32_16x16x32_bf16 v[204:207], v[92:95], v[120:123], v[204:207]
  ds_read_b64_tr_b16 v[70:71], v13 offset:50176
  v_mfma_f32_16x16x32_bf16 v[236:239], v[92:95], v[124:127], v[236:239]
  v_mfma_f32_16x16x32_bf16 v[144:147], v[96:99], v[112:115], v[144:147]
  ds_read_b128 v[48:51], v8 offset:57344
  v_mfma_f32_16x16x32_bf16 v[176:179], v[96:99], v[116:119], v[176:179]
  v_mfma_f32_16x16x32_bf16 v[208:211], v[96:99], v[120:123], v[208:211]
  ds_read_b64_tr_b16 v[72:73], v14 offset:49152
  v_mfma_f32_16x16x32_bf16 v[240:243], v[96:99], v[124:127], v[240:243]
  v_mfma_f32_16x16x32_bf16 v[148:151], v[100:103], v[112:115], v[148:151]
  ds_read_b128 v[52:55], v8 offset:59392
  v_mfma_f32_16x16x32_bf16 v[180:183], v[100:103], v[116:119], v[180:183]
  v_mfma_f32_16x16x32_bf16 v[212:215], v[100:103], v[120:123], v[212:215]
  ds_read_b64_tr_b16 v[74:75], v14 offset:50176
  v_mfma_f32_16x16x32_bf16 v[244:247], v[100:103], v[124:127], v[244:247]
  v_mfma_f32_16x16x32_bf16 v[152:155], v[104:107], v[112:115], v[152:155]
  ds_read_b128 v[56:59], v8 offset:61440
  v_mfma_f32_16x16x32_bf16 v[184:187], v[104:107], v[116:119], v[184:187]
  v_mfma_f32_16x16x32_bf16 v[216:219], v[104:107], v[120:123], v[216:219]
  ds_read_b64_tr_b16 v[76:77], v15 offset:49152
  v_mfma_f32_16x16x32_bf16 v[248:251], v[104:107], v[124:127], v[248:251]
  v_mfma_f32_16x16x32_bf16 v[156:159], v[108:111], v[112:115], v[156:159]
  ds_read_b128 v[60:63], v8 offset:63488
  v_mfma_f32_16x16x32_bf16 v[188:191], v[108:111], v[116:119], v[188:191]
  v_mfma_f32_16x16x32_bf16 v[220:223], v[108:111], v[120:123], v[220:223]
  ds_read_b64_tr_b16 v[78:79], v15 offset:50176
  v_mfma_f32_16x16x32_bf16 v[252:255], v[108:111], v[124:127], v[252:255]
  s_waitcnt lgkmcnt(0)
  v_mfma_f32_16x16x32_bf16 v[128:131], v[32:35], v[64:67], v[128:131]
  ds_read_b128 v[80:83], v9 offset:49152
  v_mfma_f32_16x16x32_bf16 v[160:163], v[32:35], v[68:71], v[160:163]
  v_mfma_f32_16x16x32_bf16 v[192:195], v[32:35], v[72:75], v[192:195]
  ds_read_b64_tr_b16 v[112:113], v12 offset:57344
  v_mfma_f32_16x16x32_bf16 v[224:227], v[32:35], v[76:79], v[224:227]
  v_mfma_f32_16x16x32_bf16 v[132:135], v[36:39], v[64:67], v[132:135]
  ds_read_b128 v[84:87], v9 offset:51200
  v_mfma_f32_16x16x32_bf16 v[164:167], v[36:39], v[68:71], v[164:167]
  v_mfma_f32_16x16x32_bf16 v[196:199], v[36:39], v[72:75], v[196:199]
  ds_read_b64_tr_b16 v[114:115], v12 offset:58368
  v_mfma_f32_16x16x32_bf16 v[228:231], v[36:39], v[76:79], v[228:231]
  v_mfma_f32_16x16x32_bf16 v[136:139], v[40:43], v[64:67], v[136:139]
  ds_read_b128 v[88:91], v9 offset:53248
  v_mfma_f32_16x16x32_bf16 v[168:171], v[40:43], v[68:71], v[168:171]
  v_mfma_f32_16x16x32_bf16 v[200:203], v[40:43], v[72:75], v[200:203]
  ds_read_b64_tr_b16 v[116:117], v13 offset:57344
  v_mfma_f32_16x16x32_bf16 v[232:235], v[40:43], v[76:79], v[232:235]
  v_mfma_f32_16x16x32_bf16 v[140:143], v[44:47], v[64:67], v[140:143]
  ds_read_b128 v[92:95], v9 offset:55296
  v_mfma_f32_16x16x32_bf16 v[172:175], v[44:47], v[68:71], v[172:175]
  v_mfma_f32_16x16x32_bf16 v[204:207], v[44:47], v[72:75], v[204:207]
  ds_read_b64_tr_b16 v[118:119], v13 offset:58368
  v_mfma_f32_16x16x32_bf16 v[236:239], v[44:47], v[76:79], v[236:239]
  v_mfma_f32_16x16x32_bf16 v[144:147], v[48:51], v[64:67], v[144:147]
  ds_read_b128 v[96:99], v9 offset:57344
  v_mfma_f32_16x16x32_bf16 v[176:179], v[48:51], v[68:71], v[176:179]
  v_mfma_f32_16x16x32_bf16 v[208:211], v[48:51], v[72:75], v[208:211]
  ds_read_b64_tr_b16 v[120:121], v14 offset:57344
  v_mfma_f32_16x16x32_bf16 v[240:243], v[48:51], v[76:79], v[240:243]
  v_mfma_f32_16x16x32_bf16 v[148:151], v[52:55], v[64:67], v[148:151]
  ds_read_b128 v[100:103], v9 offset:59392
  v_mfma_f32_16x16x32_bf16 v[180:183], v[52:55], v[68:71], v[180:183]
  v_mfma_f32_16x16x32_bf16 v[212:215], v[52:55], v[72:75], v[212:215]
  ds_read_b64_tr_b16 v[122:123], v14 offset:58368
  v_mfma_f32_16x16x32_bf16 v[244:247], v[52:55], v[76:79], v[244:247]
  v_mfma_f32_16x16x32_bf16 v[152:155], v[56:59], v[64:67], v[152:155]
  ds_read_b128 v[104:107], v9 offset:61440
  v_mfma_f32_16x16x32_bf16 v[184:187], v[56:59], v[68:71], v[184:187]
  v_mfma_f32_16x16x32_bf16 v[216:219], v[56:59], v[72:75], v[216:219]
  ds_read_b64_tr_b16 v[124:125], v15 offset:57344
  v_mfma_f32_16x16x32_bf16 v[248:251], v[56:59], v[76:79], v[248:251]
  v_mfma_f32_16x16x32_bf16 v[156:159], v[60:63], v[64:67], v[156:159]
  ds_read_b128 v[108:111], v9 offset:63488
  v_mfma_f32_16x16x32_bf16 v[188:191], v[60:63], v[68:71], v[188:191]
  v_mfma_f32_16x16x32_bf16 v[220:223], v[60:63], v[72:75], v[220:223]
  ds_read_b64_tr_b16 v[126:127], v15 offset:58368
  v_mfma_f32_16x16x32_bf16 v[252:255], v[60:63], v[76:79], v[252:255]
  s_waitcnt lgkmcnt(0)
  s_barrier
  s_waitcnt lgkmcnt(0)
  v_mfma_f32_16x16x32_bf16 v[128:131], v[80:83], v[112:115], v[128:131]
  ds_read_b128 v[32:35], v10 offset:0
  v_mfma_f32_16x16x32_bf16 v[160:163], v[80:83], v[116:119], v[160:163]
  v_mfma_f32_16x16x32_bf16 v[192:195], v[80:83], v[120:123], v[192:195]
  ds_read_b64_tr_b16 v[64:65], v16 offset:0
  v_mfma_f32_16x16x32_bf16 v[224:227], v[80:83], v[124:127], v[224:227]
  v_mfma_f32_16x16x32_bf16 v[132:135], v[84:87], v[112:115], v[132:135]
  ds_read_b128 v[36:39], v10 offset:2048
  v_mfma_f32_16x16x32_bf16 v[164:167], v[84:87], v[116:119], v[164:167]
  v_mfma_f32_16x16x32_bf16 v[196:199], v[84:87], v[120:123], v[196:199]
  ds_read_b64_tr_b16 v[66:67], v16 offset:1024
  v_mfma_f32_16x16x32_bf16 v[228:231], v[84:87], v[124:127], v[228:231]
  v_mfma_f32_16x16x32_bf16 v[136:139], v[88:91], v[112:115], v[136:139]
  ds_read_b128 v[40:43], v10 offset:4096
  v_mfma_f32_16x16x32_bf16 v[168:171], v[88:91], v[116:119], v[168:171]
  v_mfma_f32_16x16x32_bf16 v[200:203], v[88:91], v[120:123], v[200:203]
  ds_read_b64_tr_b16 v[68:69], v17 offset:0
  v_mfma_f32_16x16x32_bf16 v[232:235], v[88:91], v[124:127], v[232:235]
  v_mfma_f32_16x16x32_bf16 v[140:143], v[92:95], v[112:115], v[140:143]
  ds_read_b128 v[44:47], v10 offset:6144
  v_mfma_f32_16x16x32_bf16 v[172:175], v[92:95], v[116:119], v[172:175]
  v_mfma_f32_16x16x32_bf16 v[204:207], v[92:95], v[120:123], v[204:207]
  ds_read_b64_tr_b16 v[70:71], v17 offset:1024
  v_mfma_f32_16x16x32_bf16 v[236:239], v[92:95], v[124:127], v[236:239]
  v_mfma_f32_16x16x32_bf16 v[144:147], v[96:99], v[112:115], v[144:147]
  ds_read_b128 v[48:51], v10 offset:8192
  v_mfma_f32_16x16x32_bf16 v[176:179], v[96:99], v[116:119], v[176:179]
  v_mfma_f32_16x16x32_bf16 v[208:211], v[96:99], v[120:123], v[208:211]
  ds_read_b64_tr_b16 v[72:73], v18 offset:0
  v_mfma_f32_16x16x32_bf16 v[240:243], v[96:99], v[124:127], v[240:243]
  v_mfma_f32_16x16x32_bf16 v[148:151], v[100:103], v[112:115], v[148:151]
  ds_read_b128 v[52:55], v10 offset:10240
  v_mfma_f32_16x16x32_bf16 v[180:183], v[100:103], v[116:119], v[180:183]
  v_mfma_f32_16x16x32_bf16 v[212:215], v[100:103], v[120:123], v[212:215]
  ds_read_b64_tr_b16 v[74:75], v18 offset:1024
  v_mfma_f32_16x16x32_bf16 v[244:247], v[100:103], v[124:127], v[244:247]
  v_mfma_f32_16x16x32_bf16 v[152:155], v[104:107], v[112:115], v[152:155]
  ds_read_b128 v[56:59], v10 offset:12288
  v_mfma_f32_16x16x32_bf16 v[184:187], v[104:107], v[116:119], v[184:187]
  v_mfma_f32_16x16x32_bf16 v[216:219], v[104:107], v[120:123], v[216:219]
  ds_read_b64_tr_b16 v[76:77], v19 offset:0
  v_mfma_f32_16x16x32_bf16 v[248:251], v[104:107], v[124:127], v[248:251]
  v_mfma_f32_16x16x32_bf16 v[156:159], v[108:111], v[112:115], v[156:159]
  ds_read_b128 v[60:63], v10 offset:14336
  v_mfma_f32_16x16x32_bf16 v[188:191], v[108:111], v[116:119], v[188:191]
  v_mfma_f32_16x16x32_bf16 v[220:223], v[108:111], v[120:123], v[220:223]
  ds_read_b64_tr_b16 v[78:79], v19 offset:1024
  v_mfma_f32_16x16x32_bf16 v[252:255], v[108:111], v[124:127], v[252:255]
  s_waitcnt lgkmcnt(0)
  v_mfma_f32_16x16x32_bf16 v[128:131], v[32:35], v[64:67], v[128:131]
  ds_read_b128 v[80:83], v11 offset:0
  v_mfma_f32_16x16x32_bf16 v[160:163], v[32:35], v[68:71], v[160:163]
  v_mfma_f32_16x16x32_bf16 v[192:195], v[32:35], v[72:75], v[192:195]
  ds_read_b64_tr_b16 v[112:113], v16 offset:8192
  v_mfma_f32_16x16x32_bf16 v[224:227], v[32:35], v[76:79], v[224:227]
  v_mfma_f32_16x16x32_bf16 v[132:135], v[36:39], v[64:67], v[132:135]
  ds_read_b128 v[84:87], v11 offset:2048
  v_mfma_f32_16x16x32_bf16 v[164:167], v[36:39], v[68:71], v[164:167]
  v_mfma_f32_16x16x32_bf16 v[196:199], v[36:39], v[72:75], v[196:199]
  ds_read_b64_tr_b16 v[114:115], v16 offset:9216
  v_mfma_f32_16x16x32_bf16 v[228:231], v[36:39], v[76:79], v[228:231]
  v_mfma_f32_16x16x32_bf16 v[136:139], v[40:43], v[64:67], v[136:139]
  ds_read_b128 v[88:91], v11 offset:4096
  v_mfma_f32_16x16x32_bf16 v[168:171], v[40:43], v[68:71], v[168:171]
  v_mfma_f32_16x16x32_bf16 v[200:203], v[40:43], v[72:75], v[200:203]
  ds_read_b64_tr_b16 v[116:117], v17 offset:8192
  v_mfma_f32_16x16x32_bf16 v[232:235], v[40:43], v[76:79], v[232:235]
  v_mfma_f32_16x16x32_bf16 v[140:143], v[44:47], v[64:67], v[140:143]
  ds_read_b128 v[92:95], v11 offset:6144
  v_mfma_f32_16x16x32_bf16 v[172:175], v[44:47], v[68:71], v[172:175]
  v_mfma_f32_16x16x32_bf16 v[204:207], v[44:47], v[72:75], v[204:207]
  ds_read_b64_tr_b16 v[118:119], v17 offset:9216
  v_mfma_f32_16x16x32_bf16 v[236:239], v[44:47], v[76:79], v[236:239]
  v_mfma_f32_16x16x32_bf16 v[144:147], v[48:51], v[64:67], v[144:147]
  ds_read_b128 v[96:99], v11 offset:8192
  v_mfma_f32_16x16x32_bf16 v[176:179], v[48:51], v[68:71], v[176:179]
  v_mfma_f32_16x16x32_bf16 v[208:211], v[48:51], v[72:75], v[208:211]
  ds_read_b64_tr_b16 v[120:121], v18 offset:8192
  v_mfma_f32_16x16x32_bf16 v[240:243], v[48:51], v[76:79], v[240:243]
  v_mfma_f32_16x16x32_bf16 v[148:151], v[52:55], v[64:67], v[148:151]
  ds_read_b128 v[100:103], v11 offset:10240
  v_mfma_f32_16x16x32_bf16 v[180:183], v[52:55], v[68:71], v[180:183]
  v_mfma_f32_16x16x32_bf16 v[212:215], v[52:55], v[72:75], v[212:215]
  ds_read_b64_tr_b16 v[122:123], v18 offset:9216
  v_mfma_f32_16x16x32_bf16 v[244:247], v[52:55], v[76:79], v[244:247]
  v_mfma_f32_16x16x32_bf16 v[152:155], v[56:59], v[64:67], v[152:155]
  ds_read_b128 v[104:107], v11 offset:12288
  v_mfma_f32_16x16x32_bf16 v[184:187], v[56:59], v[68:71], v[184:187]
  v_mfma_f32_16x16x32_bf16 v[216:219], v[56:59], v[72:75], v[216:219]
  ds_read_b64_tr_b16 v[124:125], v19 offset:8192
  v_mfma_f32_16x16x32_bf16 v[248:251], v[56:59], v[76:79], v[248:251]
  v_mfma_f32_16x16x32_bf16 v[156:159], v[60:63], v[64:67], v[156:159]
  ds_read_b128 v[108:111], v11 offset:14336
  v_mfma_f32_16x16x32_bf16 v[188:191], v[60:63], v[68:71], v[188:191]
  v_mfma_f32_16x16x32_bf16 v[220:223], v[60:63], v[72:75], v[220:223]
  ds_read_b64_tr_b16 v[126:127], v19 offset:9216
  v_mfma_f32_16x16x32_bf16 v[252:255], v[60:63], v[76:79], v[252:255]
  s_waitcnt lgkmcnt(0)
  s_barrier
  s_waitcnt lgkmcnt(0)
  v_mfma_f32_16x16x32_bf16 v[128:131], v[80:83], v[112:115], v[128:131]
  ds_read_b128 v[32:35], v8 offset:0
  v_mfma_f32_16x16x32_bf16 v[160:163], v[80:83], v[116:119], v[160:163]
  v_mfma_f32_16x16x32_bf16 v[192:195], v[80:83], v[120:123], v[192:195]
  ds_read_b64_tr_b16 v[64:65], v12 offset:0
  v_mfma_f32_16x16x32_bf16 v[224:227], v[80:83], v[124:127], v[224:227]
  v_mfma_f32_16x16x32_bf16 v[132:135], v[84:87], v[112:115], v[132:135]
  ds_read_b128 v[36:39], v8 offset:2048
  v_mfma_f32_16x16x32_bf16 v[164:167], v[84:87], v[116:119], v[164:167]
  v_mfma_f32_16x16x32_bf16 v[196:199], v[84:87], v[120:123], v[196:199]
  ds_read_b64_tr_b16 v[66:67], v12 offset:1024
  v_mfma_f32_16x16x32_bf16 v[228:231], v[84:87], v[124:127], v[228:231]
  v_mfma_f32_16x16x32_bf16 v[136:139], v[88:91], v[112:115], v[136:139]
  ds_read_b128 v[40:43], v8 offset:4096
  v_mfma_f32_16x16x32_bf16 v[168:171], v[88:91], v[116:119], v[168:171]
  v_mfma_f32_16x16x32_bf16 v[200:203], v[88:91], v[120:123], v[200:203]
  ds_read_b64_tr_b16 v[68:69], v13 offset:0
  v_mfma_f32_16x16x32_bf16 v[232:235], v[88:91], v[124:127], v[232:235]
  v_mfma_f32_16x16x32_bf16 v[140:143], v[92:95], v[112:115], v[140:143]
  ds_read_b128 v[44:47], v8 offset:6144
  v_mfma_f32_16x16x32_bf16 v[172:175], v[92:95], v[116:119], v[172:175]
  v_mfma_f32_16x16x32_bf16 v[204:207], v[92:95], v[120:123], v[204:207]
  ds_read_b64_tr_b16 v[70:71], v13 offset:1024
  v_mfma_f32_16x16x32_bf16 v[236:239], v[92:95], v[124:127], v[236:239]
  v_mfma_f32_16x16x32_bf16 v[144:147], v[96:99], v[112:115], v[144:147]
  ds_read_b128 v[48:51], v8 offset:8192
  v_mfma_f32_16x16x32_bf16 v[176:179], v[96:99], v[116:119], v[176:179]
  v_mfma_f32_16x16x32_bf16 v[208:211], v[96:99], v[120:123], v[208:211]
  ds_read_b64_tr_b16 v[72:73], v14 offset:0
  v_mfma_f32_16x16x32_bf16 v[240:243], v[96:99], v[124:127], v[240:243]
  v_mfma_f32_16x16x32_bf16 v[148:151], v[100:103], v[112:115], v[148:151]
  ds_read_b128 v[52:55], v8 offset:10240
  v_mfma_f32_16x16x32_bf16 v[180:183], v[100:103], v[116:119], v[180:183]
  v_mfma_f32_16x16x32_bf16 v[212:215], v[100:103], v[120:123], v[212:215]
  ds_read_b64_tr_b16 v[74:75], v14 offset:1024
  v_mfma_f32_16x16x32_bf16 v[244:247], v[100:103], v[124:127], v[244:247]
  v_mfma_f32_16x16x32_bf16 v[152:155], v[104:107], v[112:115], v[152:155]
  ds_read_b128 v[56:59], v8 offset:12288
  v_mfma_f32_16x16x32_bf16 v[184:187], v[104:107], v[116:119], v[184:187]
  v_mfma_f32_16x16x32_bf16 v[216:219], v[104:107], v[120:123], v[216:219]
  ds_read_b64_tr_b16 v[76:77], v15 offset:0
  v_mfma_f32_16x16x32_bf16 v[248:251], v[104:107], v[124:127], v[248:251]
  v_mfma_f32_16x16x32_bf16 v[156:159], v[108:111], v[112:115], v[156:159]
  ds_read_b128 v[60:63], v8 offset:14336
  v_mfma_f32_16x16x32_bf16 v[188:191], v[108:111], v[116:119], v[188:191]
  v_mfma_f32_16x16x32_bf16 v[220:223], v[108:111], v[120:123], v[220:223]
  ds_read_b64_tr_b16 v[78:79], v15 offset:1024
  v_mfma_f32_16x16x32_bf16 v[252:255], v[108:111], v[124:127], v[252:255]
  s_waitcnt lgkmcnt(0)
  v_mfma_f32_16x16x32_bf16 v[128:131], v[32:35], v[64:67], v[128:131]
  ds_read_b128 v[80:83], v9 offset:0
  v_mfma_f32_16x16x32_bf16 v[160:163], v[32:35], v[68:71], v[160:163]
  v_mfma_f32_16x16x32_bf16 v[192:195], v[32:35], v[72:75], v[192:195]
  ds_read_b64_tr_b16 v[112:113], v12 offset:8192
  v_mfma_f32_16x16x32_bf16 v[224:227], v[32:35], v[76:79], v[224:227]
  v_mfma_f32_16x16x32_bf16 v[132:135], v[36:39], v[64:67], v[132:135]
  ds_read_b128 v[84:87], v9 offset:2048
  v_mfma_f32_16x16x32_bf16 v[164:167], v[36:39], v[68:71], v[164:167]
  v_mfma_f32_16x16x32_bf16 v[196:199], v[36:39], v[72:75], v[196:199]
  ds_read_b64_tr_b16 v[114:115], v12 offset:9216
  v_mfma_f32_16x16x32_bf16 v[228:231], v[36:39], v[76:79], v[228:231]
  v_mfma_f32_16x16x32_bf16 v[136:139], v[40:43], v[64:67], v[136:139]
  ds_read_b128 v[88:91], v9 offset:4096
  v_mfma_f32_16x16x32_bf16 v[168:171], v[40:43], v[68:71], v[168:171]
  v_mfma_f32_16x16x32_bf16 v[200:203], v[40:43], v[72:75], v[200:203]
  ds_read_b64_tr_b16 v[116:117], v13 offset:8192
  v_mfma_f32_16x16x32_bf16 v[232:235], v[40:43], v[76:79], v[232:235]
  v_mfma_f32_16x16x32_bf16 v[140:143], v[44:47], v[64:67], v[140:143]
  ds_read_b128 v[92:95], v9 offset:6144
  v_mfma_f32_16x16x32_bf16 v[172:175], v[44:47], v[68:71], v[172:175]
  v_mfma_f32_16x16x32_bf16 v[204:207], v[44:47], v[72:75], v[204:207]
  ds_read_b64_tr_b16 v[118:119], v13 offset:9216
  v_mfma_f32_16x16x32_bf16 v[236:239], v[44:47], v[76:79], v[236:239]
  v_mfma_f32_16x16x32_bf16 v[144:147], v[48:51], v[64:67], v[144:147]
  ds_read_b128 v[96:99], v9 offset:8192
  v_mfma_f32_16x16x32_bf16 v[176:179], v[48:51], v[68:71], v[176:179]
  v_mfma_f32_16x16x32_bf16 v[208:211], v[48:51], v[72:75], v[208:211]
  ds_read_b64_tr_b16 v[120:121], v14 offset:8192
  v_mfma_f32_16x16x32_bf16 v[240:243], v[48:51], v[76:79], v[240:243]
  v_mfma_f32_16x16x32_bf16 v[148:151], v[52:55], v[64:67], v[148:151]
  ds_read_b128 v[100:103], v9 offset:10240
  v_mfma_f32_16x16x32_bf16 v[180:183], v[52:55], v[68:71], v[180:183]
  v_mfma_f32_16x16x32_bf16 v[212:215], v[52:55], v[72:75], v[212:215]
  ds_read_b64_tr_b16 v[122:123], v14 offset:9216
  v_mfma_f32_16x16x32_bf16 v[244:247], v[52:55], v[76:79], v[244:247]
  v_mfma_f32_16x16x32_bf16 v[152:155], v[56:59], v[64:67], v[152:155]
  ds_read_b128 v[104:107], v9 offset:12288
  v_mfma_f32_16x16x32_bf16 v[184:187], v[56:59], v[68:71], v[184:187]
  v_mfma_f32_16x16x32_bf16 v[216:219], v[56:59], v[72:75], v[216:219]
  ds_read_b64_tr_b16 v[124:125], v15 offset:8192
  v_mfma_f32_16x16x32_bf16 v[248:251], v[56:59], v[76:79], v[248:251]
  v_mfma_f32_16x16x32_bf16 v[156:159], v[60:63], v[64:67], v[156:159]
  ds_read_b128 v[108:111], v9 offset:14336
  v_mfma_f32_16x16x32_bf16 v[188:191], v[60:63], v[68:71], v[188:191]
  v_mfma_f32_16x16x32_bf16 v[220:223], v[60:63], v[72:75], v[220:223]
  ds_read_b64_tr_b16 v[126:127], v15 offset:9216
  v_mfma_f32_16x16x32_bf16 v[252:255], v[60:63], v[76:79], v[252:255]
  s_waitcnt lgkmcnt(0)
  s_barrier
  s_waitcnt lgkmcnt(0)
  v_mfma_f32_16x16x32_bf16 v[128:131], v[80:83], v[112:115], v[128:131]
  ds_read_b128 v[32:35], v8 offset:49152
  v_mfma_f32_16x16x32_bf16 v[160:163], v[80:83], v[116:119], v[160:163]
  v_mfma_f32_16x16x32_bf16 v[192:195], v[80:83], v[120:123], v[192:195]
  ds_read_b64_tr_b16 v[64:65], v12 offset:49152
  v_mfma_f32_16x16x32_bf16 v[224:227], v[80:83], v[124:127], v[224:227]
  v_mfma_f32_16x16x32_bf16 v[132:135], v[84:87], v[112:115], v[132:135]
  ds_read_b128 v[36:39], v8 offset:51200
  v_mfma_f32_16x16x32_bf16 v[164:167], v[84:87], v[116:119], v[164:167]
  v_mfma_f32_16x16x32_bf16 v[196:199], v[84:87], v[120:123], v[196:199]
  ds_read_b64_tr_b16 v[66:67], v12 offset:50176
  v_mfma_f32_16x16x32_bf16 v[228:231], v[84:87], v[124:127], v[228:231]
  v_mfma_f32_16x16x32_bf16 v[136:139], v[88:91], v[112:115], v[136:139]
  ds_read_b128 v[40:43], v8 offset:53248
  v_mfma_f32_16x16x32_bf16 v[168:171], v[88:91], v[116:119], v[168:171]
  v_mfma_f32_16x16x32_bf16 v[200:203], v[88:91], v[120:123], v[200:203]
  ds_read_b64_tr_b16 v[68:69], v13 offset:49152
  v_mfma_f32_16x16x32_bf16 v[232:235], v[88:91], v[124:127], v[232:235]
  v_mfma_f32_16x16x32_bf16 v[140:143], v[92:95], v[112:115], v[140:143]
  ds_read_b128 v[44:47], v8 offset:55296
  v_mfma_f32_16x16x32_bf16 v[172:175], v[92:95], v[116:119], v[172:175]
  v_mfma_f32_16x16x32_bf16 v[204:207], v[92:95], v[120:123], v[204:207]
  ds_read_b64_tr_b16 v[70:71], v13 offset:50176
  v_mfma_f32_16x16x32_bf16 v[236:239], v[92:95], v[124:127], v[236:239]
  v_mfma_f32_16x16x32_bf16 v[144:147], v[96:99], v[112:115], v[144:147]
  ds_read_b128 v[48:51], v8 offset:57344
  v_mfma_f32_16x16x32_bf16 v[176:179], v[96:99], v[116:119], v[176:179]
  v_mfma_f32_16x16x32_bf16 v[208:211], v[96:99], v[120:123], v[208:211]
  ds_read_b64_tr_b16 v[72:73], v14 offset:49152
  v_mfma_f32_16x16x32_bf16 v[240:243], v[96:99], v[124:127], v[240:243]
  v_mfma_f32_16x16x32_bf16 v[148:151], v[100:103], v[112:115], v[148:151]
  ds_read_b128 v[52:55], v8 offset:59392
  v_mfma_f32_16x16x32_bf16 v[180:183], v[100:103], v[116:119], v[180:183]
  v_mfma_f32_16x16x32_bf16 v[212:215], v[100:103], v[120:123], v[212:215]
  ds_read_b64_tr_b16 v[74:75], v14 offset:50176
  v_mfma_f32_16x16x32_bf16 v[244:247], v[100:103], v[124:127], v[244:247]
  v_mfma_f32_16x16x32_bf16 v[152:155], v[104:107], v[112:115], v[152:155]
  ds_read_b128 v[56:59], v8 offset:61440
  v_mfma_f32_16x16x32_bf16 v[184:187], v[104:107], v[116:119], v[184:187]
  v_mfma_f32_16x16x32_bf16 v[216:219], v[104:107], v[120:123], v[216:219]
  ds_read_b64_tr_b16 v[76:77], v15 offset:49152
  v_mfma_f32_16x16x32_bf16 v[248:251], v[104:107], v[124:127], v[248:251]
  v_mfma_f32_16x16x32_bf16 v[156:159], v[108:111], v[112:115], v[156:159]
  ds_read_b128 v[60:63], v8 offset:63488
  v_mfma_f32_16x16x32_bf16 v[188:191], v[108:111], v[116:119], v[188:191]
  v_mfma_f32_16x16x32_bf16 v[220:223], v[108:111], v[120:123], v[220:223]
  ds_read_b64_tr_b16 v[78:79], v15 offset:50176
  v_mfma_f32_16x16x32_bf16 v[252:255], v[108:111], v[124:127], v[252:255]
  s_waitcnt lgkmcnt(0)
  v_mfma_f32_16x16x32_bf16 v[128:131], v[32:35], v[64:67], v[128:131]
  ds_read_b128 v[80:83], v9 offset:49152
  v_mfma_f32_16x16x32_bf16 v[160:163], v[32:35], v[68:71], v[160:163]
  v_mfma_f32_16x16x32_bf16 v[192:195], v[32:35], v[72:75], v[192:195]
  ds_read_b64_tr_b16 v[112:113], v12 offset:57344
  v_mfma_f32_16x16x32_bf16 v[224:227], v[32:35], v[76:79], v[224:227]
  v_mfma_f32_16x16x32_bf16 v[132:135], v[36:39], v[64:67], v[132:135]
  ds_read_b128 v[84:87], v9 offset:51200
  v_mfma_f32_16x16x32_bf16 v[164:167], v[36:39], v[68:71], v[164:167]
  v_mfma_f32_16x16x32_bf16 v[196:199], v[36:39], v[72:75], v[196:199]
  ds_read_b64_tr_b16 v[114:115], v12 offset:58368
  v_mfma_f32_16x16x32_bf16 v[228:231], v[36:39], v[76:79], v[228:231]
  v_mfma_f32_16x16x32_bf16 v[136:139], v[40:43], v[64:67], v[136:139]
  ds_read_b128 v[88:91], v9 offset:53248
  v_mfma_f32_16x16x32_bf16 v[168:171], v[40:43], v[68:71], v[168:171]
  v_mfma_f32_16x16x32_bf16 v[200:203], v[40:43], v[72:75], v[200:203]
  ds_read_b64_tr_b16 v[116:117], v13 offset:57344
  v_mfma_f32_16x16x32_bf16 v[232:235], v[40:43], v[76:79], v[232:235]
  v_mfma_f32_16x16x32_bf16 v[140:143], v[44:47], v[64:67], v[140:143]
  ds_read_b128 v[92:95], v9 offset:55296
  v_mfma_f32_16x16x32_bf16 v[172:175], v[44:47], v[68:71], v[172:175]
  v_mfma_f32_16x16x32_bf16 v[204:207], v[44:47], v[72:75], v[204:207]
  ds_read_b64_tr_b16 v[118:119], v13 offset:58368
  v_mfma_f32_16x16x32_bf16 v[236:239], v[44:47], v[76:79], v[236:239]
  v_mfma_f32_16x16x32_bf16 v[144:147], v[48:51], v[64:67], v[144:147]
  ds_read_b128 v[96:99], v9 offset:57344
  v_mfma_f32_16x16x32_bf16 v[176:179], v[48:51], v[68:71], v[176:179]
  v_mfma_f32_16x16x32_bf16 v[208:211], v[48:51], v[72:75], v[208:211]
  ds_read_b64_tr_b16 v[120:121], v14 offset:57344
  v_mfma_f32_16x16x32_bf16 v[240:243], v[48:51], v[76:79], v[240:243]
  v_mfma_f32_16x16x32_bf16 v[148:151], v[52:55], v[64:67], v[148:151]
  ds_read_b128 v[100:103], v9 offset:59392
  v_mfma_f32_16x16x32_bf16 v[180:183], v[52:55], v[68:71], v[180:183]
  v_mfma_f32_16x16x32_bf16 v[212:215], v[52:55], v[72:75], v[212:215]
  ds_read_b64_tr_b16 v[122:123], v14 offset:58368
  v_mfma_f32_16x16x32_bf16 v[244:247], v[52:55], v[76:79], v[244:247]
  v_mfma_f32_16x16x32_bf16 v[152:155], v[56:59], v[64:67], v[152:155]
  ds_read_b128 v[104:107], v9 offset:61440
  v_mfma_f32_16x16x32_bf16 v[184:187], v[56:59], v[68:71], v[184:187]
  v_mfma_f32_16x16x32_bf16 v[216:219], v[56:59], v[72:75], v[216:219]
  ds_read_b64_tr_b16 v[124:125], v15 offset:57344
  v_mfma_f32_16x16x32_bf16 v[248:251], v[56:59], v[76:79], v[248:251]
  v_mfma_f32_16x16x32_bf16 v[156:159], v[60:63], v[64:67], v[156:159]
  ds_read_b128 v[108:111], v9 offset:63488
  v_mfma_f32_16x16x32_bf16 v[188:191], v[60:63], v[68:71], v[188:191]
  v_mfma_f32_16x16x32_bf16 v[220:223], v[60:63], v[72:75], v[220:223]
  ds_read_b64_tr_b16 v[126:127], v15 offset:58368
  v_mfma_f32_16x16x32_bf16 v[252:255], v[60:63], v[76:79], v[252:255]
  s_waitcnt lgkmcnt(0)
  s_barrier
  s_waitcnt lgkmcnt(0)
  v_mfma_f32_16x16x32_bf16 v[128:131], v[80:83], v[112:115], v[128:131]
  ds_read_b128 v[32:35], v10 offset:0
  v_mfma_f32_16x16x32_bf16 v[160:163], v[80:83], v[116:119], v[160:163]
  v_mfma_f32_16x16x32_bf16 v[192:195], v[80:83], v[120:123], v[192:195]
  ds_read_b64_tr_b16 v[64:65], v16 offset:0
  v_mfma_f32_16x16x32_bf16 v[224:227], v[80:83], v[124:127], v[224:227]
  v_mfma_f32_16x16x32_bf16 v[132:135], v[84:87], v[112:115], v[132:135]
  ds_read_b128 v[36:39], v10 offset:2048
  v_mfma_f32_16x16x32_bf16 v[164:167], v[84:87], v[116:119], v[164:167]
  v_mfma_f32_16x16x32_bf16 v[196:199], v[84:87], v[120:123], v[196:199]
  ds_read_b64_tr_b16 v[66:67], v16 offset:1024
  v_mfma_f32_16x16x32_bf16 v[228:231], v[84:87], v[124:127], v[228:231]
  v_mfma_f32_16x16x32_bf16 v[136:139], v[88:91], v[112:115], v[136:139]
  ds_read_b128 v[40:43], v10 offset:4096
  v_mfma_f32_16x16x32_bf16 v[168:171], v[88:91], v[116:119], v[168:171]
  v_mfma_f32_16x16x32_bf16 v[200:203], v[88:91], v[120:123], v[200:203]
  ds_read_b64_tr_b16 v[68:69], v17 offset:0
  v_mfma_f32_16x16x32_bf16 v[232:235], v[88:91], v[124:127], v[232:235]
  v_mfma_f32_16x16x32_bf16 v[140:143], v[92:95], v[112:115], v[140:143]
  ds_read_b128 v[44:47], v10 offset:6144
  v_mfma_f32_16x16x32_bf16 v[172:175], v[92:95], v[116:119], v[172:175]
  v_mfma_f32_16x16x32_bf16 v[204:207], v[92:95], v[120:123], v[204:207]
  ds_read_b64_tr_b16 v[70:71], v17 offset:1024
  v_mfma_f32_16x16x32_bf16 v[236:239], v[92:95], v[124:127], v[236:239]
  v_mfma_f32_16x16x32_bf16 v[144:147], v[96:99], v[112:115], v[144:147]
  ds_read_b128 v[48:51], v10 offset:8192
  v_mfma_f32_16x16x32_bf16 v[176:179], v[96:99], v[116:119], v[176:179]
  v_mfma_f32_16x16x32_bf16 v[208:211], v[96:99], v[120:123], v[208:211]
  ds_read_b64_tr_b16 v[72:73], v18 offset:0
  v_mfma_f32_16x16x32_bf16 v[240:243], v[96:99], v[124:127], v[240:243]
  v_mfma_f32_16x16x32_bf16 v[148:151], v[100:103], v[112:115], v[148:151]
  ds_read_b128 v[52:55], v10 offset:10240
  v_mfma_f32_16x16x32_bf16 v[180:183], v[100:103], v[116:119], v[180:183]
  v_mfma_f32_16x16x32_bf16 v[212:215], v[100:103], v[120:123], v[212:215]
  ds_read_b64_tr_b16 v[74:75], v18 offset:1024
  v_mfma_f32_16x16x32_bf16 v[244:247], v[100:103], v[124:127], v[244:247]
  v_mfma_f32_16x16x32_bf16 v[152:155], v[104:107], v[112:115], v[152:155]
  ds_read_b128 v[56:59], v10 offset:12288
  v_mfma_f32_16x16x32_bf16 v[184:187], v[104:107], v[116:119], v[184:187]
  v_mfma_f32_16x16x32_bf16 v[216:219], v[104:107], v[120:123], v[216:219]
  ds_read_b64_tr_b16 v[76:77], v19 offset:0
  v_mfma_f32_16x16x32_bf16 v[248:251], v[104:107], v[124:127], v[248:251]
  v_mfma_f32_16x16x32_bf16 v[156:159], v[108:111], v[112:115], v[156:159]
  ds_read_b128 v[60:63], v10 offset:14336
  v_mfma_f32_16x16x32_bf16 v[188:191], v[108:111], v[116:119], v[188:191]
  v_mfma_f32_16x16x32_bf16 v[220:223], v[108:111], v[120:123], v[220:223]
  ds_read_b64_tr_b16 v[78:79], v19 offset:1024
  v_mfma_f32_16x16x32_bf16 v[252:255], v[108:111], v[124:127], v[252:255]
  s_waitcnt lgkmcnt(0)
  v_mfma_f32_16x16x32_bf16 v[128:131], v[32:35], v[64:67], v[128:131]
  ds_read_b128 v[80:83], v11 offset:0
  v_mfma_f32_16x16x32_bf16 v[160:163], v[32:35], v[68:71], v[160:163]
  v_mfma_f32_16x16x32_bf16 v[192:195], v[32:35], v[72:75], v[192:195]
  ds_read_b64_tr_b16 v[112:113], v16 offset:8192
  v_mfma_f32_16x16x32_bf16 v[224:227], v[32:35], v[76:79], v[224:227]
  v_mfma_f32_16x16x32_bf16 v[132:135], v[36:39], v[64:67], v[132:135]
  ds_read_b128 v[84:87], v11 offset:2048
  v_mfma_f32_16x16x32_bf16 v[164:167], v[36:39], v[68:71], v[164:167]
  v_mfma_f32_16x16x32_bf16 v[196:199], v[36:39], v[72:75], v[196:199]
  ds_read_b64_tr_b16 v[114:115], v16 offset:9216
  v_mfma_f32_16x16x32_bf16 v[228:231], v[36:39], v[76:79], v[228:231]
  v_mfma_f32_16x16x32_bf16 v[136:139], v[40:43], v[64:67], v[136:139]
  ds_read_b128 v[88:91], v11 offset:4096
  v_mfma_f32_16x16x32_bf16 v[168:171], v[40:43], v[68:71], v[168:171]
  v_mfma_f32_16x16x32_bf16 v[200:203], v[40:43], v[72:75], v[200:203]
  ds_read_b64_tr_b16 v[116:117], v17 offset:8192
  v_mfma_f32_16x16x32_bf16 v[232:235], v[40:43], v[76:79], v[232:235]
  v_mfma_f32_16x16x32_bf16 v[140:143], v[44:47], v[64:67], v[140:143]
  ds_read_b128 v[92:95], v11 offset:6144
  v_mfma_f32_16x16x32_bf16 v[172:175], v[44:47], v[68:71], v[172:175]
  v_mfma_f32_16x16x32_bf16 v[204:207], v[44:47], v[72:75], v[204:207]
  ds_read_b64_tr_b16 v[118:119], v17 offset:9216
  v_mfma_f32_16x16x32_bf16 v[236:239], v[44:47], v[76:79], v[236:239]
  v_mfma_f32_16x16x32_bf16 v[144:147], v[48:51], v[64:67], v[144:147]
  ds_read_b128 v[96:99], v11 offset:8192
  v_mfma_f32_16x16x32_bf16 v[176:179], v[48:51], v[68:71], v[176:179]
  v_mfma_f32_16x16x32_bf16 v[208:211], v[48:51], v[72:75], v[208:211]
  ds_read_b64_tr_b16 v[120:121], v18 offset:8192
  v_mfma_f32_16x16x32_bf16 v[240:243], v[48:51], v[76:79], v[240:243]
  v_mfma_f32_16x16x32_bf16 v[148:151], v[52:55], v[64:67], v[148:151]
  ds_read_b128 v[100:103], v11 offset:10240
  v_mfma_f32_16x16x32_bf16 v[180:183], v[52:55], v[68:71], v[180:183]
  v_mfma_f32_16x16x32_bf16 v[212:215], v[52:55], v[72:75], v[212:215]
  ds_read_b64_tr_b16 v[122:123], v18 offset:9216
  v_mfma_f32_16x16x32_bf16 v[244:247], v[52:55], v[76:79], v[244:247]
  v_mfma_f32_16x16x32_bf16 v[152:155], v[56:59], v[64:67], v[152:155]
  ds_read_b128 v[104:107], v11 offset:12288
  v_mfma_f32_16x16x32_bf16 v[184:187], v[56:59], v[68:71], v[184:187]
  v_mfma_f32_16x16x32_bf16 v[216:219], v[56:59], v[72:75], v[216:219]
  ds_read_b64_tr_b16 v[124:125], v19 offset:8192
  v_mfma_f32_16x16x32_bf16 v[248:251], v[56:59], v[76:79], v[248:251]
  v_mfma_f32_16x16x32_bf16 v[156:159], v[60:63], v[64:67], v[156:159]
  ds_read_b128 v[108:111], v11 offset:14336
  v_mfma_f32_16x16x32_bf16 v[188:191], v[60:63], v[68:71], v[188:191]
  v_mfma_f32_16x16x32_bf16 v[220:223], v[60:63], v[72:75], v[220:223]
  ds_read_b64_tr_b16 v[126:127], v19 offset:9216
  v_mfma_f32_16x16x32_bf16 v[252:255], v[60:63], v[76:79], v[252:255]
  s_waitcnt lgkmcnt(0)
  s_barrier
  s_waitcnt lgkmcnt(0)
  v_mfma_f32_16x16x32_bf16 v[128:131], v[80:83], v[112:115], v[128:131]
  ds_read_b128 v[32:35], v8 offset:0
  v_mfma_f32_16x16x32_bf16 v[160:163], v[80:83], v[116:119], v[160:163]
  v_mfma_f32_16x16x32_bf16 v[192:195], v[80:83], v[120:123], v[192:195]
  ds_read_b64_tr_b16 v[64:65], v12 offset:0
  v_mfma_f32_16x16x32_bf16 v[224:227], v[80:83], v[124:127], v[224:227]
  v_mfma_f32_16x16x32_bf16 v[132:135], v[84:87], v[112:115], v[132:135]
  ds_read_b128 v[36:39], v8 offset:2048
  v_mfma_f32_16x16x32_bf16 v[164:167], v[84:87], v[116:119], v[164:167]
  v_mfma_f32_16x16x32_bf16 v[196:199], v[84:87], v[120:123], v[196:199]
  ds_read_b64_tr_b16 v[66:67], v12 offset:1024
  v_mfma_f32_16x16x32_bf16 v[228:231], v[84:87], v[124:127], v[228:231]
  v_mfma_f32_16x16x32_bf16 v[136:139], v[88:91], v[112:115], v[136:139]
  ds_read_b128 v[40:43], v8 offset:4096
  v_mfma_f32_16x16x32_bf16 v[168:171], v[88:91], v[116:119], v[168:171]
  v_mfma_f32_16x16x32_bf16 v[200:203], v[88:91], v[120:123], v[200:203]
  ds_read_b64_tr_b16 v[68:69], v13 offset:0
  v_mfma_f32_16x16x32_bf16 v[232:235], v[88:91], v[124:127], v[232:235]
  v_mfma_f32_16x16x32_bf16 v[140:143], v[92:95], v[112:115], v[140:143]
  ds_read_b128 v[44:47], v8 offset:6144
  v_mfma_f32_16x16x32_bf16 v[172:175], v[92:95], v[116:119], v[172:175]
  v_mfma_f32_16x16x32_bf16 v[204:207], v[92:95], v[120:123], v[204:207]
  ds_read_b64_tr_b16 v[70:71], v13 offset:1024
  v_mfma_f32_16x16x32_bf16 v[236:239], v[92:95], v[124:127], v[236:239]
  v_mfma_f32_16x16x32_bf16 v[144:147], v[96:99], v[112:115], v[144:147]
  ds_read_b128 v[48:51], v8 offset:8192
  v_mfma_f32_16x16x32_bf16 v[176:179], v[96:99], v[116:119], v[176:179]
  v_mfma_f32_16x16x32_bf16 v[208:211], v[96:99], v[120:123], v[208:211]
  ds_read_b64_tr_b16 v[72:73], v14 offset:0
  v_mfma_f32_16x16x32_bf16 v[240:243], v[96:99], v[124:127], v[240:243]
  v_mfma_f32_16x16x32_bf16 v[148:151], v[100:103], v[112:115], v[148:151]
  ds_read_b128 v[52:55], v8 offset:10240
  v_mfma_f32_16x16x32_bf16 v[180:183], v[100:103], v[116:119], v[180:183]
  v_mfma_f32_16x16x32_bf16 v[212:215], v[100:103], v[120:123], v[212:215]
  ds_read_b64_tr_b16 v[74:75], v14 offset:1024
  v_mfma_f32_16x16x32_bf16 v[244:247], v[100:103], v[124:127], v[244:247]
  v_mfma_f32_16x16x32_bf16 v[152:155], v[104:107], v[112:115], v[152:155]
  ds_read_b128 v[56:59], v8 offset:12288
  v_mfma_f32_16x16x32_bf16 v[184:187], v[104:107], v[116:119], v[184:187]
  v_mfma_f32_16x16x32_bf16 v[216:219], v[104:107], v[120:123], v[216:219]
  ds_read_b64_tr_b16 v[76:77], v15 offset:0
  v_mfma_f32_16x16x32_bf16 v[248:251], v[104:107], v[124:127], v[248:251]
  v_mfma_f32_16x16x32_bf16 v[156:159], v[108:111], v[112:115], v[156:159]
  ds_read_b128 v[60:63], v8 offset:14336
  v_mfma_f32_16x16x32_bf16 v[188:191], v[108:111], v[116:119], v[188:191]
  v_mfma_f32_16x16x32_bf16 v[220:223], v[108:111], v[120:123], v[220:223]
  ds_read_b64_tr_b16 v[78:79], v15 offset:1024
  v_mfma_f32_16x16x32_bf16 v[252:255], v[108:111], v[124:127], v[252:255]
  s_waitcnt lgkmcnt(0)
  v_mfma_f32_16x16x32_bf16 v[128:131], v[32:35], v[64:67], v[128:131]
  ds_read_b128 v[80:83], v9 offset:0
  v_mfma_f32_16x16x32_bf16 v[160:163], v[32:35], v[68:71], v[160:163]
  v_mfma_f32_16x16x32_bf16 v[192:195], v[32:35], v[72:75], v[192:195]
  ds_read_b64_tr_b16 v[112:113], v12 offset:8192
  v_mfma_f32_16x16x32_bf16 v[224:227], v[32:35], v[76:79], v[224:227]
  v_mfma_f32_16x16x32_bf16 v[132:135], v[36:39], v[64:67], v[132:135]
  ds_read_b128 v[84:87], v9 offset:2048
  v_mfma_f32_16x16x32_bf16 v[164:167], v[36:39], v[68:71], v[164:167]
  v_mfma_f32_16x16x32_bf16 v[196:199], v[36:39], v[72:75], v[196:199]
  ds_read_b64_tr_b16 v[114:115], v12 offset:9216
  v_mfma_f32_16x16x32_bf16 v[228:231], v[36:39], v[76:79], v[228:231]
  v_mfma_f32_16x16x32_bf16 v[136:139], v[40:43], v[64:67], v[136:139]
  ds_read_b128 v[88:91], v9 offset:4096
  v_mfma_f32_16x16x32_bf16 v[168:171], v[40:43], v[68:71], v[168:171]
  v_mfma_f32_16x16x32_bf16 v[200:203], v[40:43], v[72:75], v[200:203]
  ds_read_b64_tr_b16 v[116:117], v13 offset:8192
  v_mfma_f32_16x16x32_bf16 v[232:235], v[40:43], v[76:79], v[232:235]
  v_mfma_f32_16x16x32_bf16 v[140:143], v[44:47], v[64:67], v[140:143]
  ds_read_b128 v[92:95], v9 offset:6144
  v_mfma_f32_16x16x32_bf16 v[172:175], v[44:47], v[68:71], v[172:175]
  v_mfma_f32_16x16x32_bf16 v[204:207], v[44:47], v[72:75], v[204:207]
  ds_read_b64_tr_b16 v[118:119], v13 offset:9216
  v_mfma_f32_16x16x32_bf16 v[236:239], v[44:47], v[76:79], v[236:239]
  v_mfma_f32_16x16x32_bf16 v[144:147], v[48:51], v[64:67], v[144:147]
  ds_read_b128 v[96:99], v9 offset:8192
  v_mfma_f32_16x16x32_bf16 v[176:179], v[48:51], v[68:71], v[176:179]
  v_mfma_f32_16x16x32_bf16 v[208:211], v[48:51], v[72:75], v[208:211]
  ds_read_b64_tr_b16 v[120:121], v14 offset:8192
  v_mfma_f32_16x16x32_bf16 v[240:243], v[48:51], v[76:79], v[240:243]
  v_mfma_f32_16x16x32_bf16 v[148:151], v[52:55], v[64:67], v[148:151]
  ds_read_b128 v[100:103], v9 offset:10240
  v_mfma_f32_16x16x32_bf16 v[180:183], v[52:55], v[68:71], v[180:183]
  v_mfma_f32_16x16x32_bf16 v[212:215], v[52:55], v[72:75], v[212:215]
  ds_read_b64_tr_b16 v[122:123], v14 offset:9216
  v_mfma_f32_16x16x32_bf16 v[244:247], v[52:55], v[76:79], v[244:247]
  v_mfma_f32_16x16x32_bf16 v[152:155], v[56:59], v[64:67], v[152:155]
  ds_read_b128 v[104:107], v9 offset:12288
  v_mfma_f32_16x16x32_bf16 v[184:187], v[56:59], v[68:71], v[184:187]
  v_mfma_f32_16x16x32_bf16 v[216:219], v[56:59], v[72:75], v[216:219]
  ds_read_b64_tr_b16 v[124:125], v15 offset:8192
  v_mfma_f32_16x16x32_bf16 v[248:251], v[56:59], v[76:79], v[248:251]
  v_mfma_f32_16x16x32_bf16 v[156:159], v[60:63], v[64:67], v[156:159]
  ds_read_b128 v[108:111], v9 offset:14336
  v_mfma_f32_16x16x32_bf16 v[188:191], v[60:63], v[68:71], v[188:191]
  v_mfma_f32_16x16x32_bf16 v[220:223], v[60:63], v[72:75], v[220:223]
  ds_read_b64_tr_b16 v[126:127], v15 offset:9216
  v_mfma_f32_16x16x32_bf16 v[252:255], v[60:63], v[76:79], v[252:255]
  s_waitcnt lgkmcnt(0)
  s_barrier
  s_waitcnt lgkmcnt(0)
  v_mfma_f32_16x16x32_bf16 v[128:131], v[80:83], v[112:115], v[128:131]
  ds_read_b128 v[32:35], v8 offset:49152
  v_mfma_f32_16x16x32_bf16 v[160:163], v[80:83], v[116:119], v[160:163]
  v_mfma_f32_16x16x32_bf16 v[192:195], v[80:83], v[120:123], v[192:195]
  ds_read_b64_tr_b16 v[64:65], v12 offset:49152
  v_mfma_f32_16x16x32_bf16 v[224:227], v[80:83], v[124:127], v[224:227]
  v_mfma_f32_16x16x32_bf16 v[132:135], v[84:87], v[112:115], v[132:135]
  ds_read_b128 v[36:39], v8 offset:51200
  v_mfma_f32_16x16x32_bf16 v[164:167], v[84:87], v[116:119], v[164:167]
  v_mfma_f32_16x16x32_bf16 v[196:199], v[84:87], v[120:123], v[196:199]
  ds_read_b64_tr_b16 v[66:67], v12 offset:50176
  v_mfma_f32_16x16x32_bf16 v[228:231], v[84:87], v[124:127], v[228:231]
  v_mfma_f32_16x16x32_bf16 v[136:139], v[88:91], v[112:115], v[136:139]
  ds_read_b128 v[40:43], v8 offset:53248
  v_mfma_f32_16x16x32_bf16 v[168:171], v[88:91], v[116:119], v[168:171]
  v_mfma_f32_16x16x32_bf16 v[200:203], v[88:91], v[120:123], v[200:203]
  ds_read_b64_tr_b16 v[68:69], v13 offset:49152
  v_mfma_f32_16x16x32_bf16 v[232:235], v[88:91], v[124:127], v[232:235]
  v_mfma_f32_16x16x32_bf16 v[140:143], v[92:95], v[112:115], v[140:143]
  ds_read_b128 v[44:47], v8 offset:55296
  v_mfma_f32_16x16x32_bf16 v[172:175], v[92:95], v[116:119], v[172:175]
  v_mfma_f32_16x16x32_bf16 v[204:207], v[92:95], v[120:123], v[204:207]
  ds_read_b64_tr_b16 v[70:71], v13 offset:50176
  v_mfma_f32_16x16x32_bf16 v[236:239], v[92:95], v[124:127], v[236:239]
  v_mfma_f32_16x16x32_bf16 v[144:147], v[96:99], v[112:115], v[144:147]
  ds_read_b128 v[48:51], v8 offset:57344
  v_mfma_f32_16x16x32_bf16 v[176:179], v[96:99], v[116:119], v[176:179]
  v_mfma_f32_16x16x32_bf16 v[208:211], v[96:99], v[120:123], v[208:211]
  ds_read_b64_tr_b16 v[72:73], v14 offset:49152
  v_mfma_f32_16x16x32_bf16 v[240:243], v[96:99], v[124:127], v[240:243]
  v_mfma_f32_16x16x32_bf16 v[148:151], v[100:103], v[112:115], v[148:151]
  ds_read_b128 v[52:55], v8 offset:59392
  v_mfma_f32_16x16x32_bf16 v[180:183], v[100:103], v[116:119], v[180:183]
  v_mfma_f32_16x16x32_bf16 v[212:215], v[100:103], v[120:123], v[212:215]
  ds_read_b64_tr_b16 v[74:75], v14 offset:50176
  v_mfma_f32_16x16x32_bf16 v[244:247], v[100:103], v[124:127], v[244:247]
  v_mfma_f32_16x16x32_bf16 v[152:155], v[104:107], v[112:115], v[152:155]
  ds_read_b128 v[56:59], v8 offset:61440
  v_mfma_f32_16x16x32_bf16 v[184:187], v[104:107], v[116:119], v[184:187]
  v_mfma_f32_16x16x32_bf16 v[216:219], v[104:107], v[120:123], v[216:219]
  ds_read_b64_tr_b16 v[76:77], v15 offset:49152
  v_mfma_f32_16x16x32_bf16 v[248:251], v[104:107], v[124:127], v[248:251]
  v_mfma_f32_16x16x32_bf16 v[156:159], v[108:111], v[112:115], v[156:159]
  ds_read_b128 v[60:63], v8 offset:63488
  v_mfma_f32_16x16x32_bf16 v[188:191], v[108:111], v[116:119], v[188:191]
  v_mfma_f32_16x16x32_bf16 v[220:223], v[108:111], v[120:123], v[220:223]
  ds_read_b64_tr_b16 v[78:79], v15 offset:50176
  v_mfma_f32_16x16x32_bf16 v[252:255], v[108:111], v[124:127], v[252:255]
  s_waitcnt lgkmcnt(0)
  v_mfma_f32_16x16x32_bf16 v[128:131], v[32:35], v[64:67], v[128:131]
  ds_read_b128 v[80:83], v9 offset:49152
  v_mfma_f32_16x16x32_bf16 v[160:163], v[32:35], v[68:71], v[160:163]
  v_mfma_f32_16x16x32_bf16 v[192:195], v[32:35], v[72:75], v[192:195]
  ds_read_b64_tr_b16 v[112:113], v12 offset:57344
  v_mfma_f32_16x16x32_bf16 v[224:227], v[32:35], v[76:79], v[224:227]
  v_mfma_f32_16x16x32_bf16 v[132:135], v[36:39], v[64:67], v[132:135]
  ds_read_b128 v[84:87], v9 offset:51200
  v_mfma_f32_16x16x32_bf16 v[164:167], v[36:39], v[68:71], v[164:167]
  v_mfma_f32_16x16x32_bf16 v[196:199], v[36:39], v[72:75], v[196:199]
  ds_read_b64_tr_b16 v[114:115], v12 offset:58368
  v_mfma_f32_16x16x32_bf16 v[228:231], v[36:39], v[76:79], v[228:231]
  v_mfma_f32_16x16x32_bf16 v[136:139], v[40:43], v[64:67], v[136:139]
  ds_read_b128 v[88:91], v9 offset:53248
  v_mfma_f32_16x16x32_bf16 v[168:171], v[40:43], v[68:71], v[168:171]
  v_mfma_f32_16x16x32_bf16 v[200:203], v[40:43], v[72:75], v[200:203]
  ds_read_b64_tr_b16 v[116:117], v13 offset:57344
  v_mfma_f32_16x16x32_bf16 v[232:235], v[40:43], v[76:79], v[232:235]
  v_mfma_f32_16x16x32_bf16 v[140:143], v[44:47], v[64:67], v[140:143]
  ds_read_b128 v[92:95], v9 offset:55296
  v_mfma_f32_16x16x32_bf16 v[172:175], v[44:47], v[68:71], v[172:175]
  v_mfma_f32_16x16x32_bf16 v[204:207], v[44:47], v[72:75], v[204:207]
  ds_read_b64_tr_b16 v[118:119], v13 offset:58368
  v_mfma_f32_16x16x32_bf16 v[236:239], v[44:47], v[76:79], v[236:239]
  v_mfma_f32_16x16x32_bf16 v[144:147], v[48:51], v[64:67], v[144:147]
  ds_read_b128 v[96:99], v9 offset:57344
  v_mfma_f32_16x16x32_bf16 v[176:179], v[48:51], v[68:71], v[176:179]
  v_mfma_f32_16x16x32_bf16 v[208:211], v[48:51], v[72:75], v[208:211]
  ds_read_b64_tr_b16 v[120:121], v14 offset:57344
  v_mfma_f32_16x16x32_bf16 v[240:243], v[48:51], v[76:79], v[240:243]
  v_mfma_f32_16x16x32_bf16 v[148:151], v[52:55], v[64:67], v[148:151]
  ds_read_b128 v[100:103], v9 offset:59392
  v_mfma_f32_16x16x32_bf16 v[180:183], v[52:55], v[68:71], v[180:183]
  v_mfma_f32_16x16x32_bf16 v[212:215], v[52:55], v[72:75], v[212:215]
  ds_read_b64_tr_b16 v[122:123], v14 offset:58368
  v_mfma_f32_16x16x32_bf16 v[244:247], v[52:55], v[76:79], v[244:247]
  v_mfma_f32_16x16x32_bf16 v[152:155], v[56:59], v[64:67], v[152:155]
  ds_read_b128 v[104:107], v9 offset:61440
  v_mfma_f32_16x16x32_bf16 v[184:187], v[56:59], v[68:71], v[184:187]
  v_mfma_f32_16x16x32_bf16 v[216:219], v[56:59], v[72:75], v[216:219]
  ds_read_b64_tr_b16 v[124:125], v15 offset:57344
  v_mfma_f32_16x16x32_bf16 v[248:251], v[56:59], v[76:79], v[248:251]
  v_mfma_f32_16x16x32_bf16 v[156:159], v[60:63], v[64:67], v[156:159]
  ds_read_b128 v[108:111], v9 offset:63488
  v_mfma_f32_16x16x32_bf16 v[188:191], v[60:63], v[68:71], v[188:191]
  v_mfma_f32_16x16x32_bf16 v[220:223], v[60:63], v[72:75], v[220:223]
  ds_read_b64_tr_b16 v[126:127], v15 offset:58368
  v_mfma_f32_16x16x32_bf16 v[252:255], v[60:63], v[76:79], v[252:255]
  s_waitcnt lgkmcnt(0)
  s_barrier
  v_mov_b32 v3, 147456
  ds_read_b32 v4, v3
  s_waitcnt lgkmcnt(0)
  v_mfma_f32_16x16x32_bf16 v[128:131], v[80:83], v[112:115], v[128:131]
  ds_read_b128 v[32:35], v10 offset:0
  v_mfma_f32_16x16x32_bf16 v[160:163], v[80:83], v[116:119], v[160:163]
  v_mfma_f32_16x16x32_bf16 v[192:195], v[80:83], v[120:123], v[192:195]
  ds_read_b64_tr_b16 v[64:65], v16 offset:0
  v_mfma_f32_16x16x32_bf16 v[224:227], v[80:83], v[124:127], v[224:227]
  v_mfma_f32_16x16x32_bf16 v[132:135], v[84:87], v[112:115], v[132:135]
  ds_read_b128 v[36:39], v10 offset:2048
  v_mfma_f32_16x16x32_bf16 v[164:167], v[84:87], v[116:119], v[164:167]
  v_mfma_f32_16x16x32_bf16 v[196:199], v[84:87], v[120:123], v[196:199]
  ds_read_b64_tr_b16 v[66:67], v16 offset:1024
  v_mfma_f32_16x16x32_bf16 v[228:231], v[84:87], v[124:127], v[228:231]
  v_mfma_f32_16x16x32_bf16 v[136:139], v[88:91], v[112:115], v[136:139]
  ds_read_b128 v[40:43], v10 offset:4096
  v_mfma_f32_16x16x32_bf16 v[168:171], v[88:91], v[116:119], v[168:171]
  v_mfma_f32_16x16x32_bf16 v[200:203], v[88:91], v[120:123], v[200:203]
  ds_read_b64_tr_b16 v[68:69], v17 offset:0
  v_mfma_f32_16x16x32_bf16 v[232:235], v[88:91], v[124:127], v[232:235]
  v_mfma_f32_16x16x32_bf16 v[140:143], v[92:95], v[112:115], v[140:143]
  ds_read_b128 v[44:47], v10 offset:6144
  v_mfma_f32_16x16x32_bf16 v[172:175], v[92:95], v[116:119], v[172:175]
  v_mfma_f32_16x16x32_bf16 v[204:207], v[92:95], v[120:123], v[204:207]
  ds_read_b64_tr_b16 v[70:71], v17 offset:1024
  v_mfma_f32_16x16x32_bf16 v[236:239], v[92:95], v[124:127], v[236:239]
  v_mfma_f32_16x16x32_bf16 v[144:147], v[96:99], v[112:115], v[144:147]
  ds_read_b128 v[48:51], v10 offset:8192
  v_mfma_f32_16x16x32_bf16 v[176:179], v[96:99], v[116:119], v[176:179]
  v_mfma_f32_16x16x32_bf16 v[208:211], v[96:99], v[120:123], v[208:211]
  ds_read_b64_tr_b16 v[72:73], v18 offset:0
  v_mfma_f32_16x16x32_bf16 v[240:243], v[96:99], v[124:127], v[240:243]
  v_mfma_f32_16x16x32_bf16 v[148:151], v[100:103], v[112:115], v[148:151]
  ds_read_b128 v[52:55], v10 offset:10240
  v_mfma_f32_16x16x32_bf16 v[180:183], v[100:103], v[116:119], v[180:183]
  v_mfma_f32_16x16x32_bf16 v[212:215], v[100:103], v[120:123], v[212:215]
  ds_read_b64_tr_b16 v[74:75], v18 offset:1024
  v_mfma_f32_16x16x32_bf16 v[244:247], v[100:103], v[124:127], v[244:247]
  v_mfma_f32_16x16x32_bf16 v[152:155], v[104:107], v[112:115], v[152:155]
  ds_read_b128 v[56:59], v10 offset:12288
  v_mfma_f32_16x16x32_bf16 v[184:187], v[104:107], v[116:119], v[184:187]
  v_mfma_f32_16x16x32_bf16 v[216:219], v[104:107], v[120:123], v[216:219]
  ds_read_b64_tr_b16 v[76:77], v19 offset:0
  v_mfma_f32_16x16x32_bf16 v[248:251], v[104:107], v[124:127], v[248:251]
  v_mfma_f32_16x16x32_bf16 v[156:159], v[108:111], v[112:115], v[156:159]
  ds_read_b128 v[60:63], v10 offset:14336
  v_mfma_f32_16x16x32_bf16 v[188:191], v[108:111], v[116:119], v[188:191]
  v_mfma_f32_16x16x32_bf16 v[220:223], v[108:111], v[120:123], v[220:223]
  ds_read_b64_tr_b16 v[78:79], v19 offset:1024
  v_mfma_f32_16x16x32_bf16 v[252:255], v[108:111], v[124:127], v[252:255]
  v_readfirstlane_b32 s47, v4
  s_waitcnt lgkmcnt(0)
  v_mfma_f32_16x16x32_bf16 v[128:131], v[32:35], v[64:67], v[128:131]
  ds_read_b128 v[80:83], v11 offset:0
  v_mfma_f32_16x16x32_bf16 v[160:163], v[32:35], v[68:71], v[160:163]
  v_mfma_f32_16x16x32_bf16 v[192:195], v[32:35], v[72:75], v[192:195]
  ds_read_b64_tr_b16 v[112:113], v16 offset:8192
  v_mfma_f32_16x16x32_bf16 v[224:227], v[32:35], v[76:79], v[224:227]
  v_mfma_f32_16x16x32_bf16 v[132:135], v[36:39], v[64:67], v[132:135]
  ds_read_b128 v[84:87], v11 offset:2048
  v_mfma_f32_16x16x32_bf16 v[164:167], v[36:39], v[68:71], v[164:167]
  v_mfma_f32_16x16x32_bf16 v[196:199], v[36:39], v[72:75], v[196:199]
  ds_read_b64_tr_b16 v[114:115], v16 offset:9216
  v_mfma_f32_16x16x32_bf16 v[228:231], v[36:39], v[76:79], v[228:231]
  v_mfma_f32_16x16x32_bf16 v[136:139], v[40:43], v[64:67], v[136:139]
  ds_read_b128 v[88:91], v11 offset:4096
  v_mfma_f32_16x16x32_bf16 v[168:171], v[40:43], v[68:71], v[168:171]
  v_mfma_f32_16x16x32_bf16 v[200:203], v[40:43], v[72:75], v[200:203]
  ds_read_b64_tr_b16 v[116:117], v17 offset:8192
  v_mfma_f32_16x16x32_bf16 v[232:235], v[40:43], v[76:79], v[232:235]
  v_mfma_f32_16x16x32_bf16 v[140:143], v[44:47], v[64:67], v[140:143]
  ds_read_b128 v[92:95], v11 offset:6144
  v_mfma_f32_16x16x32_bf16 v[172:175], v[44:47], v[68:71], v[172:175]
  v_mfma_f32_16x16x32_bf16 v[204:207], v[44:47], v[72:75], v[204:207]
  ds_read_b64_tr_b16 v[118:119], v17 offset:9216
  v_mfma_f32_16x16x32_bf16 v[236:239], v[44:47], v[76:79], v[236:239]
  v_mfma_f32_16x16x32_bf16 v[144:147], v[48:51], v[64:67], v[144:147]
  ds_read_b128 v[96:99], v11 offset:8192
  v_mfma_f32_16x16x32_bf16 v[176:179], v[48:51], v[68:71], v[176:179]
  v_mfma_f32_16x16x32_bf16 v[208:211], v[48:51], v[72:75], v[208:211]
  ds_read_b64_tr_b16 v[120:121], v18 offset:8192
  v_mfma_f32_16x16x32_bf16 v[240:243], v[48:51], v[76:79], v[240:243]
  v_mfma_f32_16x16x32_bf16 v[148:151], v[52:55], v[64:67], v[148:151]
  ds_read_b128 v[100:103], v11 offset:10240
  v_mfma_f32_16x16x32_bf16 v[180:183], v[52:55], v[68:71], v[180:183]
  v_mfma_f32_16x16x32_bf16 v[212:215], v[52:55], v[72:75], v[212:215]
  ds_read_b64_tr_b16 v[122:123], v18 offset:9216
  v_mfma_f32_16x16x32_bf16 v[244:247], v[52:55], v[76:79], v[244:247]
  v_mfma_f32_16x16x32_bf16 v[152:155], v[56:59], v[64:67], v[152:155]
  ds_read_b128 v[104:107], v11 offset:12288
  v_mfma_f32_16x16x32_bf16 v[184:187], v[56:59], v[68:71], v[184:187]
  v_mfma_f32_16x16x32_bf16 v[216:219], v[56:59], v[72:75], v[216:219]
  ds_read_b64_tr_b16 v[124:125], v19 offset:8192
  v_mfma_f32_16x16x32_bf16 v[248:251], v[56:59], v[76:79], v[248:251]
  v_mfma_f32_16x16x32_bf16 v[156:159], v[60:63], v[64:67], v[156:159]
  ds_read_b128 v[108:111], v11 offset:14336
  v_mfma_f32_16x16x32_bf16 v[188:191], v[60:63], v[68:71], v[188:191]
  v_mfma_f32_16x16x32_bf16 v[220:223], v[60:63], v[72:75], v[220:223]
  ds_read_b64_tr_b16 v[126:127], v19 offset:9216
  v_mfma_f32_16x16x32_bf16 v[252:255], v[60:63], v[76:79], v[252:255]
  s_waitcnt lgkmcnt(0)
  s_barrier
  v_mov_b32 v3, 147460
  ds_read_b32 v4, v3
  s_waitcnt lgkmcnt(0)
  v_mfma_f32_16x16x32_bf16 v[128:131], v[80:83], v[112:115], v[128:131]
  ds_read_b128 v[32:35], v8 offset:0
  v_mfma_f32_16x16x32_bf16 v[160:163], v[80:83], v[116:119], v[160:163]
  v_mfma_f32_16x16x32_bf16 v[192:195], v[80:83], v[120:123], v[192:195]
  ds_read_b64_tr_b16 v[64:65], v12 offset:0
  v_mfma_f32_16x16x32_bf16 v[224:227], v[80:83], v[124:127], v[224:227]
  v_mfma_f32_16x16x32_bf16 v[132:135], v[84:87], v[112:115], v[132:135]
  ds_read_b128 v[36:39], v8 offset:2048
  v_mfma_f32_16x16x32_bf16 v[164:167], v[84:87], v[116:119], v[164:167]
  v_mfma_f32_16x16x32_bf16 v[196:199], v[84:87], v[120:123], v[196:199]
  ds_read_b64_tr_b16 v[66:67], v12 offset:1024
  v_mfma_f32_16x16x32_bf16 v[228:231], v[84:87], v[124:127], v[228:231]
  v_mfma_f32_16x16x32_bf16 v[136:139], v[88:91], v[112:115], v[136:139]
  ds_read_b128 v[40:43], v8 offset:4096
  v_mfma_f32_16x16x32_bf16 v[168:171], v[88:91], v[116:119], v[168:171]
  v_mfma_f32_16x16x32_bf16 v[200:203], v[88:91], v[120:123], v[200:203]
  ds_read_b64_tr_b16 v[68:69], v13 offset:0
  v_mfma_f32_16x16x32_bf16 v[232:235], v[88:91], v[124:127], v[232:235]
  v_mfma_f32_16x16x32_bf16 v[140:143], v[92:95], v[112:115], v[140:143]
  ds_read_b128 v[44:47], v8 offset:6144
  v_mfma_f32_16x16x32_bf16 v[172:175], v[92:95], v[116:119], v[172:175]
  v_mfma_f32_16x16x32_bf16 v[204:207], v[92:95], v[120:123], v[204:207]
  ds_read_b64_tr_b16 v[70:71], v13 offset:1024
  v_mfma_f32_16x16x32_bf16 v[236:239], v[92:95], v[124:127], v[236:239]
  v_mfma_f32_16x16x32_bf16 v[144:147], v[96:99], v[112:115], v[144:147]
  ds_read_b128 v[48:51], v8 offset:8192
  v_mfma_f32_16x16x32_bf16 v[176:179], v[96:99], v[116:119], v[176:179]
  v_mfma_f32_16x16x32_bf16 v[208:211], v[96:99], v[120:123], v[208:211]
  ds_read_b64_tr_b16 v[72:73], v14 offset:0
  v_mfma_f32_16x16x32_bf16 v[240:243], v[96:99], v[124:127], v[240:243]
  v_mfma_f32_16x16x32_bf16 v[148:151], v[100:103], v[112:115], v[148:151]
  ds_read_b128 v[52:55], v8 offset:10240
  v_mfma_f32_16x16x32_bf16 v[180:183], v[100:103], v[116:119], v[180:183]
  v_mfma_f32_16x16x32_bf16 v[212:215], v[100:103], v[120:123], v[212:215]
  ds_read_b64_tr_b16 v[74:75], v14 offset:1024
  v_mfma_f32_16x16x32_bf16 v[244:247], v[100:103], v[124:127], v[244:247]
  v_mfma_f32_16x16x32_bf16 v[152:155], v[104:107], v[112:115], v[152:155]
  ds_read_b128 v[56:59], v8 offset:12288
  v_mfma_f32_16x16x32_bf16 v[184:187], v[104:107], v[116:119], v[184:187]
  v_mfma_f32_16x16x32_bf16 v[216:219], v[104:107], v[120:123], v[216:219]
  ds_read_b64_tr_b16 v[76:77], v15 offset:0
  v_mfma_f32_16x16x32_bf16 v[248:251], v[104:107], v[124:127], v[248:251]
  v_mfma_f32_16x16x32_bf16 v[156:159], v[108:111], v[112:115], v[156:159]
  ds_read_b128 v[60:63], v8 offset:14336
  v_mfma_f32_16x16x32_bf16 v[188:191], v[108:111], v[116:119], v[188:191]
  v_mfma_f32_16x16x32_bf16 v[220:223], v[108:111], v[120:123], v[220:223]
  ds_read_b64_tr_b16 v[78:79], v15 offset:1024
  v_mfma_f32_16x16x32_bf16 v[252:255], v[108:111], v[124:127], v[252:255]
  v_readfirstlane_b32 s49, v4
  s_nop 0
  s_cmp_lg_u32 s47, 0
  s_cselect_b32 s47, 1, s49
  s_waitcnt lgkmcnt(0)
  v_mfma_f32_16x16x32_bf16 v[128:131], v[32:35], v[64:67], v[128:131]
  ds_read_b128 v[80:83], v9 offset:0
  v_mfma_f32_16x16x32_bf16 v[160:163], v[32:35], v[68:71], v[160:163]
  v_mfma_f32_16x16x32_bf16 v[192:195], v[32:35], v[72:75], v[192:195]
  ds_read_b64_tr_b16 v[112:113], v12 offset:8192
  v_mfma_f32_16x16x32_bf16 v[224:227], v[32:35], v[76:79], v[224:227]
  v_mfma_f32_16x16x32_bf16 v[132:135], v[36:39], v[64:67], v[132:135]
  ds_read_b128 v[84:87], v9 offset:2048
  v_mfma_f32_16x16x32_bf16 v[164:167], v[36:39], v[68:71], v[164:167]
  v_mfma_f32_16x16x32_bf16 v[196:199], v[36:39], v[72:75], v[196:199]
  ds_read_b64_tr_b16 v[114:115], v12 offset:9216
  v_mfma_f32_16x16x32_bf16 v[228:231], v[36:39], v[76:79], v[228:231]
  v_mfma_f32_16x16x32_bf16 v[136:139], v[40:43], v[64:67], v[136:139]
  ds_read_b128 v[88:91], v9 offset:4096
  v_mfma_f32_16x16x32_bf16 v[168:171], v[40:43], v[68:71], v[168:171]
  v_mfma_f32_16x16x32_bf16 v[200:203], v[40:43], v[72:75], v[200:203]
  ds_read_b64_tr_b16 v[116:117], v13 offset:8192
  v_mfma_f32_16x16x32_bf16 v[232:235], v[40:43], v[76:79], v[232:235]
  v_mfma_f32_16x16x32_bf16 v[140:143], v[44:47], v[64:67], v[140:143]
  ds_read_b128 v[92:95], v9 offset:6144
  v_mfma_f32_16x16x32_bf16 v[172:175], v[44:47], v[68:71], v[172:175]
  v_mfma_f32_16x16x32_bf16 v[204:207], v[44:47], v[72:75], v[204:207]
  ds_read_b64_tr_b16 v[118:119], v13 offset:9216
  v_mfma_f32_16x16x32_bf16 v[236:239], v[44:47], v[76:79], v[236:239]
  v_mfma_f32_16x16x32_bf16 v[144:147], v[48:51], v[64:67], v[144:147]
  ds_read_b128 v[96:99], v9 offset:8192
  v_mfma_f32_16x16x32_bf16 v[176:179], v[48:51], v[68:71], v[176:179]
  v_mfma_f32_16x16x32_bf16 v[208:211], v[48:51], v[72:75], v[208:211]
  ds_read_b64_tr_b16 v[120:121], v14 offset:8192
  v_mfma_f32_16x16x32_bf16 v[240:243], v[48:51], v[76:79], v[240:243]
  v_mfma_f32_16x16x32_bf16 v[148:151], v[52:55], v[64:67], v[148:151]
  ds_read_b128 v[100:103], v9 offset:10240
  v_mfma_f32_16x16x32_bf16 v[180:183], v[52:55], v[68:71], v[180:183]
  v_mfma_f32_16x16x32_bf16 v[212:215], v[52:55], v[72:75], v[212:215]
  ds_read_b64_tr_b16 v[122:123], v14 offset:9216
  v_mfma_f32_16x16x32_bf16 v[244:247], v[52:55], v[76:79], v[244:247]
  v_mfma_f32_16x16x32_bf16 v[152:155], v[56:59], v[64:67], v[152:155]
  ds_read_b128 v[104:107], v9 offset:12288
  v_mfma_f32_16x16x32_bf16 v[184:187], v[56:59], v[68:71], v[184:187]
  v_mfma_f32_16x16x32_bf16 v[216:219], v[56:59], v[72:75], v[216:219]
  ds_read_b64_tr_b16 v[124:125], v15 offset:8192
  v_mfma_f32_16x16x32_bf16 v[248:251], v[56:59], v[76:79], v[248:251]
  v_mfma_f32_16x16x32_bf16 v[156:159], v[60:63], v[64:67], v[156:159]
  ds_read_b128 v[108:111], v9 offset:14336
  v_mfma_f32_16x16x32_bf16 v[188:191], v[60:63], v[68:71], v[188:191]
  v_mfma_f32_16x16x32_bf16 v[220:223], v[60:63], v[72:75], v[220:223]
  ds_read_b64_tr_b16 v[126:127], v15 offset:9216
  v_mfma_f32_16x16x32_bf16 v[252:255], v[60:63], v[76:79], v[252:255]
  s_waitcnt lgkmcnt(0)
  v_mfma_f32_16x16x32_bf16 v[128:131], v[80:83], v[112:115], v[128:131]
  v_mfma_f32_16x16x32_bf16 v[160:163], v[80:83], v[116:119], v[160:163]
  v_mfma_f32_16x16x32_bf16 v[192:195], v[80:83], v[120:123], v[192:195]
  v_mfma_f32_16x16x32_bf16 v[224:227], v[80:83], v[124:127], v[224:227]
  v_mfma_f32_16x16x32_bf16 v[132:135], v[84:87], v[112:115], v[132:135]
  v_mfma_f32_16x16x32_bf16 v[164:167], v[84:87], v[116:119], v[164:167]
  v_mfma_f32_16x16x32_bf16 v[196:199], v[84:87], v[120:123], v[196:199]
  v_mfma_f32_16x16x32_bf16 v[228:231], v[84:87], v[124:127], v[228:231]
  v_mfma_f32_16x16x32_bf16 v[136:139], v[88:91], v[112:115], v[136:139]
  v_mfma_f32_16x16x32_bf16 v[168:171], v[88:91], v[116:119], v[168:171]
  v_mfma_f32_16x16x32_bf16 v[200:203], v[88:91], v[120:123], v[200:203]
  v_mfma_f32_16x16x32_bf16 v[232:235], v[88:91], v[124:127], v[232:235]
  v_mfma_f32_16x16x32_bf16 v[140:143], v[92:95], v[112:115], v[140:143]
  v_mfma_f32_16x16x32_bf16 v[172:175], v[92:95], v[116:119], v[172:175]
  v_mfma_f32_16x16x32_bf16 v[204:207], v[92:95], v[120:123], v[204:207]
  v_mfma_f32_16x16x32_bf16 v[236:239], v[92:95], v[124:127], v[236:239]
  v_mfma_f32_16x16x32_bf16 v[144:147], v[96:99], v[112:115], v[144:147]
  v_mfma_f32_16x16x32_bf16 v[176:179], v[96:99], v[116:119], v[176:179]
  v_mfma_f32_16x16x32_bf16 v[208:211], v[96:99], v[120:123], v[208:211]
  v_mfma_f32_16x16x32_bf16 v[240:243], v[96:99], v[124:127], v[240:243]
  v_mfma_f32_16x16x32_bf16 v[148:151], v[100:103], v[112:115], v[148:151]
  v_mfma_f32_16x16x32_bf16 v[180:183], v[100:103], v[116:119], v[180:183]
  v_mfma_f32_16x16x32_bf16 v[212:215], v[100:103], v[120:123], v[212:215]
  v_mfma_f32_16x16x32_bf16 v[244:247], v[100:103], v[124:127], v[244:247]
  v_mfma_f32_16x16x32_bf16 v[152:155], v[104:107], v[112:115], v[152:155]
  v_mfma_f32_16x16x32_bf16 v[184:187], v[104:107], v[116:119], v[184:187]
  v_mfma_f32_16x16x32_bf16 v[216:219], v[104:107], v[120:123], v[216:219]
  v_mfma_f32_16x16x32_bf16 v[248:251], v[104:107], v[124:127], v[248:251]
  v_mfma_f32_16x16x32_bf16 v[156:159], v[108:111], v[112:115], v[156:159]
  v_mfma_f32_16x16x32_bf16 v[188:191], v[108:111], v[116:119], v[188:191]
  v_mfma_f32_16x16x32_bf16 v[220:223], v[108:111], v[120:123], v[220:223]
  v_mfma_f32_16x16x32_bf16 v[252:255], v[108:111], v[124:127], v[252:255]
  s_barrier
  s_cmp_lg_u32 s47, 0
  s_cbranch_scc1 K1_RDY_S
  s_barrier
  s_barrier
K1_RDY_S:
  v_and_b32 v1, 15, v0
  v_lshrrev_b32 v2, 4, v0
  s_lshl_b32 s3, s37, 9
  s_add_u32 s3, s3, 147520
  v_lshlrev_b32 v3, 4, v2
  v_add_u32 v3, s3, v3
  s_lshl_b32 s3, s38, 8
  s_add_u32 s3, s3, 149568
  v_lshlrev_b32 v4, 2, v1
  v_add_u32 v4, s3, v4
  ds_read_b32 v32, v4 offset:0
  ds_read_b32 v34, v4 offset:64
  ds_read_b32 v36, v4 offset:128
  ds_read_b32 v38, v4 offset:192
  ds_read_b128 v[48:51], v3 offset:0
  ds_read_b128 v[80:83], v3 offset:1024
  ds_read_b128 v[52:55], v3 offset:64
  ds_read_b128 v[84:87], v3 offset:1088
  ds_read_b128 v[56:59], v3 offset:128
  ds_read_b128 v[88:91], v3 offset:1152
  ds_read_b128 v[60:63], v3 offset:192
  ds_read_b128 v[92:95], v3 offset:1216
  ds_read_b128 v[64:67], v3 offset:256
  ds_read_b128 v[96:99], v3 offset:1280
  ds_read_b128 v[68:71], v3 offset:320
  ds_read_b128 v[100:103], v3 offset:1344
  ds_read_b128 v[72:75], v3 offset:384
  ds_read_b128 v[104:107], v3 offset:1408
  ds_read_b128 v[76:79], v3 offset:448
  ds_read_b128 v[108:111], v3 offset:1472
  s_waitcnt lgkmcnt(0)
  s_mov_b32 s54, s56
  v_pk_fma_f32 v[128:129], v[48:49], v[32:33], v[128:129] op_sel_hi:[1,0,1]
  v_pk_fma_f32 v[130:131], v[50:51], v[32:33], v[130:131] op_sel_hi:[1,0,1]
  v_pk_mul_f32 v[128:129], v[128:129], v[80:81]
  v_pk_mul_f32 v[130:131], v[130:131], v[82:83]
  v_pk_fma_f32 v[132:133], v[52:53], v[32:33], v[132:133] op_sel_hi:[1,0,1]
  v_pk_fma_f32 v[134:135], v[54:55], v[32:33], v[134:135] op_sel_hi:[1,0,1]
  v_pk_mul_f32 v[132:133], v[132:133], v[84:85]
  v_pk_mul_f32 v[134:135], v[134:135], v[86:87]
  v_cvt_pk_bf16_f32 v112, v128, v132
  v_cvt_pk_bf16_f32 v113, v129, v133
  v_cvt_pk_bf16_f32 v114, v130, v134
  v_cvt_pk_bf16_f32 v115, v131, v135
  s_nop 1
  v_permlane16_swap_b32 v112, v114
  v_permlane16_swap_b32 v113, v115
  buffer_store_dwordx4 v[112:115], v20, s[32:35], s54 offen
  v_pk_fma_f32 v[160:161], v[48:49], v[34:35], v[160:161] op_sel_hi:[1,0,1]
  v_pk_fma_f32 v[162:163], v[50:51], v[34:35], v[162:163] op_sel_hi:[1,0,1]
  v_pk_mul_f32 v[160:161], v[160:161], v[80:81]
  v_pk_mul_f32 v[162:163], v[162:163], v[82:83]
  v_pk_fma_f32 v[164:165], v[52:53], v[34:35], v[164:165] op_sel_hi:[1,0,1]
  v_pk_fma_f32 v[166:167], v[54:55], v[34:35], v[166:167] op_sel_hi:[1,0,1]
  v_pk_mul_f32 v[164:165], v[164:165], v[84:85]
  v_pk_mul_f32 v[166:167], v[166:167], v[86:87]
  v_cvt_pk_bf16_f32 v116, v160, v164
  v_cvt_pk_bf16_f32 v117, v161, v165
  v_cvt_pk_bf16_f32 v118, v162, v166
  v_cvt_pk_bf16_f32 v119, v163, v167
  s_nop 1
  v_permlane16_swap_b32 v116, v118
  v_permlane16_swap_b32 v117, v119
  buffer_store_dwordx4 v[116:119], v21, s[32:35], s54 offen
  v_pk_fma_f32 v[192:193], v[48:49], v[36:37], v[192:193] op_sel_hi:[1,0,1]
  v_pk_fma_f32 v[194:195], v[50:51], v[36:37], v[194:195] op_sel_hi:[1,0,1]
  v_pk_mul_f32 v[192:193], v[192:193], v[80:81]
  v_pk_mul_f32 v[194:195], v[194:195], v[82:83]
  v_pk_fma_f32 v[196:197], v[52:53], v[36:37], v[196:197] op_sel_hi:[1,0,1]
  v_pk_fma_f32 v[198:199], v[54:55], v[36:37], v[198:199] op_sel_hi:[1,0,1]
  v_pk_mul_f32 v[196:197], v[196:197], v[84:85]
  v_pk_mul_f32 v[198:199], v[198:199], v[86:87]
  v_cvt_pk_bf16_f32 v120, v192, v196
  v_cvt_pk_bf16_f32 v121, v193, v197
  v_cvt_pk_bf16_f32 v122, v194, v198
  v_cvt_pk_bf16_f32 v123, v195, v199
  s_nop 1
  v_permlane16_swap_b32 v120, v122
  v_permlane16_swap_b32 v121, v123
  buffer_store_dwordx4 v[120:123], v22, s[32:35], s54 offen
  v_pk_fma_f32 v[224:225], v[48:49], v[38:39], v[224:225] op_sel_hi:[1,0,1]
  v_pk_fma_f32 v[226:227], v[50:51], v[38:39], v[226:227] op_sel_hi:[1,0,1]
  v_pk_mul_f32 v[224:225], v[224:225], v[80:81]
  v_pk_mul_f32 v[226:227], v[226:227], v[82:83]
  v_pk_fma_f32 v[228:229], v[52:53], v[38:39], v[228:229] op_sel_hi:[1,0,1]
  v_pk_fma_f32 v[230:231], v[54:55], v[38:39], v[230:231] op_sel_hi:[1,0,1]
  v_pk_mul_f32 v[228:229], v[228:229], v[84:85]
  v_pk_mul_f32 v[230:231], v[230:231], v[86:87]
  v_cvt_pk_bf16_f32 v124, v224, v228
  v_cvt_pk_bf16_f32 v125, v225, v229
  v_cvt_pk_bf16_f32 v126, v226, v230
  v_cvt_pk_bf16_f32 v127, v227, v231
  s_nop 1
  v_permlane16_swap_b32 v124, v126
  v_permlane16_swap_b32 v125, v127
  buffer_store_dwordx4 v[124:127], v23, s[32:35], s54 offen
  s_add_u32 s54, s54, 1280
  v_pk_fma_f32 v[136:137], v[56:57], v[32:33], v[136:137] op_sel_hi:[1,0,1]
  v_pk_fma_f32 v[138:139], v[58:59], v[32:33], v[138:139] op_sel_hi:[1,0,1]
  v_pk_mul_f32 v[136:137], v[136:137], v[88:89]
  v_pk_mul_f32 v[138:139], v[138:139], v[90:91]
  v_pk_fma_f32 v[140:141], v[60:61], v[32:33], v[140:141] op_sel_hi:[1,0,1]
  v_pk_fma_f32 v[142:143], v[62:63], v[32:33], v[142:143] op_sel_hi:[1,0,1]
  v_pk_mul_f32 v[140:141], v[140:141], v[92:93]
  v_pk_mul_f32 v[142:143], v[142:143], v[94:95]
  v_cvt_pk_bf16_f32 v112, v136, v140
  v_cvt_pk_bf16_f32 v113, v137, v141
  v_cvt_pk_bf16_f32 v114, v138, v142
  v_cvt_pk_bf16_f32 v115, v139, v143
  s_nop 1
  v_permlane16_swap_b32 v112, v114
  v_permlane16_swap_b32 v113, v115
  buffer_store_dwordx4 v[112:115], v20, s[32:35], s54 offen
  v_pk_fma_f32 v[168:169], v[56:57], v[34:35], v[168:169] op_sel_hi:[1,0,1]
  v_pk_fma_f32 v[170:171], v[58:59], v[34:35], v[170:171] op_sel_hi:[1,0,1]
  v_pk_mul_f32 v[168:169], v[168:169], v[88:89]
  v_pk_mul_f32 v[170:171], v[170:171], v[90:91]
  v_pk_fma_f32 v[172:173], v[60:61], v[34:35], v[172:173] op_sel_hi:[1,0,1]
  v_pk_fma_f32 v[174:175], v[62:63], v[34:35], v[174:175] op_sel_hi:[1,0,1]
  v_pk_mul_f32 v[172:173], v[172:173], v[92:93]
  v_pk_mul_f32 v[174:175], v[174:175], v[94:95]
  v_cvt_pk_bf16_f32 v116, v168, v172
  v_cvt_pk_bf16_f32 v117, v169, v173
  v_cvt_pk_bf16_f32 v118, v170, v174
  v_cvt_pk_bf16_f32 v119, v171, v175
  s_nop 1
  v_permlane16_swap_b32 v116, v118
  v_permlane16_swap_b32 v117, v119
  buffer_store_dwordx4 v[116:119], v21, s[32:35], s54 offen
  v_pk_fma_f32 v[200:201], v[56:57], v[36:37], v[200:201] op_sel_hi:[1,0,1]
  v_pk_fma_f32 v[202:203], v[58:59], v[36:37], v[202:203] op_sel_hi:[1,0,1]
  v_pk_mul_f32 v[200:201], v[200:201], v[88:89]
  v_pk_mul_f32 v[202:203], v[202:203], v[90:91]
  v_pk_fma_f32 v[204:205], v[60:61], v[36:37], v[204:205] op_sel_hi:[1,0,1]
  v_pk_fma_f32 v[206:207], v[62:63], v[36:37], v[206:207] op_sel_hi:[1,0,1]
  v_pk_mul_f32 v[204:205], v[204:205], v[92:93]
  v_pk_mul_f32 v[206:207], v[206:207], v[94:95]
  v_cvt_pk_bf16_f32 v120, v200, v204
  v_cvt_pk_bf16_f32 v121, v201, v205
  v_cvt_pk_bf16_f32 v122, v202, v206
  v_cvt_pk_bf16_f32 v123, v203, v207
  s_nop 1
  v_permlane16_swap_b32 v120, v122
  v_permlane16_swap_b32 v121, v123
  buffer_store_dwordx4 v[120:123], v22, s[32:35], s54 offen
  v_pk_fma_f32 v[232:233], v[56:57], v[38:39], v[232:233] op_sel_hi:[1,0,1]
  v_pk_fma_f32 v[234:235], v[58:59], v[38:39], v[234:235] op_sel_hi:[1,0,1]
  v_pk_mul_f32 v[232:233], v[232:233], v[88:89]
  v_pk_mul_f32 v[234:235], v[234:235], v[90:91]
  v_pk_fma_f32 v[236:237], v[60:61], v[38:39], v[236:237] op_sel_hi:[1,0,1]
  v_pk_fma_f32 v[238:239], v[62:63], v[38:39], v[238:239] op_sel_hi:[1,0,1]
  v_pk_mul_f32 v[236:237], v[236:237], v[92:93]
  v_pk_mul_f32 v[238:239], v[238:239], v[94:95]
  v_cvt_pk_bf16_f32 v124, v232, v236
  v_cvt_pk_bf16_f32 v125, v233, v237
  v_cvt_pk_bf16_f32 v126, v234, v238
  v_cvt_pk_bf16_f32 v127, v235, v239
  s_nop 1
  v_permlane16_swap_b32 v124, v126
  v_permlane16_swap_b32 v125, v127
  buffer_store_dwordx4 v[124:127], v23, s[32:35], s54 offen
  s_add_u32 s54, s54, 1280
  v_pk_fma_f32 v[144:145], v[64:65], v[32:33], v[144:145] op_sel_hi:[1,0,1]
  v_pk_fma_f32 v[146:147], v[66:67], v[32:33], v[146:147] op_sel_hi:[1,0,1]
  v_pk_mul_f32 v[144:145], v[144:145], v[96:97]
  v_pk_mul_f32 v[146:147], v[146:147], v[98:99]
  v_pk_fma_f32 v[148:149], v[68:69], v[32:33], v[148:149] op_sel_hi:[1,0,1]
  v_pk_fma_f32 v[150:151], v[70:71], v[32:33], v[150:151] op_sel_hi:[1,0,1]
  v_pk_mul_f32 v[148:149], v[148:149], v[100:101]
  v_pk_mul_f32 v[150:151], v[150:151], v[102:103]
  v_cvt_pk_bf16_f32 v112, v144, v148
  v_cvt_pk_bf16_f32 v113, v145, v149
  v_cvt_pk_bf16_f32 v114, v146, v150
  v_cvt_pk_bf16_f32 v115, v147, v151
  s_nop 1
  v_permlane16_swap_b32 v112, v114
  v_permlane16_swap_b32 v113, v115
  buffer_store_dwordx4 v[112:115], v20, s[32:35], s54 offen
  v_pk_fma_f32 v[176:177], v[64:65], v[34:35], v[176:177] op_sel_hi:[1,0,1]
  v_pk_fma_f32 v[178:179], v[66:67], v[34:35], v[178:179] op_sel_hi:[1,0,1]
  v_pk_mul_f32 v[176:177], v[176:177], v[96:97]
  v_pk_mul_f32 v[178:179], v[178:179], v[98:99]
  v_pk_fma_f32 v[180:181], v[68:69], v[34:35], v[180:181] op_sel_hi:[1,0,1]
  v_pk_fma_f32 v[182:183], v[70:71], v[34:35], v[182:183] op_sel_hi:[1,0,1]
  v_pk_mul_f32 v[180:181], v[180:181], v[100:101]
  v_pk_mul_f32 v[182:183], v[182:183], v[102:103]
  v_cvt_pk_bf16_f32 v116, v176, v180
  v_cvt_pk_bf16_f32 v117, v177, v181
  v_cvt_pk_bf16_f32 v118, v178, v182
  v_cvt_pk_bf16_f32 v119, v179, v183
  s_nop 1
  v_permlane16_swap_b32 v116, v118
  v_permlane16_swap_b32 v117, v119
  buffer_store_dwordx4 v[116:119], v21, s[32:35], s54 offen
  v_pk_fma_f32 v[208:209], v[64:65], v[36:37], v[208:209] op_sel_hi:[1,0,1]
  v_pk_fma_f32 v[210:211], v[66:67], v[36:37], v[210:211] op_sel_hi:[1,0,1]
  v_pk_mul_f32 v[208:209], v[208:209], v[96:97]
  v_pk_mul_f32 v[210:211], v[210:211], v[98:99]
  v_pk_fma_f32 v[212:213], v[68:69], v[36:37], v[212:213] op_sel_hi:[1,0,1]
  v_pk_fma_f32 v[214:215], v[70:71], v[36:37], v[214:215] op_sel_hi:[1,0,1]
  v_pk_mul_f32 v[212:213], v[212:213], v[100:101]
  v_pk_mul_f32 v[214:215], v[214:215], v[102:103]
  v_cvt_pk_bf16_f32 v120, v208, v212
  v_cvt_pk_bf16_f32 v121, v209, v213
  v_cvt_pk_bf16_f32 v122, v210, v214
  v_cvt_pk_bf16_f32 v123, v211, v215
  s_nop 1
  v_permlane16_swap_b32 v120, v122
  v_permlane16_swap_b32 v121, v123
  buffer_store_dwordx4 v[120:123], v22, s[32:35], s54 offen
  v_pk_fma_f32 v[240:241], v[64:65], v[38:39], v[240:241] op_sel_hi:[1,0,1]
  v_pk_fma_f32 v[242:243], v[66:67], v[38:39], v[242:243] op_sel_hi:[1,0,1]
  v_pk_mul_f32 v[240:241], v[240:241], v[96:97]
  v_pk_mul_f32 v[242:243], v[242:243], v[98:99]
  v_pk_fma_f32 v[244:245], v[68:69], v[38:39], v[244:245] op_sel_hi:[1,0,1]
  v_pk_fma_f32 v[246:247], v[70:71], v[38:39], v[246:247] op_sel_hi:[1,0,1]
  v_pk_mul_f32 v[244:245], v[244:245], v[100:101]
  v_pk_mul_f32 v[246:247], v[246:247], v[102:103]
  v_cvt_pk_bf16_f32 v124, v240, v244
  v_cvt_pk_bf16_f32 v125, v241, v245
  v_cvt_pk_bf16_f32 v126, v242, v246
  v_cvt_pk_bf16_f32 v127, v243, v247
  s_nop 1
  v_permlane16_swap_b32 v124, v126
  v_permlane16_swap_b32 v125, v127
  buffer_store_dwordx4 v[124:127], v23, s[32:35], s54 offen
  s_add_u32 s54, s54, 1280
  v_pk_fma_f32 v[152:153], v[72:73], v[32:33], v[152:153] op_sel_hi:[1,0,1]
  v_pk_fma_f32 v[154:155], v[74:75], v[32:33], v[154:155] op_sel_hi:[1,0,1]
  v_pk_mul_f32 v[152:153], v[152:153], v[104:105]
  v_pk_mul_f32 v[154:155], v[154:155], v[106:107]
  v_pk_fma_f32 v[156:157], v[76:77], v[32:33], v[156:157] op_sel_hi:[1,0,1]
  v_pk_fma_f32 v[158:159], v[78:79], v[32:33], v[158:159] op_sel_hi:[1,0,1]
  v_pk_mul_f32 v[156:157], v[156:157], v[108:109]
  v_pk_mul_f32 v[158:159], v[158:159], v[110:111]
  v_cvt_pk_bf16_f32 v112, v152, v156
  v_cvt_pk_bf16_f32 v113, v153, v157
  v_cvt_pk_bf16_f32 v114, v154, v158
  v_cvt_pk_bf16_f32 v115, v155, v159
  s_nop 1
  v_permlane16_swap_b32 v112, v114
  v_permlane16_swap_b32 v113, v115
  buffer_store_dwordx4 v[112:115], v20, s[32:35], s54 offen
  v_pk_fma_f32 v[184:185], v[72:73], v[34:35], v[184:185] op_sel_hi:[1,0,1]
  v_pk_fma_f32 v[186:187], v[74:75], v[34:35], v[186:187] op_sel_hi:[1,0,1]
  v_pk_mul_f32 v[184:185], v[184:185], v[104:105]
  v_pk_mul_f32 v[186:187], v[186:187], v[106:107]
  v_pk_fma_f32 v[188:189], v[76:77], v[34:35], v[188:189] op_sel_hi:[1,0,1]
  v_pk_fma_f32 v[190:191], v[78:79], v[34:35], v[190:191] op_sel_hi:[1,0,1]
  v_pk_mul_f32 v[188:189], v[188:189], v[108:109]
  v_pk_mul_f32 v[190:191], v[190:191], v[110:111]
  v_cvt_pk_bf16_f32 v116, v184, v188
  v_cvt_pk_bf16_f32 v117, v185, v189
  v_cvt_pk_bf16_f32 v118, v186, v190
  v_cvt_pk_bf16_f32 v119, v187, v191
  s_nop 1
  v_permlane16_swap_b32 v116, v118
  v_permlane16_swap_b32 v117, v119
  buffer_store_dwordx4 v[116:119], v21, s[32:35], s54 offen
  v_pk_fma_f32 v[216:217], v[72:73], v[36:37], v[216:217] op_sel_hi:[1,0,1]
  v_pk_fma_f32 v[218:219], v[74:75], v[36:37], v[218:219] op_sel_hi:[1,0,1]
  v_pk_mul_f32 v[216:217], v[216:217], v[104:105]
  v_pk_mul_f32 v[218:219], v[218:219], v[106:107]
  v_pk_fma_f32 v[220:221], v[76:77], v[36:37], v[220:221] op_sel_hi:[1,0,1]
  v_pk_fma_f32 v[222:223], v[78:79], v[36:37], v[222:223] op_sel_hi:[1,0,1]
  v_pk_mul_f32 v[220:221], v[220:221], v[108:109]
  v_pk_mul_f32 v[222:223], v[222:223], v[110:111]
  v_cvt_pk_bf16_f32 v120, v216, v220
  v_cvt_pk_bf16_f32 v121, v217, v221
  v_cvt_pk_bf16_f32 v122, v218, v222
  v_cvt_pk_bf16_f32 v123, v219, v223
  s_nop 1
  v_permlane16_swap_b32 v120, v122
  v_permlane16_swap_b32 v121, v123
  buffer_store_dwordx4 v[120:123], v22, s[32:35], s54 offen
  v_pk_fma_f32 v[248:249], v[72:73], v[38:39], v[248:249] op_sel_hi:[1,0,1]
  v_pk_fma_f32 v[250:251], v[74:75], v[38:39], v[250:251] op_sel_hi:[1,0,1]
  v_pk_mul_f32 v[248:249], v[248:249], v[104:105]
  v_pk_mul_f32 v[250:251], v[250:251], v[106:107]
  v_pk_fma_f32 v[252:253], v[76:77], v[38:39], v[252:253] op_sel_hi:[1,0,1]
  v_pk_fma_f32 v[254:255], v[78:79], v[38:39], v[254:255] op_sel_hi:[1,0,1]
  v_pk_mul_f32 v[252:253], v[252:253], v[108:109]
  v_pk_mul_f32 v[254:255], v[254:255], v[110:111]
  v_cvt_pk_bf16_f32 v124, v248, v252
  v_cvt_pk_bf16_f32 v125, v249, v253
  v_cvt_pk_bf16_f32 v126, v250, v254
  v_cvt_pk_bf16_f32 v127, v251, v255
  s_nop 1
  v_permlane16_swap_b32 v124, v126
  v_permlane16_swap_b32 v125, v127
  buffer_store_dwordx4 v[124:127], v23, s[32:35], s54 offen
  s_branch K1_FIN
K1_HELP_A:
  s_and_b32 s3, s2, 7
  s_lshl_b32 s3, s3, 2
  s_and_b32 s49, s22, 3
  s_add_u32 s42, s3, s49
  s_branch K1_HELP
K1_HELP_B:
  s_and_b32 s3, s2, 1
  s_lshl_b32 s3, s3, 2
  s_and_b32 s49, s22, 3
  s_add_u32 s3, s3, s49
  s_add_u32 s42, s3, 32
K1_HELP:
  s_waitcnt lgkmcnt(0)
  s_add_u32 s60, s20, 25165824
  s_addc_u32 s61, s21, 0
  s_and_b32 s61, s61, 0xffff
  s_mov_b32 s62, 65536
  s_mov_b32 s63, 0x00020000
  s_cmp_ge_u32 s42, 27
  s_cbranch_scc1 K1_HROW
  s_cmp_lt_u32 s42, 15
  s_cbranch_scc1 K1_HC_Q
  s_sub_u32 s3, s42, 15
  s_lshl_b32 s3, s3, 8
  s_add_u32 s28, s12, s3
  s_addc_u32 s29, s13, 0
  s_sub_u32 s30, 1966080, s3
  s_mov_b32 s41, 3072
  s_branch K1_HC_G
K1_HC_Q:
  s_lshl_b32 s3, s42, 8
  s_add_u32 s28, s6, s3
  s_addc_u32 s29, s7, 0
  s_sub_u32 s30, 2457600, s3
  s_mov_b32 s41, 3840
K1_HC_G:
  s_and_b32 s29, s29, 0xffff
  s_mov_b32 s31, 0x00020000
  v_lshrrev_b32 v1, 4, v0
  s_mul_i32 s3, s36, 80
  v_add_u32 v1, s3, v1
  v_mul_u32_u24 v1, s41, v1
  v_and_b32 v2, 15, v0
  v_lshl_add_u32 v1, v2, 4, v1
  s_lshl_b32 s49, s41, 2
  s_mov_b32 s50, 0
  buffer_load_dwordx4 v[16:19], v1, s[28:31], s50 offen
  s_add_u32 s50, s50, s49
  buffer_load_dwordx4 v[20:23], v1, s[28:31], s50 offen
  s_add_u32 s50, s50, s49
  buffer_load_dwordx4 v[24:27], v1, s[28:31], s50 offen
  s_add_u32 s50, s50, s49
  buffer_load_dwordx4 v[28:31], v1, s[28:31], s50 offen
  s_add_u32 s50, s50, s49
  buffer_load_dwordx4 v[32:35], v1, s[28:31], s50 offen
  s_add_u32 s50, s50, s49
  buffer_load_dwordx4 v[36:39], v1, s[28:31], s50 offen
  s_add_u32 s50, s50, s49
  buffer_load_dwordx4 v[40:43], v1, s[28:31], s50 offen
  s_add_u32 s50, s50, s49
  buffer_load_dwordx4 v[44:47], v1, s[28:31], s50 offen
  s_add_u32 s50, s50, s49
  buffer_load_dwordx4 v[48:51], v1, s[28:31], s50 offen
  s_add_u32 s50, s50, s49
  buffer_load_dwordx4 v[52:55], v1, s[28:31], s50 offen
  s_add_u32 s50, s50, s49
  buffer_load_dwordx4 v[56:59], v1, s[28:31], s50 offen
  s_add_u32 s50, s50, s49
  buffer_load_dwordx4 v[60:63], v1, s[28:31], s50 offen
  s_add_u32 s50, s50, s49
  buffer_load_dwordx4 v[64:67], v1, s[28:31], s50 offen
  s_add_u32 s50, s50, s49
  buffer_load_dwordx4 v[68:71], v1, s[28:31], s50 offen
  s_add_u32 s50, s50, s49
  buffer_load_dwordx4 v[72:75], v1, s[28:31], s50 offen
  s_add_u32 s50, s50, s49
  buffer_load_dwordx4 v[76:79], v1, s[28:31], s50 offen
  s_add_u32 s50, s50, s49
  buffer_load_dwordx4 v[80:83], v1, s[28:31], s50 offen
  s_add_u32 s50, s50, s49
  buffer_load_dwordx4 v[84:87], v1, s[28:31], s50 offen
  s_add_u32 s50, s50, s49
  buffer_load_dwordx4 v[88:91], v1, s[28:31], s50 offen
  s_add_u32 s50, s50, s49
  buffer_load_dwordx4 v[92:95], v1, s[28:31], s50 offen
  s_add_u32 s50, s50, s49
  v_mov_b32 v8, 0
  v_mov_b32 v9, 0
  v_mov_b32 v10, 0
  v_mov_b32 v11, 0
  v_mov_b32 v12, 0
  v_mov_b32 v13, 0
  v_mov_b32 v14, 0
  v_mov_b32 v15, 0
  s_mov_b32 s50, 0x00003f80
  s_mov_b32 s51, 0x3f800000
  s_waitcnt vmcnt(19)
  v_dot2c_f32_bf16 v8, s50, v16
  v_dot2c_f32_bf16 v9, s51, v16
  v_dot2c_f32_bf16 v10, s50, v17
  v_dot2c_f32_bf16 v11, s51, v17
  v_dot2c_f32_bf16 v12, s50, v18
  v_dot2c_f32_bf16 v13, s51, v18
  v_dot2c_f32_bf16 v14, s50, v19
  v_dot2c_f32_bf16 v15, s51, v19
  s_waitcnt vmcnt(18)
  v_dot2c_f32_bf16 v8, s50, v20
  v_dot2c_f32_bf16 v9, s51, v20
  v_dot2c_f32_bf16 v10, s50, v21
  v_dot2c_f32_bf16 v11, s51, v21
  v_dot2c_f32_bf16 v12, s50, v22
  v_dot2c_f32_bf16 v13, s51, v22
  v_dot2c_f32_bf16 v14, s50, v23
  v_dot2c_f32_bf16 v15, s51, v23
  s_waitcnt vmcnt(17)
  v_dot2c_f32_bf16 v8, s50, v24
  v_dot2c_f32_bf16 v9, s51, v24
  v_dot2c_f32_bf16 v10, s50, v25
  v_dot2c_f32_bf16 v11, s51, v25
  v_dot2c_f32_bf16 v12, s50, v26
  v_dot2c_f32_bf16 v13, s51, v26
  v_dot2c_f32_bf16 v14, s50, v27
  v_dot2c_f32_bf16 v15, s51, v27
  s_waitcnt vmcnt(16)
  v_dot2c_f32_bf16 v8, s50, v28
  v_dot2c_f32_bf16 v9, s51, v28
  v_dot2c_f32_bf16 v10, s50, v29
  v_dot2c_f32_bf16 v11, s51, v29
  v_dot2c_f32_bf16 v12, s50, v30
  v_dot2c_f32_bf16 v13, s51, v30
  v_dot2c_f32_bf16 v14, s50, v31
  v_dot2c_f32_bf16 v15, s51, v31
  s_waitcnt vmcnt(15)
  v_dot2c_f32_bf16 v8, s50, v32
  v_dot2c_f32_bf16 v9, s51, v32
  v_dot2c_f32_bf16 v10, s50, v33
  v_dot2c_f32_bf16 v11, s51, v33
  v_dot2c_f32_bf16 v12, s50, v34
  v_dot2c_f32_bf16 v13, s51, v34
  v_dot2c_f32_bf16 v14, s50, v35
  v_dot2c_f32_bf16 v15, s51, v35
  s_waitcnt vmcnt(14)
  v_dot2c_f32_bf16 v8, s50, v36
  v_dot2c_f32_bf16 v9, s51, v36
  v_dot2c_f32_bf16 v10, s50, v37
  v_dot2c_f32_bf16 v11, s51, v37
  v_dot2c_f32_bf16 v12, s50, v38
  v_dot2c_f32_bf16 v13, s51, v38
  v_dot2c_f32_bf16 v14, s50, v39
  v_dot2c_f32_bf16 v15, s51, v39
  s_waitcnt vmcnt(13)
  v_dot2c_f32_bf16 v8, s50, v40
  v_dot2c_f32_bf16 v9, s51, v40
  v_dot2c_f32_bf16 v10, s50, v41
  v_dot2c_f32_bf16 v11, s51, v41
  v_dot2c_f32_bf16 v12, s50, v42
  v_dot2c_f32_bf16 v13, s51, v42
  v_dot2c_f32_bf16 v14, s50, v43
  v_dot2c_f32_bf16 v15, s51, v43
  s_waitcnt vmcnt(12)
  v_dot2c_f32_bf16 v8, s50, v44
  v_dot2c_f32_bf16 v9, s51, v44
  v_dot2c_f32_bf16 v10, s50, v45
  v_dot2c_f32_bf16 v11, s51, v45
  v_dot2c_f32_bf16 v12, s50, v46
  v_dot2c_f32_bf16 v13, s51, v46
  v_dot2c_f32_bf16 v14, s50, v47
  v_dot2c_f32_bf16 v15, s51, v47
  s_waitcnt vmcnt(11)
  v_dot2c_f32_bf16 v8, s50, v48
  v_dot2c_f32_bf16 v9, s51, v48
  v_dot2c_f32_bf16 v10, s50, v49
  v_dot2c_f32_bf16 v11, s51, v49
  v_dot2c_f32_bf16 v12, s50, v50
  v_dot2c_f32_bf16 v13, s51, v50
  v_dot2c_f32_bf16 v14, s50, v51
  v_dot2c_f32_bf16 v15, s51, v51
  s_waitcnt vmcnt(10)
  v_dot2c_f32_bf16 v8, s50, v52
  v_dot2c_f32_bf16 v9, s51, v52
  v_dot2c_f32_bf16 v10, s50, v53
  v_dot2c_f32_bf16 v11, s51, v53
  v_dot2c_f32_bf16 v12, s50, v54
  v_dot2c_f32_bf16 v13, s51, v54
  v_dot2c_f32_bf16 v14, s50, v55
  v_dot2c_f32_bf16 v15, s51, v55
  s_waitcnt vmcnt(9)
  v_dot2c_f32_bf16 v8, s50, v56
  v_dot2c_f32_bf16 v9, s51, v56
  v_dot2c_f32_bf16 v10, s50, v57
  v_dot2c_f32_bf16 v11, s51, v57
  v_dot2c_f32_bf16 v12, s50, v58
  v_dot2c_f32_bf16 v13, s51, v58
  v_dot2c_f32_bf16 v14, s50, v59
  v_dot2c_f32_bf16 v15, s51, v59
  s_waitcnt vmcnt(8)
  v_dot2c_f32_bf16 v8, s50, v60
  v_dot2c_f32_bf16 v9, s51, v60
  v_dot2c_f32_bf16 v10, s50, v61
  v_dot2c_f32_bf16 v11, s51, v61
  v_dot2c_f32_bf16 v12, s50, v62
  v_dot2c_f32_bf16 v13, s51, v62
  v_dot2c_f32_bf16 v14, s50, v63
  v_dot2c_f32_bf16 v15, s51, v63
  s_waitcnt vmcnt(7)
  v_dot2c_f32_bf16 v8, s50, v64
  v_dot2c_f32_bf16 v9, s51, v64
  v_dot2c_f32_bf16 v10, s50, v65
  v_dot2c_f32_bf16 v11, s51, v65
  v_dot2c_f32_bf16 v12, s50, v66
  v_dot2c_f32_bf16 v13, s51, v66
  v_dot2c_f32_bf16 v14, s50, v67
  v_dot2c_f32_bf16 v15, s51, v67
  s_waitcnt vmcnt(6)
  v_dot2c_f32_bf16 v8, s50, v68
  v_dot2c_f32_bf16 v9, s51, v68
  v_dot2c_f32_bf16 v10, s50, v69
  v_dot2c_f32_bf16 v11, s51, v69
  v_dot2c_f32_bf16 v12, s50, v70
  v_dot2c_f32_bf16 v13, s51, v70
  v_dot2c_f32_bf16 v14, s50, v71
  v_dot2c_f32_bf16 v15, s51, v71
  s_waitcnt vmcnt(5)
  v_dot2c_f32_bf16 v8, s50, v72
  v_dot2c_f32_bf16 v9, s51, v72
  v_dot2c_f32_bf16 v10, s50, v73
  v_dot2c_f32_bf16 v11, s51, v73
  v_dot2c_f32_bf16 v12, s50, v74
  v_dot2c_f32_bf16 v13, s51, v74
  v_dot2c_f32_bf16 v14, s50, v75
  v_dot2c_f32_bf16 v15, s51, v75
  s_waitcnt vmcnt(4)
  v_dot2c_f32_bf16 v8, s50, v76
  v_dot2c_f32_bf16 v9, s51, v76
  v_dot2c_f32_bf16 v10, s50, v77
  v_dot2c_f32_bf16 v11, s51, v77
  v_dot2c_f32_bf16 v12, s50, v78
  v_dot2c_f32_bf16 v13, s51, v78
  v_dot2c_f32_bf16 v14, s50, v79
  v_dot2c_f32_bf16 v15, s51, v79
  s_waitcnt vmcnt(3)
  v_dot2c_f32_bf16 v8, s50, v80
  v_dot2c_f32_bf16 v9, s51, v80
  v_dot2c_f32_bf16 v10, s50, v81
  v_dot2c_f32_bf16 v11, s51, v81
  v_dot2c_f32_bf16 v12, s50, v82
  v_dot2c_f32_bf16 v13, s51, v82
  v_dot2c_f32_bf16 v14, s50, v83
  v_dot2c_f32_bf16 v15, s51, v83
  s_waitcnt vmcnt(2)
  v_dot2c_f32_bf16 v8, s50, v84
  v_dot2c_f32_bf16 v9, s51, v84
  v_dot2c_f32_bf16 v10, s50, v85
  v_dot2c_f32_bf16 v11, s51, v85
  v_dot2c_f32_bf16 v12, s50, v86
  v_dot2c_f32_bf16 v13, s51, v86
  v_dot2c_f32_bf16 v14, s50, v87
  v_dot2c_f32_bf16 v15, s51, v87
  s_waitcnt vmcnt(1)
  v_dot2c_f32_bf16 v8, s50, v88
  v_dot2c_f32_bf16 v9, s51, v88
  v_dot2c_f32_bf16 v10, s50, v89
  v_dot2c_f32_bf16 v11, s51, v89
  v_dot2c_f32_bf16 v12, s50, v90
  v_dot2c_f32_bf16 v13, s51, v90
  v_dot2c_f32_bf16 v14, s50, v91
  v_dot2c_f32_bf16 v15, s51, v91
  s_waitcnt vmcnt(0)
  v_dot2c_f32_bf16 v8, s50, v92
  v_dot2c_f32_bf16 v9, s51, v92
  v_dot2c_f32_bf16 v10, s50, v93
  v_dot2c_f32_bf16 v11, s51, v93
  v_dot2c_f32_bf16 v12, s50, v94
  v_dot2c_f32_bf16 v13, s51, v94
  v_dot2c_f32_bf16 v14, s50, v95
  v_dot2c_f32_bf16 v15, s51, v95
  s_lshl_b32 s3, s36, 11
  v_lshrrev_b32 v1, 4, v0
  v_lshlrev_b32 v1, 9, v1
  v_lshl_add_u32 v1, v2, 5, v1
  v_add_u32 v1, s3, v1
  s_nop 1
  ds_write_b128 v1, v[8:11]
  ds_write_b128 v1, v[12:15] offset:16
  s_waitcnt lgkmcnt(0)
  s_barrier
  s_cmp_ge_u32 s36, 2
  s_cbranch_scc1 K1_HSIG
  s_lshl_b32 s3, s36, 6
  v_add_u32 v1, s3, v0
  v_lshlrev_b32 v2, 2, v1
  ds_read_b32 v16, v2 offset:0
  ds_read_b32 v17, v2 offset:512
  ds_read_b32 v18, v2 offset:1024
  ds_read_b32 v19, v2 offset:1536
  ds_read_b32 v20, v2 offset:2048
  ds_read_b32 v21, v2 offset:2560
  ds_read_b32 v22, v2 offset:3072
  ds_read_b32 v23, v2 offset:3584
  ds_read_b32 v24, v2 offset:4096
  ds_read_b32 v25, v2 offset:4608
  ds_read_b32 v26, v2 offset:5120
  ds_read_b32 v27, v2 offset:5632
  ds_read_b32 v28, v2 offset:6144
  ds_read_b32 v29, v2 offset:6656
  ds_read_b32 v30, v2 offset:7168
  ds_read_b32 v31, v2 offset:7680
  ds_read_b32 v32, v2 offset:8192
  ds_read_b32 v33, v2 offset:8704
  ds_read_b32 v34, v2 offset:9216
  ds_read_b32 v35, v2 offset:9728
  ds_read_b32 v36, v2 offset:10240
  ds_read_b32 v37, v2 offset:10752
  ds_read_b32 v38, v2 offset:11264
  ds_read_b32 v39, v2 offset:11776
  ds_read_b32 v40, v2 offset:12288
  ds_read_b32 v41, v2 offset:12800
  ds_read_b32 v42, v2 offset:13312
  ds_read_b32 v43, v2 offset:13824
  ds_read_b32 v44, v2 offset:14336
  ds_read_b32 v45, v2 offset:14848
  ds_read_b32 v46, v2 offset:15360
  ds_read_b32 v47, v2 offset:15872
  s_waitcnt lgkmcnt(0)
  v_add_f32 v16, v16, v32
  v_add_f32 v17, v17, v33
  v_add_f32 v18, v18, v34
  v_add_f32 v19, v19, v35
  v_add_f32 v20, v20, v36
  v_add_f32 v21, v21, v37
  v_add_f32 v22, v22, v38
  v_add_f32 v23, v23, v39
  v_add_f32 v24, v24, v40
  v_add_f32 v25, v25, v41
  v_add_f32 v26, v26, v42
  v_add_f32 v27, v27, v43
  v_add_f32 v28, v28, v44
  v_add_f32 v29, v29, v45
  v_add_f32 v30, v30, v46
  v_add_f32 v31, v31, v47
  v_add_f32 v16, v16, v24
  v_add_f32 v17, v17, v25
  v_add_f32 v18, v18, v26
  v_add_f32 v19, v19, v27
  v_add_f32 v20, v20, v28
  v_add_f32 v21, v21, v29
  v_add_f32 v22, v22, v30
  v_add_f32 v23, v23, v31
  v_add_f32 v16, v16, v20
  v_add_f32 v17, v17, v21
  v_add_f32 v18, v18, v22
  v_add_f32 v19, v19, v23
  v_add_f32 v16, v16, v18
  v_add_f32 v17, v17, v19
  v_add_f32 v16, v16, v17
  v_mov_b32 v3, v16
  s_lshl_b32 s3, s42, 9
  s_add_u32 s3, s3, 32768
  buffer_store_dword v3, v2, s[60:63], s3 offen sc1
  s_branch K1_HSIG
K1_HROW:
  s_mov_b32 s24, s4
  s_and_b32 s25, s5, 0xffff
  s_mov_b32 s26, 2621440
  s_mov_b32 s27, 0x00020000
  s_sub_u32 s3, s42, 27
  s_lshl_b32 s3, s3, 3
  s_add_u32 s3, s3, s36
  s_mul_i32 s48, s3, 20
  v_lshrrev_b32 v1, 4, v0
  v_add_u32 v1, s48, v1
  v_and_b32 v2, 15, v0
  v_mul_u32_u24 v3, 1280, v1
  v_lshl_add_u32 v3, v2, 4, v3
  s_mov_b32 s50, 0
  buffer_load_dwordx4 v[16:19], v3, s[24:27], s50 offen offset:0
  buffer_load_dwordx4 v[20:23], v3, s[24:27], s50 offen offset:256
  buffer_load_dwordx4 v[24:27], v3, s[24:27], s50 offen offset:512
  buffer_load_dwordx4 v[28:31], v3, s[24:27], s50 offen offset:768
  buffer_load_dwordx4 v[32:35], v3, s[24:27], s50 offen offset:1024
  s_mov_b32 s50, 5120
  buffer_load_dwordx4 v[36:39], v3, s[24:27], s50 offen offset:0
  buffer_load_dwordx4 v[40:43], v3, s[24:27], s50 offen offset:256
  buffer_load_dwordx4 v[44:47], v3, s[24:27], s50 offen offset:512
  buffer_load_dwordx4 v[48:51], v3, s[24:27], s50 offen offset:768
  buffer_load_dwordx4 v[52:55], v3, s[24:27], s50 offen offset:1024
  s_mov_b32 s50, 10240
  buffer_load_dwordx4 v[56:59], v3, s[24:27], s50 offen offset:0
  buffer_load_dwordx4 v[60:63], v3, s[24:27], s50 offen offset:256
  buffer_load_dwordx4 v[64:67], v3, s[24:27], s50 offen offset:512
  buffer_load_dwordx4 v[68:71], v3, s[24:27], s50 offen offset:768
  buffer_load_dwordx4 v[72:75], v3, s[24:27], s50 offen offset:1024
  s_mov_b32 s50, 15360
  buffer_load_dwordx4 v[76:79], v3, s[24:27], s50 offen offset:0
  buffer_load_dwordx4 v[80:83], v3, s[24:27], s50 offen offset:256
  buffer_load_dwordx4 v[84:87], v3, s[24:27], s50 offen offset:512
  buffer_load_dwordx4 v[88:91], v3, s[24:27], s50 offen offset:768
  buffer_load_dwordx4 v[92:95], v3, s[24:27], s50 offen offset:1024
  s_mov_b32 s50, 20480
  buffer_load_dwordx4 v[96:99], v3, s[24:27], s50 offen offset:0
  buffer_load_dwordx4 v[100:103], v3, s[24:27], s50 offen offset:256
  buffer_load_dwordx4 v[104:107], v3, s[24:27], s50 offen offset:512
  buffer_load_dwordx4 v[108:111], v3, s[24:27], s50 offen offset:768
  buffer_load_dwordx4 v[112:115], v3, s[24:27], s50 offen offset:1024
  s_mov_b32 s51, 0x3f803f80
  s_waitcnt vmcnt(20)
  v_mov_b32 v8, 0
  v_mov_b32 v9, 0
  v_dot2c_f32_bf16 v8, s51, v16
  v_dot2c_f32_bf16 v9, v16, v16
  v_dot2c_f32_bf16 v8, s51, v17
  v_dot2c_f32_bf16 v9, v17, v17
  v_dot2c_f32_bf16 v8, s51, v18
  v_dot2c_f32_bf16 v9, v18, v18
  v_dot2c_f32_bf16 v8, s51, v19
  v_dot2c_f32_bf16 v9, v19, v19
  v_dot2c_f32_bf16 v8, s51, v20
  v_dot2c_f32_bf16 v9, v20, v20
  v_dot2c_f32_bf16 v8, s51, v21
  v_dot2c_f32_bf16 v9, v21, v21
  v_dot2c_f32_bf16 v8, s51, v22
  v_dot2c_f32_bf16 v9, v22, v22
  v_dot2c_f32_bf16 v8, s51, v23
  v_dot2c_f32_bf16 v9, v23, v23
  v_dot2c_f32_bf16 v8, s51, v24
  v_dot2c_f32_bf16 v9, v24, v24
  v_dot2c_f32_bf16 v8, s51, v25
  v_dot2c_f32_bf16 v9, v25, v25
  v_dot2c_f32_bf16 v8, s51, v26
  v_dot2c_f32_bf16 v9, v26, v26
  v_dot2c_f32_bf16 v8, s51, v27
  v_dot2c_f32_bf16 v9, v27, v27
  v_dot2c_f32_bf16 v8, s51, v28
  v_dot2c_f32_bf16 v9, v28, v28
  v_dot2c_f32_bf16 v8, s51, v29
  v_dot2c_f32_bf16 v9, v29, v29
  v_dot2c_f32_bf16 v8, s51, v30
  v_dot2c_f32_bf16 v9, v30, v30
  v_dot2c_f32_bf16 v8, s51, v31
  v_dot2c_f32_bf16 v9, v31, v31
  v_dot2c_f32_bf16 v8, s51, v32
  v_dot2c_f32_bf16 v9, v32, v32
  v_dot2c_f32_bf16 v8, s51, v33
  v_dot2c_f32_bf16 v9, v33, v33
  v_dot2c_f32_bf16 v8, s51, v34
  v_dot2c_f32_bf16 v9, v34, v34
  v_dot2c_f32_bf16 v8, s51, v35
  v_dot2c_f32_bf16 v9, v35, v35
  s_nop 2
  v_add_f32_dpp v8, v8, v8 row_ror:8 row_mask:0xf bank_mask:0xf
  s_nop 0
  v_add_f32_dpp v9, v9, v9 row_ror:8 row_mask:0xf bank_mask:0xf
  s_nop 0
  v_add_f32_dpp v8, v8, v8 row_ror:4 row_mask:0xf bank_mask:0xf
  s_nop 0
  v_add_f32_dpp v9, v9, v9 row_ror:4 row_mask:0xf bank_mask:0xf
  s_nop 0
  v_add_f32_dpp v8, v8, v8 row_ror:2 row_mask:0xf bank_mask:0xf
  s_nop 0
  v_add_f32_dpp v9, v9, v9 row_ror:2 row_mask:0xf bank_mask:0xf
  s_nop 0
  v_add_f32_dpp v8, v8, v8 row_ror:1 row_mask:0xf bank_mask:0xf
  s_nop 0
  v_add_f32_dpp v9, v9, v9 row_ror:1 row_mask:0xf bank_mask:0xf
  s_nop 0
  s_mov_b32 s3, 986500301
  v_mul_f32 v8, s3, v8
  v_mul_f32 v9, s3, v9
  v_fma_f32 v9, -v8, v8, v9
  v_max_f32 v9, 0, v9
  v_cvt_pk_bf16_f32 v8, -v8, -v8
  v_and_b32 v8, 0xffff0000, v8
  v_cvt_pk_bf16_f32 v9, v9, v9
  v_and_b32 v9, 0xffff0000, v9
  v_add_f32 v9, 925353388, v9
  v_cvt_pk_bf16_f32 v9, v9, v9
  v_and_b32 v9, 0xffff0000, v9
  v_sqrt_f32 v9, v9
  s_nop 0
  v_cvt_pk_bf16_f32 v9, v9, v9
  v_and_b32 v9, 0xffff0000, v9
  v_rcp_f32 v9, v9
  v_add_u32 v4, 0, v1
  v_cmp_eq_u32 vcc, 0, v2
  v_mov_b32 v7, 1073741824
  v_lshlrev_b32 v5, 3, v4
  v_lshlrev_b32 v6, 2, v4
  v_add_u32 v6, 16384, v6
  s_nop 0
  v_cndmask_b32 v5, v7, v5, vcc
  v_cndmask_b32 v6, v7, v6, vcc
  v_cmp_gt_u32 vcc, 0x800, v4
  s_nop 1
  v_cndmask_b32 v5, v7, v5, vcc
  v_cndmask_b32 v6, v7, v6, vcc
  v_mov_b32 v120, v8
  v_mov_b32 v121, v9
  v_mov_b32 v132, v5
  s_mov_b32 s51, 0x3f803f80
  s_waitcnt vmcnt(15)
  v_mov_b32 v8, 0
  v_mov_b32 v9, 0
  v_dot2c_f32_bf16 v8, s51, v36
  v_dot2c_f32_bf16 v9, v36, v36
  v_dot2c_f32_bf16 v8, s51, v37
  v_dot2c_f32_bf16 v9, v37, v37
  v_dot2c_f32_bf16 v8, s51, v38
  v_dot2c_f32_bf16 v9, v38, v38
  v_dot2c_f32_bf16 v8, s51, v39
  v_dot2c_f32_bf16 v9, v39, v39
  v_dot2c_f32_bf16 v8, s51, v40
  v_dot2c_f32_bf16 v9, v40, v40
  v_dot2c_f32_bf16 v8, s51, v41
  v_dot2c_f32_bf16 v9, v41, v41
  v_dot2c_f32_bf16 v8, s51, v42
  v_dot2c_f32_bf16 v9, v42, v42
  v_dot2c_f32_bf16 v8, s51, v43
  v_dot2c_f32_bf16 v9, v43, v43
  v_dot2c_f32_bf16 v8, s51, v44
  v_dot2c_f32_bf16 v9, v44, v44
  v_dot2c_f32_bf16 v8, s51, v45
  v_dot2c_f32_bf16 v9, v45, v45
  v_dot2c_f32_bf16 v8, s51, v46
  v_dot2c_f32_bf16 v9, v46, v46
  v_dot2c_f32_bf16 v8, s51, v47
  v_dot2c_f32_bf16 v9, v47, v47
  v_dot2c_f32_bf16 v8, s51, v48
  v_dot2c_f32_bf16 v9, v48, v48
  v_dot2c_f32_bf16 v8, s51, v49
  v_dot2c_f32_bf16 v9, v49, v49
  v_dot2c_f32_bf16 v8, s51, v50
  v_dot2c_f32_bf16 v9, v50, v50
  v_dot2c_f32_bf16 v8, s51, v51
  v_dot2c_f32_bf16 v9, v51, v51
  v_dot2c_f32_bf16 v8, s51, v52
  v_dot2c_f32_bf16 v9, v52, v52
  v_dot2c_f32_bf16 v8, s51, v53
  v_dot2c_f32_bf16 v9, v53, v53
  v_dot2c_f32_bf16 v8, s51, v54
  v_dot2c_f32_bf16 v9, v54, v54
  v_dot2c_f32_bf16 v8, s51, v55
  v_dot2c_f32_bf16 v9, v55, v55
  s_nop 2
  v_add_f32_dpp v8, v8, v8 row_ror:8 row_mask:0xf bank_mask:0xf
  s_nop 0
  v_add_f32_dpp v9, v9, v9 row_ror:8 row_mask:0xf bank_mask:0xf
  s_nop 0
  v_add_f32_dpp v8, v8, v8 row_ror:4 row_mask:0xf bank_mask:0xf
  s_nop 0
  v_add_f32_dpp v9, v9, v9 row_ror:4 row_mask:0xf bank_mask:0xf
  s_nop 0
  v_add_f32_dpp v8, v8, v8 row_ror:2 row_mask:0xf bank_mask:0xf
  s_nop 0
  v_add_f32_dpp v9, v9, v9 row_ror:2 row_mask:0xf bank_mask:0xf
  s_nop 0
  v_add_f32_dpp v8, v8, v8 row_ror:1 row_mask:0xf bank_mask:0xf
  s_nop 0
  v_add_f32_dpp v9, v9, v9 row_ror:1 row_mask:0xf bank_mask:0xf
  s_nop 0
  s_mov_b32 s3, 986500301
  v_mul_f32 v8, s3, v8
  v_mul_f32 v9, s3, v9
  v_fma_f32 v9, -v8, v8, v9
  v_max_f32 v9, 0, v9
  v_cvt_pk_bf16_f32 v8, -v8, -v8
  v_and_b32 v8, 0xffff0000, v8
  v_cvt_pk_bf16_f32 v9, v9, v9
  v_and_b32 v9, 0xffff0000, v9
  v_add_f32 v9, 925353388, v9
  v_cvt_pk_bf16_f32 v9, v9, v9
  v_and_b32 v9, 0xffff0000, v9
  v_sqrt_f32 v9, v9
  s_nop 0
  v_cvt_pk_bf16_f32 v9, v9, v9
  v_and_b32 v9, 0xffff0000, v9
  v_rcp_f32 v9, v9
  v_add_u32 v4, 4, v1
  v_cmp_eq_u32 vcc, 0, v2
  v_mov_b32 v7, 1073741824
  v_lshlrev_b32 v5, 3, v4
  v_lshlrev_b32 v6, 2, v4
  v_add_u32 v6, 16384, v6
  s_nop 0
  v_cndmask_b32 v5, v7, v5, vcc
  v_cndmask_b32 v6, v7, v6, vcc
  v_cmp_gt_u32 vcc, 0x800, v4
  s_nop 1
  v_cndmask_b32 v5, v7, v5, vcc
  v_cndmask_b32 v6, v7, v6, vcc
  v_mov_b32 v122, v8
  v_mov_b32 v123, v9
  v_mov_b32 v133, v5
  s_mov_b32 s51, 0x3f803f80
  s_waitcnt vmcnt(10)
  v_mov_b32 v8, 0
  v_mov_b32 v9, 0
  v_dot2c_f32_bf16 v8, s51, v56
  v_dot2c_f32_bf16 v9, v56, v56
  v_dot2c_f32_bf16 v8, s51, v57
  v_dot2c_f32_bf16 v9, v57, v57
  v_dot2c_f32_bf16 v8, s51, v58
  v_dot2c_f32_bf16 v9, v58, v58
  v_dot2c_f32_bf16 v8, s51, v59
  v_dot2c_f32_bf16 v9, v59, v59
  v_dot2c_f32_bf16 v8, s51, v60
  v_dot2c_f32_bf16 v9, v60, v60
  v_dot2c_f32_bf16 v8, s51, v61
  v_dot2c_f32_bf16 v9, v61, v61
  v_dot2c_f32_bf16 v8, s51, v62
  v_dot2c_f32_bf16 v9, v62, v62
  v_dot2c_f32_bf16 v8, s51, v63
  v_dot2c_f32_bf16 v9, v63, v63
  v_dot2c_f32_bf16 v8, s51, v64
  v_dot2c_f32_bf16 v9, v64, v64
  v_dot2c_f32_bf16 v8, s51, v65
  v_dot2c_f32_bf16 v9, v65, v65
  v_dot2c_f32_bf16 v8, s51, v66
  v_dot2c_f32_bf16 v9, v66, v66
  v_dot2c_f32_bf16 v8, s51, v67
  v_dot2c_f32_bf16 v9, v67, v67
  v_dot2c_f32_bf16 v8, s51, v68
  v_dot2c_f32_bf16 v9, v68, v68
  v_dot2c_f32_bf16 v8, s51, v69
  v_dot2c_f32_bf16 v9, v69, v69
  v_dot2c_f32_bf16 v8, s51, v70
  v_dot2c_f32_bf16 v9, v70, v70
  v_dot2c_f32_bf16 v8, s51, v71
  v_dot2c_f32_bf16 v9, v71, v71
  v_dot2c_f32_bf16 v8, s51, v72
  v_dot2c_f32_bf16 v9, v72, v72
  v_dot2c_f32_bf16 v8, s51, v73
  v_dot2c_f32_bf16 v9, v73, v73
  v_dot2c_f32_bf16 v8, s51, v74
  v_dot2c_f32_bf16 v9, v74, v74
  v_dot2c_f32_bf16 v8, s51, v75
  v_dot2c_f32_bf16 v9, v75, v75
  s_nop 2
  v_add_f32_dpp v8, v8, v8 row_ror:8 row_mask:0xf bank_mask:0xf
  s_nop 0
  v_add_f32_dpp v9, v9, v9 row_ror:8 row_mask:0xf bank_mask:0xf
  s_nop 0
  v_add_f32_dpp v8, v8, v8 row_ror:4 row_mask:0xf bank_mask:0xf
  s_nop 0
  v_add_f32_dpp v9, v9, v9 row_ror:4 row_mask:0xf bank_mask:0xf
  s_nop 0
  v_add_f32_dpp v8, v8, v8 row_ror:2 row_mask:0xf bank_mask:0xf
  s_nop 0
  v_add_f32_dpp v9, v9, v9 row_ror:2 row_mask:0xf bank_mask:0xf
  s_nop 0
  v_add_f32_dpp v8, v8, v8 row_ror:1 row_mask:0xf bank_mask:0xf
  s_nop 0
  v_add_f32_dpp v9, v9, v9 row_ror:1 row_mask:0xf bank_mask:0xf
  s_nop 0
  s_mov_b32 s3, 986500301
  v_mul_f32 v8, s3, v8
  v_mul_f32 v9, s3, v9
  v_fma_f32 v9, -v8, v8, v9
  v_max_f32 v9, 0, v9
  v_cvt_pk_bf16_f32 v8, -v8, -v8
  v_and_b32 v8, 0xffff0000, v8
  v_cvt_pk_bf16_f32 v9, v9, v9
  v_and_b32 v9, 0xffff0000, v9
  v_add_f32 v9, 925353388, v9
  v_cvt_pk_bf16_f32 v9, v9, v9
  v_and_b32 v9, 0xffff0000, v9
  v_sqrt_f32 v9, v9
  s_nop 0
  v_cvt_pk_bf16_f32 v9, v9, v9
  v_and_b32 v9, 0xffff0000, v9
  v_rcp_f32 v9, v9
  v_add_u32 v4, 8, v1
  v_cmp_eq_u32 vcc, 0, v2
  v_mov_b32 v7, 1073741824
  v_lshlrev_b32 v5, 3, v4
  v_lshlrev_b32 v6, 2, v4
  v_add_u32 v6, 16384, v6
  s_nop 0
  v_cndmask_b32 v5, v7, v5, vcc
  v_cndmask_b32 v6, v7, v6, vcc
  v_cmp_gt_u32 vcc, 0x800, v4
  s_nop 1
  v_cndmask_b32 v5, v7, v5, vcc
  v_cndmask_b32 v6, v7, v6, vcc
  v_mov_b32 v124, v8
  v_mov_b32 v125, v9
  v_mov_b32 v134, v5
  s_mov_b32 s51, 0x3f803f80
  s_waitcnt vmcnt(5)
  v_mov_b32 v8, 0
  v_mov_b32 v9, 0
  v_dot2c_f32_bf16 v8, s51, v76
  v_dot2c_f32_bf16 v9, v76, v76
  v_dot2c_f32_bf16 v8, s51, v77
  v_dot2c_f32_bf16 v9, v77, v77
  v_dot2c_f32_bf16 v8, s51, v78
  v_dot2c_f32_bf16 v9, v78, v78
  v_dot2c_f32_bf16 v8, s51, v79
  v_dot2c_f32_bf16 v9, v79, v79
  v_dot2c_f32_bf16 v8, s51, v80
  v_dot2c_f32_bf16 v9, v80, v80
  v_dot2c_f32_bf16 v8, s51, v81
  v_dot2c_f32_bf16 v9, v81, v81
  v_dot2c_f32_bf16 v8, s51, v82
  v_dot2c_f32_bf16 v9, v82, v82
  v_dot2c_f32_bf16 v8, s51, v83
  v_dot2c_f32_bf16 v9, v83, v83
  v_dot2c_f32_bf16 v8, s51, v84
  v_dot2c_f32_bf16 v9, v84, v84
  v_dot2c_f32_bf16 v8, s51, v85
  v_dot2c_f32_bf16 v9, v85, v85
  v_dot2c_f32_bf16 v8, s51, v86
  v_dot2c_f32_bf16 v9, v86, v86
  v_dot2c_f32_bf16 v8, s51, v87
  v_dot2c_f32_bf16 v9, v87, v87
  v_dot2c_f32_bf16 v8, s51, v88
  v_dot2c_f32_bf16 v9, v88, v88
  v_dot2c_f32_bf16 v8, s51, v89
  v_dot2c_f32_bf16 v9, v89, v89
  v_dot2c_f32_bf16 v8, s51, v90
  v_dot2c_f32_bf16 v9, v90, v90
  v_dot2c_f32_bf16 v8, s51, v91
  v_dot2c_f32_bf16 v9, v91, v91
  v_dot2c_f32_bf16 v8, s51, v92
  v_dot2c_f32_bf16 v9, v92, v92
  v_dot2c_f32_bf16 v8, s51, v93
  v_dot2c_f32_bf16 v9, v93, v93
  v_dot2c_f32_bf16 v8, s51, v94
  v_dot2c_f32_bf16 v9, v94, v94
  v_dot2c_f32_bf16 v8, s51, v95
  v_dot2c_f32_bf16 v9, v95, v95
  s_nop 2
  v_add_f32_dpp v8, v8, v8 row_ror:8 row_mask:0xf bank_mask:0xf
  s_nop 0
  v_add_f32_dpp v9, v9, v9 row_ror:8 row_mask:0xf bank_mask:0xf
  s_nop 0
  v_add_f32_dpp v8, v8, v8 row_ror:4 row_mask:0xf bank_mask:0xf
  s_nop 0
  v_add_f32_dpp v9, v9, v9 row_ror:4 row_mask:0xf bank_mask:0xf
  s_nop 0
  v_add_f32_dpp v8, v8, v8 row_ror:2 row_mask:0xf bank_mask:0xf
  s_nop 0
  v_add_f32_dpp v9, v9, v9 row_ror:2 row_mask:0xf bank_mask:0xf
  s_nop 0
  v_add_f32_dpp v8, v8, v8 row_ror:1 row_mask:0xf bank_mask:0xf
  s_nop 0
  v_add_f32_dpp v9, v9, v9 row_ror:1 row_mask:0xf bank_mask:0xf
  s_nop 0
  s_mov_b32 s3, 986500301
  v_mul_f32 v8, s3, v8
  v_mul_f32 v9, s3, v9
  v_fma_f32 v9, -v8, v8, v9
  v_max_f32 v9, 0, v9
  v_cvt_pk_bf16_f32 v8, -v8, -v8
  v_and_b32 v8, 0xffff0000, v8
  v_cvt_pk_bf16_f32 v9, v9, v9
  v_and_b32 v9, 0xffff0000, v9
  v_add_f32 v9, 925353388, v9
  v_cvt_pk_bf16_f32 v9, v9, v9
  v_and_b32 v9, 0xffff0000, v9
  v_sqrt_f32 v9, v9
  s_nop 0
  v_cvt_pk_bf16_f32 v9, v9, v9
  v_and_b32 v9, 0xffff0000, v9
  v_rcp_f32 v9, v9
  v_add_u32 v4, 12, v1
  v_cmp_eq_u32 vcc, 0, v2
  v_mov_b32 v7, 1073741824
  v_lshlrev_b32 v5, 3, v4
  v_lshlrev_b32 v6, 2, v4
  v_add_u32 v6, 16384, v6
  s_nop 0
  v_cndmask_b32 v5, v7, v5, vcc
  v_cndmask_b32 v6, v7, v6, vcc
  v_cmp_gt_u32 vcc, 0x800, v4
  s_nop 1
  v_cndmask_b32 v5, v7, v5, vcc
  v_cndmask_b32 v6, v7, v6, vcc
  v_mov_b32 v126, v8
  v_mov_b32 v127, v9
  v_mov_b32 v135, v5
  s_mov_b32 s51, 0x3f803f80
  s_waitcnt vmcnt(0)
  v_mov_b32 v8, 0
  v_mov_b32 v9, 0
  v_dot2c_f32_bf16 v8, s51, v96
  v_dot2c_f32_bf16 v9, v96, v96
  v_dot2c_f32_bf16 v8, s51, v97
  v_dot2c_f32_bf16 v9, v97, v97
  v_dot2c_f32_bf16 v8, s51, v98
  v_dot2c_f32_bf16 v9, v98, v98
  v_dot2c_f32_bf16 v8, s51, v99
  v_dot2c_f32_bf16 v9, v99, v99
  v_dot2c_f32_bf16 v8, s51, v100
  v_dot2c_f32_bf16 v9, v100, v100
  v_dot2c_f32_bf16 v8, s51, v101
  v_dot2c_f32_bf16 v9, v101, v101
  v_dot2c_f32_bf16 v8, s51, v102
  v_dot2c_f32_bf16 v9, v102, v102
  v_dot2c_f32_bf16 v8, s51, v103
  v_dot2c_f32_bf16 v9, v103, v103
  v_dot2c_f32_bf16 v8, s51, v104
  v_dot2c_f32_bf16 v9, v104, v104
  v_dot2c_f32_bf16 v8, s51, v105
  v_dot2c_f32_bf16 v9, v105, v105
  v_dot2c_f32_bf16 v8, s51, v106
  v_dot2c_f32_bf16 v9, v106, v106
  v_dot2c_f32_bf16 v8, s51, v107
  v_dot2c_f32_bf16 v9, v107, v107
  v_dot2c_f32_bf16 v8, s51, v108
  v_dot2c_f32_bf16 v9, v108, v108
  v_dot2c_f32_bf16 v8, s51, v109
  v_dot2c_f32_bf16 v9, v109, v109
  v_dot2c_f32_bf16 v8, s51, v110
  v_dot2c_f32_bf16 v9, v110, v110
  v_dot2c_f32_bf16 v8, s51, v111
  v_dot2c_f32_bf16 v9, v111, v111
  v_dot2c_f32_bf16 v8, s51, v112
  v_dot2c_f32_bf16 v9, v112, v112
  v_dot2c_f32_bf16 v8, s51, v113
  v_dot2c_f32_bf16 v9, v113, v113
  v_dot2c_f32_bf16 v8, s51, v114
  v_dot2c_f32_bf16 v9, v114, v114
  v_dot2c_f32_bf16 v8, s51, v115
  v_dot2c_f32_bf16 v9, v115, v115
  s_nop 2
  v_add_f32_dpp v8, v8, v8 row_ror:8 row_mask:0xf bank_mask:0xf
  s_nop 0
  v_add_f32_dpp v9, v9, v9 row_ror:8 row_mask:0xf bank_mask:0xf
  s_nop 0
  v_add_f32_dpp v8, v8, v8 row_ror:4 row_mask:0xf bank_mask:0xf
  s_nop 0
  v_add_f32_dpp v9, v9, v9 row_ror:4 row_mask:0xf bank_mask:0xf
  s_nop 0
  v_add_f32_dpp v8, v8, v8 row_ror:2 row_mask:0xf bank_mask:0xf
  s_nop 0
  v_add_f32_dpp v9, v9, v9 row_ror:2 row_mask:0xf bank_mask:0xf
  s_nop 0
  v_add_f32_dpp v8, v8, v8 row_ror:1 row_mask:0xf bank_mask:0xf
  s_nop 0
  v_add_f32_dpp v9, v9, v9 row_ror:1 row_mask:0xf bank_mask:0xf
  s_nop 0
  s_mov_b32 s3, 986500301
  v_mul_f32 v8, s3, v8
  v_mul_f32 v9, s3, v9
  v_fma_f32 v9, -v8, v8, v9
  v_max_f32 v9, 0, v9
  v_cvt_pk_bf16_f32 v8, -v8, -v8
  v_and_b32 v8, 0xffff0000, v8
  v_cvt_pk_bf16_f32 v9, v9, v9
  v_and_b32 v9, 0xffff0000, v9
  v_add_f32 v9, 925353388, v9
  v_cvt_pk_bf16_f32 v9, v9, v9
  v_and_b32 v9, 0xffff0000, v9
  v_sqrt_f32 v9, v9
  s_nop 0
  v_cvt_pk_bf16_f32 v9, v9, v9
  v_and_b32 v9, 0xffff0000, v9
  v_rcp_f32 v9, v9
  v_add_u32 v4, 16, v1
  v_cmp_eq_u32 vcc, 0, v2
  v_mov_b32 v7, 1073741824
  v_lshlrev_b32 v5, 3, v4
  v_lshlrev_b32 v6, 2, v4
  v_add_u32 v6, 16384, v6
  s_nop 0
  v_cndmask_b32 v5, v7, v5, vcc
  v_cndmask_b32 v6, v7, v6, vcc
  v_cmp_gt_u32 vcc, 0x800, v4
  s_nop 1
  v_cndmask_b32 v5, v7, v5, vcc
  v_cndmask_b32 v6, v7, v6, vcc
  v_mov_b32 v128, v8
  v_mov_b32 v129, v9
  v_mov_b32 v136, v5
  s_mov_b32 s51, 0x3f803f80
  buffer_store_dwordx2 v[120:121], v132, s[60:63], 0 offen sc1
  buffer_store_dwordx2 v[122:123], v133, s[60:63], 0 offen sc1
  buffer_store_dwordx2 v[124:125], v134, s[60:63], 0 offen sc1
  buffer_store_dwordx2 v[126:127], v135, s[60:63], 0 offen sc1
  buffer_store_dwordx2 v[128:129], v136, s[60:63], 0 offen sc1
K1_HSIG:
  s_waitcnt vmcnt(0)
  s_barrier
  s_cmp_lg_u32 s36, 0
  s_cbranch_scc1 K1_RELAY
  v_mov_b32 v1, 0
  v_mov_b32 v2, 1
  s_mov_b64 s[50:51], exec
  s_mov_b64 exec, 1
  global_atomic_add v1, v2, s[18:19]
  s_mov_b64 exec, s[50:51]
K1_RELAY:
  s_add_u32 s32, s20, 17825792
  s_addc_u32 s33, s21, 0
  s_and_b32 s33, s33, 0xffff
  s_mov_b32 s34, 2621440
  s_mov_b32 s35, 0x00020000
  s_lshl_b32 s3, s42, 3
  s_add_u32 s3, s3, s36
  s_lshl_b32 s3, s3, 13
  v_lshlrev_b32 v1, 4, v0
  v_mov_b32 v4, -1
  v_mov_b32 v5, -1
  v_mov_b32 v6, -1
  v_mov_b32 v7, -1
  buffer_store_dwordx4 v[4:7], v1, s[32:35], s3 offen offset:0 sc1
  buffer_store_dwordx4 v[4:7], v1, s[32:35], s3 offen offset:1024 sc1
  buffer_store_dwordx4 v[4:7], v1, s[32:35], s3 offen offset:2048 sc1
  buffer_store_dwordx4 v[4:7], v1, s[32:35], s3 offen offset:3072 sc1
  s_add_u32 s3, s3, 4096
  buffer_store_dwordx4 v[4:7], v1, s[32:35], s3 offen offset:0 sc1
  buffer_store_dwordx4 v[4:7], v1, s[32:35], s3 offen offset:1024 sc1
  buffer_store_dwordx4 v[4:7], v1, s[32:35], s3 offen offset:2048 sc1
  buffer_store_dwordx4 v[4:7], v1, s[32:35], s3 offen offset:3072 sc1
  s_cmp_lt_u32 s42, 27
  s_cbranch_scc0 K1_RL_R
  s_lshl_b32 s43, s42, 1
  s_mov_b32 s44, 2
  s_branch K1_RL_C
K1_RL_R:
  s_add_u32 s43, s42, 27
  s_cmp_eq_u32 s42, 39
  s_cselect_b32 s44, 2, 1
K1_RL_C:
  s_cmp_ge_u32 s43, 48
  s_cbranch_scc1 K1_RL_WO
  s_mov_b32 s24, s14
  s_and_b32 s25, s15, 0xffff
  s_mov_b32 s26, 1966080
  s_mov_b32 s27, 0x00020000
  s_add_u32 s28, s20, 14680064
  s_addc_u32 s29, s21, 0
  s_and_b32 s29, s29, 0xffff
  s_mov_b32 s30, 1966080
  s_mov_b32 s31, 0x00020000
  s_mov_b32 s47, 48
  s_mov_b32 s45, 0
  v_lshrrev_b32 v7, 4, v0
  v_lshlrev_b32 v7, 2, v7
  s_mov_b32 s46, 2560
  s_branch K1_RL_GO
K1_RL_WO:
  s_mov_b32 s24, s8
  s_and_b32 s25, s9, 0xffff
  s_mov_b32 s26, 819200
  s_mov_b32 s27, 0x00020000
  s_add_u32 s28, s20, 16777216
  s_addc_u32 s29, s21, 0
  s_and_b32 s29, s29, 0xffff
  s_mov_b32 s30, 819200
  s_mov_b32 s31, 0x00020000
  s_sub_u32 s43, s43, 48
  s_mov_b32 s47, 20
  s_mov_b32 s45, 1
  v_lshrrev_b32 v7, 4, v0
  v_lshlrev_b32 v7, 3, v7
  s_mov_b32 s46, 640
K1_RL_GO:
  v_add_u32 v1, 0, v0
  v_mul_u32_u24 v2, 6554, v1
  v_lshrrev_b32 v2, 16, v2
  v_mul_u32_u24 v3, 10, v2
  v_sub_u32 v3, v1, v3
  v_mov_b32 v60, v2
  v_lshlrev_b32 v65, 4, v3
  v_mul_u32_u24 v2, 1280, v2
  v_lshl_add_u32 v8, v3, 4, v2
  v_add_u32 v1, 64, v0
  v_mul_u32_u24 v2, 6554, v1
  v_lshrrev_b32 v2, 16, v2
  v_mul_u32_u24 v3, 10, v2
  v_sub_u32 v3, v1, v3
  v_mov_b32 v61, v2
  v_lshlrev_b32 v66, 4, v3
  v_mul_u32_u24 v2, 1280, v2
  v_lshl_add_u32 v9, v3, 4, v2
  v_add_u32 v1, 128, v0
  v_mul_u32_u24 v2, 6554, v1
  v_lshrrev_b32 v2, 16, v2
  v_mul_u32_u24 v3, 10, v2
  v_sub_u32 v3, v1, v3
  v_mov_b32 v62, v2
  v_lshlrev_b32 v67, 4, v3
  v_mul_u32_u24 v2, 1280, v2
  v_lshl_add_u32 v10, v3, 4, v2
  v_add_u32 v1, 192, v0
  v_mul_u32_u24 v2, 6554, v1
  v_lshrrev_b32 v2, 16, v2
  v_mul_u32_u24 v3, 10, v2
  v_sub_u32 v3, v1, v3
  v_mov_b32 v63, v2
  v_lshlrev_b32 v68, 4, v3
  v_mul_u32_u24 v2, 1280, v2
  v_lshl_add_u32 v11, v3, 4, v2
  v_add_u32 v1, 256, v0
  v_mul_u32_u24 v2, 6554, v1
  v_lshrrev_b32 v2, 16, v2
  v_mul_u32_u24 v3, 10, v2
  v_sub_u32 v3, v1, v3
  v_mov_b32 v64, v2
  v_lshlrev_b32 v69, 4, v3
  v_mul_u32_u24 v2, 1280, v2
  v_lshl_add_u32 v12, v3, 4, v2
  v_bfe_u32 v1, v0, 2, 2
  v_add_u32 v1, v1, v7
  v_mul_u32_u24 v1, 160, v1
  v_and_b32 v2, 3, v0
  v_lshl_add_u32 v13, v2, 3, v1
  s_mul_i32 s3, s36, 10240
  v_add_u32 v13, s3, v13
  v_add_u32 v14, s46, v13
  v_lshlrev_b32 v15, 4, v0
  s_add_u32 s49, s43, 0
  s_mul_i32 s3, s36, s47
  s_add_u32 s3, s3, s49
  s_mul_i32 s52, s3, 5120
  s_mul_i32 s51, s36, 160
  s_cmp_eq_u32 s45, 0
  s_cbranch_scc1 K1_RL_N0
  s_mov_b32 s50, s51
  s_lshl_b32 s51, s49, 2
  v_lshrrev_b32 v1, 3, v60
  v_add_u32 v1, s51, v1
  v_and_b32 v2, 7, v60
  v_mul_u32_u24 v3, 205, v1
  v_lshrrev_b32 v3, 10, v3
  v_mul_u32_u24 v4, 5, v3
  v_sub_u32 v4, v1, v4
  v_mul_u32_u24 v3, 40, v3
  v_add_u32 v3, v3, v2
  v_lshrrev_b32 v5, 1, v4
  v_mul_u32_u24 v5, 20, v5
  v_and_b32 v6, 1, v4
  v_lshl_add_u32 v5, v6, 3, v5
  v_lshrrev_b32 v6, 2, v2
  v_lshlrev_b32 v6, 4, v6
  v_add_u32 v6, 16, v6
  v_cmp_eq_u32 vcc, 4, v4
  s_nop 1
  v_cndmask_b32 v5, v5, v6, vcc
  v_add_u32 v3, v3, v5
  v_mul_u32_u24 v3, 1280, v3
  v_add_u32 v8, v3, v65
  v_lshrrev_b32 v1, 3, v61
  v_add_u32 v1, s51, v1
  v_and_b32 v2, 7, v61
  v_mul_u32_u24 v3, 205, v1
  v_lshrrev_b32 v3, 10, v3
  v_mul_u32_u24 v4, 5, v3
  v_sub_u32 v4, v1, v4
  v_mul_u32_u24 v3, 40, v3
  v_add_u32 v3, v3, v2
  v_lshrrev_b32 v5, 1, v4
  v_mul_u32_u24 v5, 20, v5
  v_and_b32 v6, 1, v4
  v_lshl_add_u32 v5, v6, 3, v5
  v_lshrrev_b32 v6, 2, v2
  v_lshlrev_b32 v6, 4, v6
  v_add_u32 v6, 16, v6
  v_cmp_eq_u32 vcc, 4, v4
  s_nop 1
  v_cndmask_b32 v5, v5, v6, vcc
  v_add_u32 v3, v3, v5
  v_mul_u32_u24 v3, 1280, v3
  v_add_u32 v9, v3, v66
  v_lshrrev_b32 v1, 3, v62
  v_add_u32 v1, s51, v1
  v_and_b32 v2, 7, v62
  v_mul_u32_u24 v3, 205, v1
  v_lshrrev_b32 v3, 10, v3
  v_mul_u32_u24 v4, 5, v3
  v_sub_u32 v4, v1, v4
  v_mul_u32_u24 v3, 40, v3
  v_add_u32 v3, v3, v2
  v_lshrrev_b32 v5, 1, v4
  v_mul_u32_u24 v5, 20, v5
  v_and_b32 v6, 1, v4
  v_lshl_add_u32 v5, v6, 3, v5
  v_lshrrev_b32 v6, 2, v2
  v_lshlrev_b32 v6, 4, v6
  v_add_u32 v6, 16, v6
  v_cmp_eq_u32 vcc, 4, v4
  s_nop 1
  v_cndmask_b32 v5, v5, v6, vcc
  v_add_u32 v3, v3, v5
  v_mul_u32_u24 v3, 1280, v3
  v_add_u32 v10, v3, v67
  v_lshrrev_b32 v1, 3, v63
  v_add_u32 v1, s51, v1
  v_and_b32 v2, 7, v63
  v_mul_u32_u24 v3, 205, v1
  v_lshrrev_b32 v3, 10, v3
  v_mul_u32_u24 v4, 5, v3
  v_sub_u32 v4, v1, v4
  v_mul_u32_u24 v3, 40, v3
  v_add_u32 v3, v3, v2
  v_lshrrev_b32 v5, 1, v4
  v_mul_u32_u24 v5, 20, v5
  v_and_b32 v6, 1, v4
  v_lshl_add_u32 v5, v6, 3, v5
  v_lshrrev_b32 v6, 2, v2
  v_lshlrev_b32 v6, 4, v6
  v_add_u32 v6, 16, v6
  v_cmp_eq_u32 vcc, 4, v4
  s_nop 1
  v_cndmask_b32 v5, v5, v6, vcc
  v_add_u32 v3, v3, v5
  v_mul_u32_u24 v3, 1280, v3
  v_add_u32 v11, v3, v68
  v_lshrrev_b32 v1, 3, v64
  v_add_u32 v1, s51, v1
  v_and_b32 v2, 7, v64
  v_mul_u32_u24 v3, 205, v1
  v_lshrrev_b32 v3, 10, v3
  v_mul_u32_u24 v4, 5, v3
  v_sub_u32 v4, v1, v4
  v_mul_u32_u24 v3, 40, v3
  v_add_u32 v3, v3, v2
  v_lshrrev_b32 v5, 1, v4
  v_mul_u32_u24 v5, 20, v5
  v_and_b32 v6, 1, v4
  v_lshl_add_u32 v5, v6, 3, v5
  v_lshrrev_b32 v6, 2, v2
  v_lshlrev_b32 v6, 4, v6
  v_add_u32 v6, 16, v6
  v_cmp_eq_u32 vcc, 4, v4
  s_nop 1
  v_cndmask_b32 v5, v5, v6, vcc
  v_add_u32 v3, v3, v5
  v_mul_u32_u24 v3, 1280, v3
  v_add_u32 v12, v3, v69
  s_branch K1_RL_M0
K1_RL_N0:
  s_mul_i32 s50, s49, 40960
  s_add_u32 s50, s50, s51
K1_RL_M0:
  s_mul_i32 s3, s36, 10240
  s_add_u32 m0, s3, 0
  s_nop 0
  buffer_load_dwordx4 v8, s[24:27], s50 offen lds
  s_mul_i32 s3, s36, 10240
  s_add_u32 m0, s3, 1024
  s_nop 0
  buffer_load_dwordx4 v9, s[24:27], s50 offen lds
  s_mul_i32 s3, s36, 10240
  s_add_u32 m0, s3, 2048
  s_nop 0
  buffer_load_dwordx4 v10, s[24:27], s50 offen lds
  s_mul_i32 s3, s36, 10240
  s_add_u32 m0, s3, 3072
  s_nop 0
  buffer_load_dwordx4 v11, s[24:27], s50 offen lds
  s_mul_i32 s3, s36, 10240
  s_add_u32 m0, s3, 4096
  s_nop 0
  buffer_load_dwordx4 v12, s[24:27], s50 offen lds
  s_cmp_lt_u32 s44, 2
  s_cbranch_scc1 K1_RL_S1
  s_add_u32 s49, s43, 1
  s_mul_i32 s3, s36, s47
  s_add_u32 s3, s3, s49
  s_mul_i32 s53, s3, 5120
  s_mul_i32 s51, s36, 160
  s_cmp_eq_u32 s45, 0
  s_cbranch_scc1 K1_RL_N1
  s_mov_b32 s50, s51
  s_lshl_b32 s51, s49, 2
  v_lshrrev_b32 v1, 3, v60
  v_add_u32 v1, s51, v1
  v_and_b32 v2, 7, v60
  v_mul_u32_u24 v3, 205, v1
  v_lshrrev_b32 v3, 10, v3
  v_mul_u32_u24 v4, 5, v3
  v_sub_u32 v4, v1, v4
  v_mul_u32_u24 v3, 40, v3
  v_add_u32 v3, v3, v2
  v_lshrrev_b32 v5, 1, v4
  v_mul_u32_u24 v5, 20, v5
  v_and_b32 v6, 1, v4
  v_lshl_add_u32 v5, v6, 3, v5
  v_lshrrev_b32 v6, 2, v2
  v_lshlrev_b32 v6, 4, v6
  v_add_u32 v6, 16, v6
  v_cmp_eq_u32 vcc, 4, v4
  s_nop 1
  v_cndmask_b32 v5, v5, v6, vcc
  v_add_u32 v3, v3, v5
  v_mul_u32_u24 v3, 1280, v3
  v_add_u32 v8, v3, v65
  v_lshrrev_b32 v1, 3, v61
  v_add_u32 v1, s51, v1
  v_and_b32 v2, 7, v61
  v_mul_u32_u24 v3, 205, v1
  v_lshrrev_b32 v3, 10, v3
  v_mul_u32_u24 v4, 5, v3
  v_sub_u32 v4, v1, v4
  v_mul_u32_u24 v3, 40, v3
  v_add_u32 v3, v3, v2
  v_lshrrev_b32 v5, 1, v4
  v_mul_u32_u24 v5, 20, v5
  v_and_b32 v6, 1, v4
  v_lshl_add_u32 v5, v6, 3, v5
  v_lshrrev_b32 v6, 2, v2
  v_lshlrev_b32 v6, 4, v6
  v_add_u32 v6, 16, v6
  v_cmp_eq_u32 vcc, 4, v4
  s_nop 1
  v_cndmask_b32 v5, v5, v6, vcc
  v_add_u32 v3, v3, v5
  v_mul_u32_u24 v3, 1280, v3
  v_add_u32 v9, v3, v66
  v_lshrrev_b32 v1, 3, v62
  v_add_u32 v1, s51, v1
  v_and_b32 v2, 7, v62
  v_mul_u32_u24 v3, 205, v1
  v_lshrrev_b32 v3, 10, v3
  v_mul_u32_u24 v4, 5, v3
  v_sub_u32 v4, v1, v4
  v_mul_u32_u24 v3, 40, v3
  v_add_u32 v3, v3, v2
  v_lshrrev_b32 v5, 1, v4
  v_mul_u32_u24 v5, 20, v5
  v_and_b32 v6, 1, v4
  v_lshl_add_u32 v5, v6, 3, v5
  v_lshrrev_b32 v6, 2, v2
  v_lshlrev_b32 v6, 4, v6
  v_add_u32 v6, 16, v6
  v_cmp_eq_u32 vcc, 4, v4
  s_nop 1
  v_cndmask_b32 v5, v5, v6, vcc
  v_add_u32 v3, v3, v5
  v_mul_u32_u24 v3, 1280, v3
  v_add_u32 v10, v3, v67
  v_lshrrev_b32 v1, 3, v63
  v_add_u32 v1, s51, v1
  v_and_b32 v2, 7, v63
  v_mul_u32_u24 v3, 205, v1
  v_lshrrev_b32 v3, 10, v3
  v_mul_u32_u24 v4, 5, v3
  v_sub_u32 v4, v1, v4
  v_mul_u32_u24 v3, 40, v3
  v_add_u32 v3, v3, v2
  v_lshrrev_b32 v5, 1, v4
  v_mul_u32_u24 v5, 20, v5
  v_and_b32 v6, 1, v4
  v_lshl_add_u32 v5, v6, 3, v5
  v_lshrrev_b32 v6, 2, v2
  v_lshlrev_b32 v6, 4, v6
  v_add_u32 v6, 16, v6
  v_cmp_eq_u32 vcc, 4, v4
  s_nop 1
  v_cndmask_b32 v5, v5, v6, vcc
  v_add_u32 v3, v3, v5
  v_mul_u32_u24 v3, 1280, v3
  v_add_u32 v11, v3, v68
  v_lshrrev_b32 v1, 3, v64
  v_add_u32 v1, s51, v1
  v_and_b32 v2, 7, v64
  v_mul_u32_u24 v3, 205, v1
  v_lshrrev_b32 v3, 10, v3
  v_mul_u32_u24 v4, 5, v3
  v_sub_u32 v4, v1, v4
  v_mul_u32_u24 v3, 40, v3
  v_add_u32 v3, v3, v2
  v_lshrrev_b32 v5, 1, v4
  v_mul_u32_u24 v5, 20, v5
  v_and_b32 v6, 1, v4
  v_lshl_add_u32 v5, v6, 3, v5
  v_lshrrev_b32 v6, 2, v2
  v_lshlrev_b32 v6, 4, v6
  v_add_u32 v6, 16, v6
  v_cmp_eq_u32 vcc, 4, v4
  s_nop 1
  v_cndmask_b32 v5, v5, v6, vcc
  v_add_u32 v3, v3, v5
  v_mul_u32_u24 v3, 1280, v3
  v_add_u32 v12, v3, v69
  s_branch K1_RL_M1
K1_RL_N1:
  s_mul_i32 s50, s49, 40960
  s_add_u32 s50, s50, s51
K1_RL_M1:
  s_mul_i32 s3, s36, 10240
  s_add_u32 m0, s3, 5120
  s_nop 0
  buffer_load_dwordx4 v8, s[24:27], s50 offen lds
  s_mul_i32 s3, s36, 10240
  s_add_u32 m0, s3, 6144
  s_nop 0
  buffer_load_dwordx4 v9, s[24:27], s50 offen lds
  s_mul_i32 s3, s36, 10240
  s_add_u32 m0, s3, 7168
  s_nop 0
  buffer_load_dwordx4 v10, s[24:27], s50 offen lds
  s_mul_i32 s3, s36, 10240
  s_add_u32 m0, s3, 8192
  s_nop 0
  buffer_load_dwordx4 v11, s[24:27], s50 offen lds
  s_mul_i32 s3, s36, 10240
  s_add_u32 m0, s3, 9216
  s_nop 0
  buffer_load_dwordx4 v12, s[24:27], s50 offen lds
K1_RL_S1:
  s_waitcnt vmcnt(0)
  ds_read_b64_tr_b16 v[16:17], v13 offset:0
  ds_read_b64_tr_b16 v[18:19], v14 offset:0
  ds_read_b64_tr_b16 v[20:21], v13 offset:32
  ds_read_b64_tr_b16 v[22:23], v14 offset:32
  ds_read_b64_tr_b16 v[24:25], v13 offset:64
  ds_read_b64_tr_b16 v[26:27], v14 offset:64
  ds_read_b64_tr_b16 v[28:29], v13 offset:96
  ds_read_b64_tr_b16 v[30:31], v14 offset:96
  ds_read_b64_tr_b16 v[32:33], v13 offset:128
  ds_read_b64_tr_b16 v[34:35], v14 offset:128
  ds_read_b64_tr_b16 v[36:37], v13 offset:5120
  ds_read_b64_tr_b16 v[38:39], v14 offset:5120
  ds_read_b64_tr_b16 v[40:41], v13 offset:5152
  ds_read_b64_tr_b16 v[42:43], v14 offset:5152
  ds_read_b64_tr_b16 v[44:45], v13 offset:5184
  ds_read_b64_tr_b16 v[46:47], v14 offset:5184
  ds_read_b64_tr_b16 v[48:49], v13 offset:5216
  ds_read_b64_tr_b16 v[50:51], v14 offset:5216
  ds_read_b64_tr_b16 v[52:53], v13 offset:5248
  ds_read_b64_tr_b16 v[54:55], v14 offset:5248
  s_waitcnt lgkmcnt(0)
  buffer_store_dwordx4 v[16:19], v15, s[28:31], s52 offen offset:0
  buffer_store_dwordx4 v[20:23], v15, s[28:31], s52 offen offset:1024
  buffer_store_dwordx4 v[24:27], v15, s[28:31], s52 offen offset:2048
  buffer_store_dwordx4 v[28:31], v15, s[28:31], s52 offen offset:3072
  s_add_u32 s3, s52, 4096
  buffer_store_dwordx4 v[32:35], v15, s[28:31], s3 offen
  s_cmp_lt_u32 s44, 2
  s_cbranch_scc1 K1_FIN
  buffer_store_dwordx4 v[36:39], v15, s[28:31], s53 offen offset:0
  buffer_store_dwordx4 v[40:43], v15, s[28:31], s53 offen offset:1024
  buffer_store_dwordx4 v[44:47], v15, s[28:31], s53 offen offset:2048
  buffer_store_dwordx4 v[48:51], v15, s[28:31], s53 offen offset:3072
  s_add_u32 s3, s53, 4096
  buffer_store_dwordx4 v[52:55], v15, s[28:31], s3 offen
K1_FIN:
K1_END:
  s_endpgm
.section .rodata,"a"
.p2align 6
.amdhsa_kernel recurrent_scan__softmax_full_mha__dense_activation_relu__prompt_kernel
  .amdhsa_next_free_vgpr 256
  .amdhsa_next_free_sgpr 102
  .amdhsa_accum_offset 256
  .amdhsa_group_segment_fixed_size 0
  .amdhsa_kernarg_size 72
  .amdhsa_user_sgpr_count 2
  .amdhsa_user_sgpr_kernarg_segment_ptr 1
  .amdhsa_system_sgpr_workgroup_id_x 1
  .amdhsa_float_denorm_mode_32 3
.end_amdhsa_kernel
.text
.globl attn_kernel
.p2align 8
.type attn_kernel,@function
attn_kernel:
  s_cmp_ge_u32 s2, 256
  s_cbranch_scc1 K2_END
  s_load_dwordx2 s[20:21], s[0:1], 64
  s_load_dwordx2 s[12:13], s[0:1], 0
  s_load_dwordx2 s[14:15], s[0:1], 48
  v_lshrrev_b32 v1, 6, v0
  v_and_b32 v0, 63, v0
  s_and_b32 s3, s2, 7
  s_lshr_b32 s4, s2, 3
  v_readfirstlane_b32 s36, v1
  s_and_b32 s40, s4, 7
  s_lshr_b32 s4, s4, 3
  s_lshl_b32 s3, s3, 2
  s_add_u32 s39, s3, s4
  s_cmp_lg_u32 s36, 0
  s_cbranch_scc1 K2_NOCLR
  v_lshlrev_b32 v2, 3, v0
  v_add_u32 v2, 158720, v2
  v_mov_b32 v4, 0
  v_mov_b32 v5, 0
  ds_write_b64 v2, v[4:5]
  s_waitcnt lgkmcnt(0)
K2_NOCLR:
  s_cmp_ge_u32 s36, 8
  s_cbranch_scc1 K2_FFN
  s_and_b32 s37, s36, 3
  s_lshr_b32 s38, s36, 2
  v_and_b32 v1, 31, v0
  v_lshrrev_b32 v2, 5, v0
  s_lshl_b32 s3, s40, 8
  s_lshl_b32 s4, s37, 6
  s_add_u32 s3, s3, s4
  v_and_b32 v3, 15, v1
  v_lshlrev_b32 v3, 1, v3
  v_lshrrev_b32 v5, 4, v1
  v_add_u32 v3, v3, v5
  v_add_u32 v3, s3, v3
  s_mul_i32 s4, s39, 81920
  v_lshlrev_b32 v5, 3, v3
  v_lshl_add_u32 v4, v2, 15, v5
  v_add_u32 v6, 16384, v4
  v_add_u32 v5, 65536, v5
  s_waitcnt lgkmcnt(0)
  s_add_u32 s28, s20, 5767168
  s_addc_u32 s29, s21, 0
  s_and_b32 s29, s29, 0xffff
  s_mov_b32 s30, 2621440
  s_mov_b32 s31, 0x00020000
  buffer_load_dwordx2 v[144:145], v4, s[28:31], s4 offen offset:0
  buffer_load_dwordx2 v[146:147], v6, s[28:31], s4 offen offset:0
  buffer_load_dwordx2 v[148:149], v5, s[28:31], s4 offen offset:0
  buffer_load_dwordx2 v[152:153], v4, s[28:31], s4 offen offset:256
  buffer_load_dwordx2 v[154:155], v6, s[28:31], s4 offen offset:256
  buffer_load_dwordx2 v[156:157], v5, s[28:31], s4 offen offset:256
  s_add_u32 s32, s20, 17825792
  s_addc_u32 s33, s21, 0
  s_and_b32 s33, s33, 0xffff
  s_mov_b32 s34, 2621440
  s_mov_b32 s35, 0x00020000
  s_mul_i32 s3, s38, 30720
  v_lshlrev_b32 v3, 3, v1
  v_lshl_add_u32 v3, v2, 11, v3
  v_add_u32 v160, s3, v3
  v_lshlrev_b32 v4, 3, v1
  v_add_u32 v4, 4096, v4
  v_add_u32 v161, s3, v4
  v_mul_u32_u24 v6, 320, v2
  v_lshl_add_u32 v5, v1, 4, v6
  v_add_u32 v5, 5120, v5
  v_add_u32 v162, s3, v5
  v_mov_b32 v7, v3
  v_mov_b32 v8, v4
  v_mov_b32 v167, 1
  s_mul_i32 s3, s38, 96
  s_add_u32 s3, s3, 158720
  v_mov_b32 v166, s3
  s_mov_b32 s56, 0x000fffff
  s_mov_b32 s57, 0x000fffff
  s_mov_b32 s41, 0
  v_mov_b32 v134, 0x3f803f80
  v_mov_b32 v135, 0x00003f80
  v_mov_b32 v150, 0
  v_mov_b32 v151, 0
  v_mov_b32 v158, 0
  v_mov_b32 v159, 0
  v_mov_b32 v80, 0
  v_mov_b32 v81, 0
  v_mov_b32 v82, 0
  v_mov_b32 v83, 0
  v_mov_b32 v84, 0
  v_mov_b32 v85, 0
  v_mov_b32 v86, 0
  v_mov_b32 v87, 0
  v_mov_b32 v88, 0
  v_mov_b32 v89, 0
  v_mov_b32 v90, 0
  v_mov_b32 v91, 0
  v_mov_b32 v92, 0
  v_mov_b32 v93, 0
  v_mov_b32 v94, 0
  v_mov_b32 v95, 0
  v_mov_b32 v96, 0
  v_mov_b32 v97, 0
  v_mov_b32 v98, 0
  v_mov_b32 v99, 0
  v_mov_b32 v100, 0
  v_mov_b32 v101, 0
  v_mov_b32 v102, 0
  v_mov_b32 v103, 0
  v_mov_b32 v104, 0
  v_mov_b32 v105, 0
  v_mov_b32 v106, 0
  v_mov_b32 v107, 0
  v_mov_b32 v108, 0
  v_mov_b32 v109, 0
  v_mov_b32 v110, 0
  v_mov_b32 v111, 0
  v_mov_b32 v120, 0
  v_mov_b32 v121, 0
  v_mov_b32 v122, 0
  v_mov_b32 v123, 0
  v_mov_b32 v124, 0
  v_mov_b32 v125, 0
  v_mov_b32 v126, 0
  v_mov_b32 v127, 0
  v_cmp_eq_u32 vcc, 20, v1
  v_mov_b32 v12, 0x3f803f80
  s_nop 0
  v_cndmask_b32 v136, 0, v12, vcc
  v_cndmask_b32 v137, 0, v12, vcc
  v_cndmask_b32 v138, 0, v12, vcc
  v_cndmask_b32 v139, 0, v12, vcc
  v_cndmask_b32 v140, 0, v12, vcc
  v_cndmask_b32 v141, 0, v12, vcc
  v_cndmask_b32 v142, 0, v12, vcc
  v_cndmask_b32 v143, 0, v12, vcc
  v_mov_b32 v163, v160
  v_mov_b32 v164, v161
  v_mov_b32 v165, v162
  v_lshrrev_b32 v6, 4, v1
  v_mul_u32_u24 v6, 20480, v6
  v_and_b32 v9, 15, v1
  v_lshl_add_u32 v6, v9, 4, v6
  s_lshr_b32 s3, s39, 1
  s_mul_i32 s3, s3, 5
  s_and_b32 s4, s39, 1
  s_lshl_b32 s5, s4, 1
  s_add_u32 s5, s5, s3
  v_add_u32 v9, s5, v2
  v_lshrrev_b32 v10, 2, v9
  v_lshl_add_u32 v10, v10, 10, v6
  v_and_b32 v9, 3, v9
  v_lshl_add_u32 v3, v9, 8, v10
  s_add_u32 s3, s3, 4
  s_lshr_b32 s5, s3, 2
  s_lshl_b32 s5, s5, 10
  s_and_b32 s3, s3, 3
  s_lshl_b32 s3, s3, 8
  s_add_u32 s3, s3, s5
  s_lshl_b32 s4, s4, 3
  s_add_u32 s3, s3, s4
  v_cmp_lt_u32 vcc, 31, v0
  v_add_u32 v4, s3, v6
  s_nop 0
  v_cndmask_b32 v4, v4, -1, vcc
  s_lshl_b32 s3, s40, 3
  s_lshl_b32 s4, s37, 1
  s_add_u32 s3, s3, s4
  s_add_u32 s3, s3, s38
  s_mul_i32 s62, s3, 40960
  s_mul_i32 s3, s36, 3072
  s_cmp_ge_u32 s36, 6
  s_cselect_b32 s4, 12288, 0
  s_add_u32 s63, s3, s4
  s_xor_b32 s5, s36, 4
  s_mul_i32 s4, s5, 3072
  s_cmp_ge_u32 s5, 6
  s_cselect_b32 s5, 12288, 0
  s_add_u32 s55, s4, s5
  v_mov_b32 v9, 158720
  s_waitcnt vmcnt(0)
  v_cmp_lt_u32 vcc, 31, v0
  s_nop 1
  v_cndmask_b32 v148, v148, 0, vcc
  v_cndmask_b32 v149, v149, 0, vcc
  v_cndmask_b32 v156, v156, 0, vcc
  v_cndmask_b32 v157, v157, 0, vcc
  s_barrier
  s_mov_b32 s9, 262144
K2_SP0:
  ds_read_b32 v10, v9 offset:0
  s_waitcnt lgkmcnt(0)
  v_readfirstlane_b32 s10, v10
  s_sub_u32 s9, s9, 1
  s_cmp_eq_u32 s9, 0
  s_cbranch_scc1 K2_SX0
  s_cmp_ge_u32 s10, 2
  s_cbranch_scc1 K2_SX0
  s_sleep 1
  s_branch K2_SP0
K2_SX0:
  ds_read2_b64 v[128:131], v7 offset0:0 offset1:128
  ds_read_b64 v[132:133], v8
  s_waitcnt lgkmcnt(0)
  v_mfma_f32_32x32x16_bf16 v[16:31], v[128:131], v[144:147], 0
  v_mfma_f32_32x32x16_bf16 v[32:47], v[128:131], v[152:155], 0
  v_mfma_f32_32x32x16_bf16 v[16:31], v[132:135], v[148:151], v[16:31]
  v_mfma_f32_32x32x16_bf16 v[32:47], v[132:135], v[156:159], v[32:47]
  s_nop 11
  v_max3_f32 v13, v16, v17, v18
  v_max3_f32 v13, v13, v19, v20
  v_max3_f32 v13, v13, v21, v22
  v_max3_f32 v13, v13, v23, v24
  v_max3_f32 v13, v13, v25, v26
  v_max3_f32 v13, v13, v27, v28
  v_max3_f32 v13, v13, v29, v30
  v_max_f32 v13, v13, v31
  v_max3_f32 v14, v32, v33, v34
  v_max3_f32 v14, v14, v35, v36
  v_max3_f32 v14, v14, v37, v38
  v_max3_f32 v14, v14, v39, v40
  v_max3_f32 v14, v14, v41, v42
  v_max3_f32 v14, v14, v43, v44
  v_max3_f32 v14, v14, v45, v46
  v_max_f32 v14, v14, v47
  v_mov_b32 v11, v13
  v_mov_b32 v12, v14
  s_nop 0
  v_permlane32_swap_b32 v11, v13
  v_permlane32_swap_b32 v12, v14
  v_cmp_lt_u32 vcc, 31, v0
  v_max_f32 v13, v11, v13
  v_max_f32 v14, v12, v14
  v_cvt_pk_bf16_f32 v11, -v13, -v13
  v_and_b32 v11, 0xffff0000, v11
  v_sub_f32 v12, -v13, v11
  v_cvt_pk_bf16_f32 v10, v12, v12
  v_and_b32 v10, 0xffff0000, v10
  v_sub_f32 v12, v12, v10
  v_cvt_pk_bf16_f32 v12, v12, v12
  v_and_b32 v12, 0xffff, v12
  v_lshrrev_b32 v11, 16, v11
  v_or_b32 v11, v11, v10
  v_cndmask_b32 v150, v11, 0, vcc
  v_cndmask_b32 v151, v12, 0, vcc
  v_cvt_pk_bf16_f32 v11, -v14, -v14
  v_and_b32 v11, 0xffff0000, v11
  v_sub_f32 v12, -v14, v11
  v_cvt_pk_bf16_f32 v10, v12, v12
  v_and_b32 v10, 0xffff0000, v10
  v_sub_f32 v12, v12, v10
  v_cvt_pk_bf16_f32 v12, v12, v12
  v_and_b32 v12, 0xffff, v12
  v_lshrrev_b32 v11, 16, v11
  v_or_b32 v11, v11, v10
  v_cndmask_b32 v158, v11, 0, vcc
  v_cndmask_b32 v159, v12, 0, vcc
K2_HAVEC:
  s_mov_b32 s9, 262144
K2_SP1:
  ds_read_b32 v10, v166 offset:0
  s_waitcnt lgkmcnt(0)
  v_readfirstlane_b32 s10, v10
  s_sub_u32 s9, s9, 1
  s_cmp_eq_u32 s9, 0
  s_cbranch_scc1 K2_SX1
  s_cmp_ge_u32 s10, 2
  s_cbranch_scc1 K2_SX1
  s_sleep 1
  s_branch K2_SP1
K2_SX1:
  ds_read2_b64 v[128:131], v163 offset0:0 offset1:128
  ds_read_b64 v[132:133], v164
  s_waitcnt lgkmcnt(0)
  v_mfma_f32_32x32x16_bf16 v[16:31], v[128:131], v[144:147], 0
  v_mfma_f32_32x32x16_bf16 v[16:31], v[132:135], v[148:151], v[16:31]
  s_mov_b32 s42, 0
  s_mov_b32 s43, 0
  s_nop 8
K2_LOOP:
  v_mfma_f32_32x32x16_bf16 v[32:47], v[128:131], v[152:155], 0
  v_exp_f32 v16, v16
  v_exp_f32 v17, v17
  v_exp_f32 v18, v18
  v_exp_f32 v19, v19
  v_mfma_f32_32x32x16_bf16 v[32:47], v[132:135], v[156:159], v[32:47]
  v_exp_f32 v20, v20
  v_exp_f32 v21, v21
  ds_read2_b64 v[128:131], v163 offset0:32 offset1:160
  ds_read_b64 v[132:133], v164 offset:256
  v_exp_f32 v22, v22
  v_exp_f32 v23, v23
  v_cvt_pk_bf16_f32 v112, v16, v17
  v_cvt_pk_bf16_f32 v113, v18, v19
  v_mfma_f32_32x32x16_bf16 v[96:111], v[136:139], v[120:123], v[96:111]
  v_exp_f32 v24, v24
  v_exp_f32 v25, v25
  v_exp_f32 v26, v26
  v_exp_f32 v27, v27
  v_cvt_pk_bf16_f32 v114, v20, v21
  v_cvt_pk_bf16_f32 v115, v22, v23
  v_mfma_f32_32x32x16_bf16 v[96:111], v[140:143], v[124:127], v[96:111]
  v_exp_f32 v28, v28
  v_exp_f32 v29, v29
  s_mov_b64 exec, s[56:57]
  ds_read_b128 v[136:139], v165 offset:0
  ds_read_b128 v[140:143], v165 offset:640
  s_mov_b64 exec, -1
  v_exp_f32 v30, v30
  v_exp_f32 v31, v31
  v_cvt_pk_bf16_f32 v116, v24, v25
  v_cvt_pk_bf16_f32 v117, v26, v27
  v_cvt_pk_bf16_f32 v118, v28, v29
  v_cvt_pk_bf16_f32 v119, v30, v31
  s_waitcnt lgkmcnt(2)
  v_mfma_f32_32x32x16_bf16 v[16:31], v[128:131], v[144:147], 0
  v_exp_f32 v32, v32
  v_exp_f32 v33, v33
  v_exp_f32 v34, v34
  v_exp_f32 v35, v35
  v_mfma_f32_32x32x16_bf16 v[16:31], v[132:135], v[148:151], v[16:31]
  v_exp_f32 v36, v36
  v_exp_f32 v37, v37
  v_exp_f32 v38, v38
  v_exp_f32 v39, v39
  v_cvt_pk_bf16_f32 v120, v32, v33
  v_cvt_pk_bf16_f32 v121, v34, v35
  s_waitcnt lgkmcnt(0)
  v_mfma_f32_32x32x16_bf16 v[80:95], v[136:139], v[112:115], v[80:95]
  v_exp_f32 v40, v40
  v_exp_f32 v41, v41
  v_exp_f32 v42, v42
  v_exp_f32 v43, v43
  v_cvt_pk_bf16_f32 v122, v36, v37
  v_cvt_pk_bf16_f32 v123, v38, v39
  v_mfma_f32_32x32x16_bf16 v[80:95], v[140:143], v[116:119], v[80:95]
  v_exp_f32 v44, v44
  v_exp_f32 v45, v45
  v_exp_f32 v46, v46
  v_exp_f32 v47, v47
  v_cvt_pk_bf16_f32 v124, v40, v41
  v_cvt_pk_bf16_f32 v125, v42, v43
  v_cvt_pk_bf16_f32 v126, v44, v45
  v_cvt_pk_bf16_f32 v127, v46, v47
  v_mfma_f32_32x32x16_bf16 v[32:47], v[128:131], v[152:155], 0
  v_exp_f32 v16, v16
  v_exp_f32 v17, v17
  v_exp_f32 v18, v18
  v_exp_f32 v19, v19
  v_mfma_f32_32x32x16_bf16 v[32:47], v[132:135], v[156:159], v[32:47]
  v_exp_f32 v20, v20
  v_exp_f32 v21, v21
  ds_read2_b64 v[128:131], v163 offset0:64 offset1:192
  ds_read_b64 v[132:133], v164 offset:512
  v_exp_f32 v22, v22
  v_exp_f32 v23, v23
  v_cvt_pk_bf16_f32 v112, v16, v17
  v_cvt_pk_bf16_f32 v113, v18, v19
  v_mfma_f32_32x32x16_bf16 v[96:111], v[136:139], v[120:123], v[96:111]
  v_exp_f32 v24, v24
  v_exp_f32 v25, v25
  v_exp_f32 v26, v26
  v_exp_f32 v27, v27
  v_cvt_pk_bf16_f32 v114, v20, v21
  v_cvt_pk_bf16_f32 v115, v22, v23
  v_mfma_f32_32x32x16_bf16 v[96:111], v[140:143], v[124:127], v[96:111]
  v_exp_f32 v28, v28
  v_exp_f32 v29, v29
  s_mov_b64 exec, s[56:57]
  ds_read_b128 v[136:139], v165 offset:1280
  ds_read_b128 v[140:143], v165 offset:1920
  s_mov_b64 exec, -1
  v_exp_f32 v30, v30
  v_exp_f32 v31, v31
  v_cvt_pk_bf16_f32 v116, v24, v25
  v_cvt_pk_bf16_f32 v117, v26, v27
  v_cvt_pk_bf16_f32 v118, v28, v29
  v_cvt_pk_bf16_f32 v119, v30, v31
  s_waitcnt lgkmcnt(2)
  v_mfma_f32_32x32x16_bf16 v[16:31], v[128:131], v[144:147], 0
  v_exp_f32 v32, v32
  v_exp_f32 v33, v33
  v_exp_f32 v34, v34
  v_exp_f32 v35, v35
  v_mfma_f32_32x32x16_bf16 v[16:31], v[132:135], v[148:151], v[16:31]
  v_exp_f32 v36, v36
  v_exp_f32 v37, v37
  v_exp_f32 v38, v38
  v_exp_f32 v39, v39
  v_cvt_pk_bf16_f32 v120, v32, v33
  v_cvt_pk_bf16_f32 v121, v34, v35
  s_waitcnt lgkmcnt(0)
  v_mfma_f32_32x32x16_bf16 v[80:95], v[136:139], v[112:115], v[80:95]
  v_exp_f32 v40, v40
  v_exp_f32 v41, v41
  v_exp_f32 v42, v42
  v_exp_f32 v43, v43
  v_cvt_pk_bf16_f32 v122, v36, v37
  v_cvt_pk_bf16_f32 v123, v38, v39
  v_mfma_f32_32x32x16_bf16 v[80:95], v[140:143], v[116:119], v[80:95]
  v_exp_f32 v44, v44
  v_exp_f32 v45, v45
  v_exp_f32 v46, v46
  v_exp_f32 v47, v47
  v_cvt_pk_bf16_f32 v124, v40, v41
  v_cvt_pk_bf16_f32 v125, v42, v43
  v_cvt_pk_bf16_f32 v126, v44, v45
  v_cvt_pk_bf16_f32 v127, v46, v47
  v_mfma_f32_32x32x16_bf16 v[32:47], v[128:131], v[152:155], 0
  v_exp_f32 v16, v16
  v_exp_f32 v17, v17
  v_exp_f32 v18, v18
  v_exp_f32 v19, v19
  v_mfma_f32_32x32x16_bf16 v[32:47], v[132:135], v[156:159], v[32:47]
  v_exp_f32 v20, v20
  v_exp_f32 v21, v21
  ds_read2_b64 v[128:131], v163 offset0:96 offset1:224
  ds_read_b64 v[132:133], v164 offset:768
  v_exp_f32 v22, v22
  v_exp_f32 v23, v23
  v_cvt_pk_bf16_f32 v112, v16, v17
  v_cvt_pk_bf16_f32 v113, v18, v19
  v_mfma_f32_32x32x16_bf16 v[96:111], v[136:139], v[120:123], v[96:111]
  v_exp_f32 v24, v24
  v_exp_f32 v25, v25
  v_exp_f32 v26, v26
  v_exp_f32 v27, v27
  v_cvt_pk_bf16_f32 v114, v20, v21
  v_cvt_pk_bf16_f32 v115, v22, v23
  v_mfma_f32_32x32x16_bf16 v[96:111], v[140:143], v[124:127], v[96:111]
  v_exp_f32 v28, v28
  v_exp_f32 v29, v29
  s_mov_b64 exec, s[56:57]
  ds_read_b128 v[136:139], v165 offset:2560
  ds_read_b128 v[140:143], v165 offset:3200
  s_mov_b64 exec, -1
  ds_read_b32 v15, v166 offset:4
  v_exp_f32 v30, v30
  v_exp_f32 v31, v31
  v_cvt_pk_bf16_f32 v116, v24, v25
  v_cvt_pk_bf16_f32 v117, v26, v27
  v_cvt_pk_bf16_f32 v118, v28, v29
  v_cvt_pk_bf16_f32 v119, v30, v31
  s_waitcnt lgkmcnt(3)
  v_mfma_f32_32x32x16_bf16 v[16:31], v[128:131], v[144:147], 0
  v_exp_f32 v32, v32
  v_exp_f32 v33, v33
  v_exp_f32 v34, v34
  v_exp_f32 v35, v35
  v_mfma_f32_32x32x16_bf16 v[16:31], v[132:135], v[148:151], v[16:31]
  v_exp_f32 v36, v36
  v_exp_f32 v37, v37
  v_exp_f32 v38, v38
  v_exp_f32 v39, v39
  v_cvt_pk_bf16_f32 v120, v32, v33
  v_cvt_pk_bf16_f32 v121, v34, v35
  s_waitcnt lgkmcnt(1)
  v_mfma_f32_32x32x16_bf16 v[80:95], v[136:139], v[112:115], v[80:95]
  v_exp_f32 v40, v40
  v_exp_f32 v41, v41
  v_exp_f32 v42, v42
  v_exp_f32 v43, v43
  v_cvt_pk_bf16_f32 v122, v36, v37
  v_cvt_pk_bf16_f32 v123, v38, v39
  s_waitcnt lgkmcnt(0)
  v_mfma_f32_32x32x16_bf16 v[80:95], v[140:143], v[116:119], v[80:95]
  v_exp_f32 v44, v44
  v_exp_f32 v45, v45
  v_exp_f32 v46, v46
  v_exp_f32 v47, v47
  v_cvt_pk_bf16_f32 v124, v40, v41
  v_cvt_pk_bf16_f32 v125, v42, v43
  v_cvt_pk_bf16_f32 v126, v44, v45
  v_cvt_pk_bf16_f32 v127, v46, v47
  v_readfirstlane_b32 s10, v15
  s_cmp_eq_u32 s42, 7
  s_cselect_b32 s44, 0, 2
  s_add_u32 s43, s43, 1
  s_cmp_eq_u32 s43, 3
  s_cselect_b32 s43, 0, s43
  s_mul_i32 s6, s43, 10240
  s_cmp_ge_u32 s10, s44
  s_cbranch_scc0 K2_LATE
K2_LATE_BACK:
  v_mfma_f32_32x32x16_bf16 v[32:47], v[128:131], v[152:155], 0
  v_exp_f32 v16, v16
  v_exp_f32 v17, v17
  v_add_u32 v163, s6, v160
  v_add_u32 v164, s6, v161
  v_exp_f32 v18, v18
  v_exp_f32 v19, v19
  v_mfma_f32_32x32x16_bf16 v[32:47], v[132:135], v[156:159], v[32:47]
  v_exp_f32 v20, v20
  v_exp_f32 v21, v21
  ds_read2_b64 v[128:131], v163 offset0:0 offset1:128
  ds_read_b64 v[132:133], v164 offset:0
  v_exp_f32 v22, v22
  v_exp_f32 v23, v23
  v_cvt_pk_bf16_f32 v112, v16, v17
  v_cvt_pk_bf16_f32 v113, v18, v19
  v_mfma_f32_32x32x16_bf16 v[96:111], v[136:139], v[120:123], v[96:111]
  v_exp_f32 v24, v24
  v_exp_f32 v25, v25
  v_exp_f32 v26, v26
  v_exp_f32 v27, v27
  v_cvt_pk_bf16_f32 v114, v20, v21
  v_cvt_pk_bf16_f32 v115, v22, v23
  v_mfma_f32_32x32x16_bf16 v[96:111], v[140:143], v[124:127], v[96:111]
  v_exp_f32 v28, v28
  v_exp_f32 v29, v29
  s_mov_b64 exec, s[56:57]
  ds_read_b128 v[136:139], v165 offset:3840
  ds_read_b128 v[140:143], v165 offset:4480
  s_mov_b64 exec, 1
  ds_add_u32 v166, v167 offset:192
  s_mov_b64 exec, -1
  v_exp_f32 v30, v30
  v_exp_f32 v31, v31
  v_cvt_pk_bf16_f32 v116, v24, v25
  v_cvt_pk_bf16_f32 v117, v26, v27
  v_cvt_pk_bf16_f32 v118, v28, v29
  v_cvt_pk_bf16_f32 v119, v30, v31
  s_waitcnt lgkmcnt(3)
  v_mfma_f32_32x32x16_bf16 v[16:31], v[128:131], v[144:147], 0
  v_exp_f32 v32, v32
  v_exp_f32 v33, v33
  v_exp_f32 v34, v34
  v_exp_f32 v35, v35
  v_mfma_f32_32x32x16_bf16 v[16:31], v[132:135], v[148:151], v[16:31]
  v_exp_f32 v36, v36
  v_exp_f32 v37, v37
  v_exp_f32 v38, v38
  v_exp_f32 v39, v39
  v_cvt_pk_bf16_f32 v120, v32, v33
  v_cvt_pk_bf16_f32 v121, v34, v35
  s_waitcnt lgkmcnt(1)
  v_mfma_f32_32x32x16_bf16 v[80:95], v[136:139], v[112:115], v[80:95]
  v_exp_f32 v40, v40
  v_exp_f32 v41, v41
  v_add_u32 v165, s6, v162
  v_add_u32 v166, 4, v166
  v_exp_f32 v42, v42
  v_exp_f32 v43, v43
  v_cvt_pk_bf16_f32 v122, v36, v37
  v_cvt_pk_bf16_f32 v123, v38, v39
  v_mfma_f32_32x32x16_bf16 v[80:95], v[140:143], v[116:119], v[80:95]
  v_exp_f32 v44, v44
  v_exp_f32 v45, v45
  v_exp_f32 v46, v46
  v_exp_f32 v47, v47
  v_cvt_pk_bf16_f32 v124, v40, v41
  v_cvt_pk_bf16_f32 v125, v42, v43
  v_cvt_pk_bf16_f32 v126, v44, v45
  v_cvt_pk_bf16_f32 v127, v46, v47
  s_add_u32 s42, s42, 1
  s_cmp_lt_u32 s42, 8
  s_cbranch_scc1 K2_LOOP
  s_nop 1
  v_mfma_f32_32x32x16_bf16 v[96:111], v[136:139], v[120:123], v[96:111]
  v_mfma_f32_32x32x16_bf16 v[96:111], v[140:143], v[124:127], v[96:111]
  s_nop 10
  v_cmp_lt_u32 vcc, 31, v0
  s_nop 1
  v_cndmask_b32 v9, 1.0, v88, vcc
  v_cndmask_b32 v10, 1.0, v104, vcc
  s_mov_b32 s3, 1392508928
  v_cmp_nle_f32 s[60:61], v9, s3
  v_cmp_nle_f32 vcc, v10, s3
  s_nop 1
  s_or_b64 vcc, vcc, s[60:61]
  s_cmp_lg_u64 vcc, 0
  s_cselect_b32 s7, 1, 0
  s_lshl_b32 s3, s36, 2
  s_add_u32 s3, s3, 159104
  v_mov_b32 v11, s3
  v_mov_b32 v12, s7
  ds_write_b32 v11, v12
  v_lshlrev_b32 v13, 4, v0
  v_add_u32 v14, s55, v13
  v_add_u32 v13, s63, v13
  s_waitcnt lgkmcnt(0)
  s_barrier
  s_cmp_eq_u32 s38, 0
  s_cbranch_scc0 K2_X1
  ds_write_b128 v13, v[96:99] offset:0
  ds_write_b128 v13, v[100:103] offset:1024
  ds_write_b128 v13, v[104:107] offset:2048
  s_waitcnt lgkmcnt(0)
  s_barrier
  ds_read_b128 v[16:19], v14 offset:0
  ds_read_b128 v[20:23], v14 offset:1024
  ds_read_b128 v[24:27], v14 offset:2048
  v_mov_b32 v11, 159104
  ds_read_b128 v[32:35], v11
  ds_read_b128 v[36:39], v11 offset:16
  s_waitcnt lgkmcnt(2)
  v_add_f32 v16, v16, v80
  v_add_f32 v17, v17, v81
  v_add_f32 v18, v18, v82
  v_add_f32 v19, v19, v83
  v_add_f32 v20, v20, v84
  v_add_f32 v21, v21, v85
  v_add_f32 v22, v22, v86
  v_add_f32 v23, v23, v87
  v_add_f32 v24, v24, v88
  v_add_f32 v25, v25, v89
  v_add_f32 v26, v26, v90
  v_add_f32 v27, v27, v91
  s_branch K2_X2
K2_X1:
  ds_write_b128 v13, v[80:83] offset:0
  ds_write_b128 v13, v[84:87] offset:1024
  ds_write_b128 v13, v[88:91] offset:2048
  s_waitcnt lgkmcnt(0)
  s_barrier
  ds_read_b128 v[16:19], v14 offset:0
  ds_read_b128 v[20:23], v14 offset:1024
  ds_read_b128 v[24:27], v14 offset:2048
  v_mov_b32 v11, 159104
  ds_read_b128 v[32:35], v11
  ds_read_b128 v[36:39], v11 offset:16
  s_waitcnt lgkmcnt(2)
  v_add_f32 v16, v16, v96
  v_add_f32 v17, v17, v97
  v_add_f32 v18, v18, v98
  v_add_f32 v19, v19, v99
  v_add_f32 v20, v20, v100
  v_add_f32 v21, v21, v101
  v_add_f32 v22, v22, v102
  v_add_f32 v23, v23, v103
  v_add_f32 v24, v24, v104
  v_add_f32 v25, v25, v105
  v_add_f32 v26, v26, v106
  v_add_f32 v27, v27, v107
K2_X2:
  s_waitcnt lgkmcnt(0)
  v_or_b32 v32, v32, v33
  v_or_b32 v32, v32, v34
  v_or_b32 v32, v32, v35
  v_or_b32 v32, v32, v36
  v_or_b32 v32, v32, v37
  v_or_b32 v32, v32, v38
  v_or_b32 v32, v32, v39
  s_nop 0
  v_readfirstlane_b32 s7, v32
  s_nop 1
  s_cmp_eq_u32 s41, 0
  s_cselect_b32 s7, s7, 0
  s_cmp_lg_u32 s7, 0
  s_cbranch_scc1 K2_MAX
  v_cmp_lt_u32 vcc, 31, v0
  v_and_b32 v1, 31, v0
  v_lshrrev_b32 v2, 5, v0
  v_mov_b32 v9, v24
  v_mov_b32 v10, v24
  s_nop 1
  v_permlane32_swap_b32 v9, v10
  s_nop 1
  v_rcp_f32 v9, v10
  s_nop 0
  v_mul_f32 v16, v9, v16
  v_mul_f32 v17, v9, v17
  v_mul_f32 v18, v9, v18
  v_mul_f32 v19, v9, v19
  v_mul_f32 v20, v9, v20
  v_mul_f32 v21, v9, v21
  v_mul_f32 v22, v9, v22
  v_mul_f32 v23, v9, v23
  v_mul_f32 v24, v9, v24
  v_mul_f32 v25, v9, v25
  v_mul_f32 v26, v9, v26
  v_mul_f32 v27, v9, v27
  v_cvt_pk_bf16_f32 v16, v16, v17
  v_cvt_pk_bf16_f32 v17, v18, v19
  v_cvt_pk_bf16_f32 v18, v20, v21
  v_cvt_pk_bf16_f32 v19, v22, v23
  v_cvt_pk_bf16_f32 v20, v24, v25
  v_cvt_pk_bf16_f32 v21, v26, v27
  s_nop 0
  v_permlane32_swap_b32 v16, v18
  v_permlane32_swap_b32 v17, v19
  buffer_store_dwordx2 v[20:21], v4, s[32:35], s62 offen sc1
  buffer_store_dwordx4 v[16:19], v3, s[32:35], s62 offen sc1
  s_waitcnt vmcnt(0)
  v_mov_b32 v6, 159168
  s_mov_b64 exec, 1
  ds_add_u32 v6, v167 offset:0
  s_mov_b64 exec, -1
K2_ADONE:
  s_branch K2_END
K2_LATE:
  s_mov_b32 s9, 262144
K2_SP2:
  ds_read_b32 v15, v166 offset:4
  s_waitcnt lgkmcnt(0)
  v_readfirstlane_b32 s10, v15
  s_sub_u32 s9, s9, 1
  s_cmp_eq_u32 s9, 0
  s_cbranch_scc1 K2_SX2
  s_cmp_ge_u32 s10, 2
  s_cbranch_scc1 K2_SX2
  s_sleep 1
  s_branch K2_SP2
K2_SX2:
  s_branch K2_LATE_BACK
K2_MAX:
  s_mov_b32 s41, 1
  v_and_b32 v1, 31, v0
  v_mov_b32 v13, 0xff800000
  v_mov_b32 v14, 0xff800000
  v_mov_b32 v150, 0
  v_mov_b32 v151, 0
  v_mov_b32 v158, 0
  v_mov_b32 v159, 0
  s_mov_b32 s42, 0
  s_mov_b32 s43, 0
K2_MLOOP:
  s_mov_b32 s9, 262144
K2_SP3:
  ds_read_b32 v10, v166 offset:0
  s_waitcnt lgkmcnt(0)
  v_readfirstlane_b32 s10, v10
  s_sub_u32 s9, s9, 1
  s_cmp_eq_u32 s9, 0
  s_cbranch_scc1 K2_SX3
  s_cmp_ge_u32 s10, 2
  s_cbranch_scc1 K2_SX3
  s_sleep 1
  s_branch K2_SP3
K2_SX3:
  s_mul_i32 s6, s43, 10240
  v_add_u32 v163, s6, v160
  v_add_u32 v164, s6, v161
  ds_read2_b64 v[128:131], v163 offset0:0 offset1:128
  ds_read_b64 v[132:133], v164 offset:0
  s_waitcnt lgkmcnt(0)
  v_mfma_f32_32x32x16_bf16 v[16:31], v[128:131], v[144:147], 0
  v_mfma_f32_32x32x16_bf16 v[32:47], v[128:131], v[152:155], 0
  v_mfma_f32_32x32x16_bf16 v[16:31], v[132:135], v[148:151], v[16:31]
  v_mfma_f32_32x32x16_bf16 v[32:47], v[132:135], v[156:159], v[32:47]
  s_nop 12
  v_max3_f32 v13, v13, v16, v17
  v_max3_f32 v13, v13, v18, v19
  v_max3_f32 v13, v13, v20, v21
  v_max3_f32 v13, v13, v22, v23
  v_max3_f32 v13, v13, v24, v25
  v_max3_f32 v13, v13, v26, v27
  v_max3_f32 v13, v13, v28, v29
  v_max3_f32 v13, v13, v30, v31
  v_max3_f32 v14, v14, v32, v33
  v_max3_f32 v14, v14, v34, v35
  v_max3_f32 v14, v14, v36, v37
  v_max3_f32 v14, v14, v38, v39
  v_max3_f32 v14, v14, v40, v41
  v_max3_f32 v14, v14, v42, v43
  v_max3_f32 v14, v14, v44, v45
  v_max3_f32 v14, v14, v46, v47
  ds_read2_b64 v[128:131], v163 offset0:32 offset1:160
  ds_read_b64 v[132:133], v164 offset:256
  s_waitcnt lgkmcnt(0)
  v_mfma_f32_32x32x16_bf16 v[16:31], v[128:131], v[144:147], 0
  v_mfma_f32_32x32x16_bf16 v[32:47], v[128:131], v[152:155], 0
  v_mfma_f32_32x32x16_bf16 v[16:31], v[132:135], v[148:151], v[16:31]
  v_mfma_f32_32x32x16_bf16 v[32:47], v[132:135], v[156:159], v[32:47]
  s_nop 12
  v_max3_f32 v13, v13, v16, v17
  v_max3_f32 v13, v13, v18, v19
  v_max3_f32 v13, v13, v20, v21
  v_max3_f32 v13, v13, v22, v23
  v_max3_f32 v13, v13, v24, v25
  v_max3_f32 v13, v13, v26, v27
  v_max3_f32 v13, v13, v28, v29
  v_max3_f32 v13, v13, v30, v31
  v_max3_f32 v14, v14, v32, v33
  v_max3_f32 v14, v14, v34, v35
  v_max3_f32 v14, v14, v36, v37
  v_max3_f32 v14, v14, v38, v39
  v_max3_f32 v14, v14, v40, v41
  v_max3_f32 v14, v14, v42, v43
  v_max3_f32 v14, v14, v44, v45
  v_max3_f32 v14, v14, v46, v47
  ds_read2_b64 v[128:131], v163 offset0:64 offset1:192
  ds_read_b64 v[132:133], v164 offset:512
  s_waitcnt lgkmcnt(0)
  v_mfma_f32_32x32x16_bf16 v[16:31], v[128:131], v[144:147], 0
  v_mfma_f32_32x32x16_bf16 v[32:47], v[128:131], v[152:155], 0
  v_mfma_f32_32x32x16_bf16 v[16:31], v[132:135], v[148:151], v[16:31]
  v_mfma_f32_32x32x16_bf16 v[32:47], v[132:135], v[156:159], v[32:47]
  s_nop 12
  v_max3_f32 v13, v13, v16, v17
  v_max3_f32 v13, v13, v18, v19
  v_max3_f32 v13, v13, v20, v21
  v_max3_f32 v13, v13, v22, v23
  v_max3_f32 v13, v13, v24, v25
  v_max3_f32 v13, v13, v26, v27
  v_max3_f32 v13, v13, v28, v29
  v_max3_f32 v13, v13, v30, v31
  v_max3_f32 v14, v14, v32, v33
  v_max3_f32 v14, v14, v34, v35
  v_max3_f32 v14, v14, v36, v37
  v_max3_f32 v14, v14, v38, v39
  v_max3_f32 v14, v14, v40, v41
  v_max3_f32 v14, v14, v42, v43
  v_max3_f32 v14, v14, v44, v45
  v_max3_f32 v14, v14, v46, v47
  ds_read2_b64 v[128:131], v163 offset0:96 offset1:224
  ds_read_b64 v[132:133], v164 offset:768
  s_waitcnt lgkmcnt(0)
  v_mfma_f32_32x32x16_bf16 v[16:31], v[128:131], v[144:147], 0
  v_mfma_f32_32x32x16_bf16 v[32:47], v[128:131], v[152:155], 0
  v_mfma_f32_32x32x16_bf16 v[16:31], v[132:135], v[148:151], v[16:31]
  v_mfma_f32_32x32x16_bf16 v[32:47], v[132:135], v[156:159], v[32:47]
  s_nop 12
  v_max3_f32 v13, v13, v16, v17
  v_max3_f32 v13, v13, v18, v19
  v_max3_f32 v13, v13, v20, v21
  v_max3_f32 v13, v13, v22, v23
  v_max3_f32 v13, v13, v24, v25
  v_max3_f32 v13, v13, v26, v27
  v_max3_f32 v13, v13, v28, v29
  v_max3_f32 v13, v13, v30, v31
  v_max3_f32 v14, v14, v32, v33
  v_max3_f32 v14, v14, v34, v35
  v_max3_f32 v14, v14, v36, v37
  v_max3_f32 v14, v14, v38, v39
  v_max3_f32 v14, v14, v40, v41
  v_max3_f32 v14, v14, v42, v43
  v_max3_f32 v14, v14, v44, v45
  v_max3_f32 v14, v14, v46, v47
  s_mov_b64 exec, 1
  ds_add_u32 v166, v167 offset:192
  s_mov_b64 exec, -1
  v_add_u32 v166, 4, v166
  s_add_u32 s43, s43, 1
  s_cmp_eq_u32 s43, 3
  s_cselect_b32 s43, 0, s43
  s_add_u32 s42, s42, 1
  s_cmp_lt_u32 s42, 8
  s_cbranch_scc1 K2_MLOOP
  v_mov_b32 v11, v13
  s_nop 1
  v_permlane32_swap_b32 v11, v13
  s_nop 1
  v_max_f32 v13, v11, v13
  v_mov_b32 v11, v14
  s_nop 1
  v_permlane32_swap_b32 v11, v14
  s_nop 1
  v_max_f32 v14, v11, v14
  s_lshl_b32 s3, s36, 9
  v_lshlrev_b32 v11, 3, v0
  v_add_u32 v12, s3, v11
  v_mov_b32 v32, v13
  v_mov_b32 v33, v14
  s_barrier
  ds_write_b64 v12, v[32:33]
  s_waitcnt lgkmcnt(0)
  s_barrier
  s_xor_b32 s3, s36, 4
  s_lshl_b32 s3, s3, 9
  v_add_u32 v12, s3, v11
  ds_read_b64 v[32:33], v12
  s_waitcnt lgkmcnt(0)
  s_barrier
  v_max_f32 v13, v13, v32
  v_max_f32 v14, v14, v33
  v_cmp_lt_u32 vcc, 31, v0
  s_nop 1
  v_cvt_pk_bf16_f32 v11, -v13, -v13
  v_and_b32 v11, 0xffff0000, v11
  v_sub_f32 v12, -v13, v11
  v_cvt_pk_bf16_f32 v10, v12, v12
  v_and_b32 v10, 0xffff0000, v10
  v_sub_f32 v12, v12, v10
  v_cvt_pk_bf16_f32 v12, v12, v12
  v_and_b32 v12, 0xffff, v12
  v_lshrrev_b32 v11, 16, v11
  v_or_b32 v11, v11, v10
  v_cndmask_b32 v150, v11, 0, vcc
  v_cndmask_b32 v151, v12, 0, vcc
  v_cvt_pk_bf16_f32 v11, -v14, -v14
  v_and_b32 v11, 0xffff0000, v11
  v_sub_f32 v12, -v14, v11
  v_cvt_pk_bf16_f32 v10, v12, v12
  v_and_b32 v10, 0xffff0000, v10
  v_sub_f32 v12, v12, v10
  v_cvt_pk_bf16_f32 v12, v12, v12
  v_and_b32 v12, 0xffff, v12
  v_lshrrev_b32 v11, 16, v11
  v_or_b32 v11, v11, v10
  v_cndmask_b32 v158, v11, 0, vcc
  v_cndmask_b32 v159, v12, 0, vcc
  v_mov_b32 v80, 0
  v_mov_b32 v81, 0
  v_mov_b32 v82, 0
  v_mov_b32 v83, 0
  v_mov_b32 v84, 0
  v_mov_b32 v85, 0
  v_mov_b32 v86, 0
  v_mov_b32 v87, 0
  v_mov_b32 v88, 0
  v_mov_b32 v89, 0
  v_mov_b32 v90, 0
  v_mov_b32 v91, 0
  v_mov_b32 v92, 0
  v_mov_b32 v93, 0
  v_mov_b32 v94, 0
  v_mov_b32 v95, 0
  v_mov_b32 v96, 0
  v_mov_b32 v97, 0
  v_mov_b32 v98, 0
  v_mov_b32 v99, 0
  v_mov_b32 v100, 0
  v_mov_b32 v101, 0
  v_mov_b32 v102, 0
  v_mov_b32 v103, 0
  v_mov_b32 v104, 0
  v_mov_b32 v105, 0
  v_mov_b32 v106, 0
  v_mov_b32 v107, 0
  v_mov_b32 v108, 0
  v_mov_b32 v109, 0
  v_mov_b32 v110, 0
  v_mov_b32 v111, 0
  v_mov_b32 v120, 0
  v_mov_b32 v121, 0
  v_mov_b32 v122, 0
  v_mov_b32 v123, 0
  v_mov_b32 v124, 0
  v_mov_b32 v125, 0
  v_mov_b32 v126, 0
  v_mov_b32 v127, 0
  v_cmp_eq_u32 vcc, 20, v1
  v_mov_b32 v12, 0x3f803f80
  s_nop 0
  v_cndmask_b32 v136, 0, v12, vcc
  v_cndmask_b32 v137, 0, v12, vcc
  v_cndmask_b32 v138, 0, v12, vcc
  v_cndmask_b32 v139, 0, v12, vcc
  v_cndmask_b32 v140, 0, v12, vcc
  v_cndmask_b32 v141, 0, v12, vcc
  v_cndmask_b32 v142, 0, v12, vcc
  v_cndmask_b32 v143, 0, v12, vcc
  v_mov_b32 v163, v160
  v_mov_b32 v164, v161
  v_mov_b32 v165, v162
  s_mov_b32 s41, 2
  s_branch K2_HAVEC
K2_FFN:
  s_sub_u32 s49, s36, 8
  s_lshr_b32 s45, s49, 1
  s_and_b32 s46, s49, 1
  v_lshlrev_b32 v1, 4, v0
  v_add_u32 v2, 4096, v1
  s_lshl_b32 s5, s39, 4
  s_lshl_b32 s6, s45, 3
  s_add_u32 s5, s5, s6
  s_mul_i32 s5, s5, 10240
  s_mul_i32 s3, s46, 5120
  s_add_u32 s57, s5, s3
  s_mul_i32 s5, s45, 30720
  s_add_u32 s58, s5, s3
  s_mul_i32 s3, s45, 96
  s_add_u32 s3, s3, 158720
  v_mov_b32 v160, s3
  v_mov_b32 v161, 1
  s_waitcnt lgkmcnt(0)
  s_add_u32 s40, s20, 0
  s_addc_u32 s41, s21, 0
  s_and_b32 s41, s41, 0xffff
  s_mov_b32 s42, 5242880
  s_mov_b32 s43, 0x00020000
  s_add_u32 m0, s58, 0
  s_add_u32 s3, s57, 0
  buffer_load_dwordx4 v1, s[40:43], s3 offen lds
  s_add_u32 m0, s58, 1024
  s_add_u32 s3, s57, 1024
  buffer_load_dwordx4 v1, s[40:43], s3 offen lds
  s_add_u32 m0, s58, 2048
  s_add_u32 s3, s57, 2048
  buffer_load_dwordx4 v1, s[40:43], s3 offen lds
  s_add_u32 m0, s58, 3072
  s_add_u32 s3, s57, 3072
  buffer_load_dwordx4 v1, s[40:43], s3 offen lds
  s_add_u32 m0, s58, 4096
  s_add_u32 s3, s57, 4096
  buffer_load_dwordx4 v1, s[40:43], s3 offen lds
  s_and_b32 s3, s2, 7
  s_lshr_b32 s8, s2, 3
  s_lshr_b32 s9, s3, 1
  s_and_b32 s10, s8, 7
  s_lshl_b32 s11, s10, 2
  s_add_u32 s50, s11, s9
  s_mov_b32 s59, s10
  s_and_b32 s9, s3, 1
  s_lshl_b32 s9, s9, 2
  s_lshr_b32 s10, s8, 3
  s_add_u32 s51, s9, s10
  s_add_u32 s24, s20, 14680064
  s_addc_u32 s25, s21, 0
  s_and_b32 s25, s25, 0xffff
  s_mov_b32 s26, 1966080
  s_mov_b32 s27, 0x00020000
  s_add_u32 s28, s20, 8388608
  s_addc_u32 s29, s21, 0
  s_and_b32 s29, s29, 0xffff
  s_mov_b32 s30, 6291456
  s_mov_b32 s31, 0x00020000
  s_add_u32 s60, s20, 25165824
  s_addc_u32 s61, s21, 0
  s_and_b32 s61, s61, 0xffff
  s_mov_b32 s62, 65536
  s_mov_b32 s63, 0x00020000
  s_mul_i32 s3, s49, 20480
  s_add_u32 s3, s3, 61440
  v_add_u32 v3, s3, v1
  s_mul_i32 s3, s49, 5120
  s_add_u32 s3, s3, 61440
  v_add_u32 v4, s3, v1
  v_add_u32 v5, 40960, v4
  s_mul_i32 s8, s49, 12
  s_lshl_b32 s3, s50, 2
  s_add_u32 s3, s3, 0
  s_mul_i32 s3, s3, 48
  s_add_u32 s3, s3, s8
  s_lshl_b32 s52, s3, 10
  s_lshl_b32 s3, s50, 2
  s_add_u32 s3, s3, 1
  s_mul_i32 s3, s3, 48
  s_add_u32 s3, s3, s8
  s_lshl_b32 s53, s3, 10
  s_lshl_b32 s3, s50, 2
  s_add_u32 s3, s3, 2
  s_mul_i32 s3, s3, 48
  s_add_u32 s3, s3, s8
  s_lshl_b32 s54, s3, 10
  s_lshl_b32 s3, s50, 2
  s_add_u32 s3, s3, 3
  s_mul_i32 s3, s3, 48
  s_add_u32 s3, s3, s8
  s_lshl_b32 s55, s3, 10
  s_mul_i32 s3, s51, 48
  s_add_u32 s3, s3, s8
  s_mul_i32 s56, s3, 5120
  s_lshl_b32 s3, s50, 6
  s_lshl_b32 s9, s49, 4
  s_add_u32 s3, s3, s9
  v_and_b32 v7, 15, v0
  v_add_u32 v7, s3, v7
  v_lshlrev_b32 v7, 3, v7
  v_add_u32 v7, 4, v7
  s_waitcnt vmcnt(0)
  s_barrier
  s_mov_b64 exec, 1
  ds_add_u32 v160, v161 offset:0
  s_mov_b64 exec, -1
  s_add_u32 m0, s58, 10240
  s_add_u32 s3, s57, 10240
  buffer_load_dwordx4 v1, s[40:43], s3 offen lds
  s_add_u32 m0, s58, 11264
  s_add_u32 s3, s57, 11264
  buffer_load_dwordx4 v1, s[40:43], s3 offen lds
  s_add_u32 m0, s58, 12288
  s_add_u32 s3, s57, 12288
  buffer_load_dwordx4 v1, s[40:43], s3 offen lds
  s_add_u32 m0, s58, 13312
  s_add_u32 s3, s57, 13312
  buffer_load_dwordx4 v1, s[40:43], s3 offen lds
  s_add_u32 m0, s58, 14336
  s_add_u32 s3, s57, 14336
  buffer_load_dwordx4 v1, s[40:43], s3 offen lds
  s_add_u32 m0, s58, 20480
  s_add_u32 s3, s57, 20480
  buffer_load_dwordx4 v1, s[40:43], s3 offen lds
  s_add_u32 m0, s58, 21504
  s_add_u32 s3, s57, 21504
  buffer_load_dwordx4 v1, s[40:43], s3 offen lds
  s_add_u32 m0, s58, 22528
  s_add_u32 s3, s57, 22528
  buffer_load_dwordx4 v1, s[40:43], s3 offen lds
  s_add_u32 m0, s58, 23552
  s_add_u32 s3, s57, 23552
  buffer_load_dwordx4 v1, s[40:43], s3 offen lds
  s_add_u32 m0, s58, 24576
  s_add_u32 s3, s57, 24576
  buffer_load_dwordx4 v1, s[40:43], s3 offen lds
  buffer_load_dword v6, v7, s[60:63], 0 offen
  buffer_load_dwordx4 v[8:11], v1, s[28:31], s52 offen
  buffer_load_dwordx4 v[24:27], v1, s[24:27], s56 offen offset:0
  buffer_load_dwordx4 v[28:31], v1, s[24:27], s56 offen offset:1024
  buffer_load_dwordx4 v[12:15], v1, s[28:31], s53 offen
  buffer_load_dwordx4 v[32:35], v1, s[24:27], s56 offen offset:2048
  buffer_load_dwordx4 v[16:19], v1, s[28:31], s54 offen
  buffer_load_dwordx4 v[36:39], v1, s[24:27], s56 offen offset:3072
  buffer_load_dwordx4 v[20:23], v1, s[28:31], s55 offen
  buffer_load_dwordx4 v[40:43], v2, s[24:27], s56 offen
  s_add_u32 s52, s52, 1024
  s_add_u32 s53, s53, 1024
  s_add_u32 s54, s54, 1024
  s_add_u32 s55, s55, 1024
  s_add_u32 s56, s56, 5120
  s_waitcnt vmcnt(15)
  s_mov_b64 exec, 1
  ds_add_u32 v160, v161 offset:4
  s_mov_b64 exec, -1
  s_waitcnt vmcnt(10)
  s_mov_b64 exec, 1
  ds_add_u32 v160, v161 offset:8
  s_mov_b64 exec, -1
  s_mov_b32 s64, 3
  s_add_u32 s65, s57, 30720
  s_mov_b32 s66, s58
  s_mov_b32 s67, 0
  s_mov_b32 s68, 0
  v_add_u32 v162, 192, v160
  v_add_u32 v163, 12, v160
  buffer_load_dwordx4 v[44:47], v1, s[28:31], s52 offen
  buffer_load_dwordx4 v[60:63], v1, s[24:27], s56 offen offset:0
  buffer_load_dwordx4 v[64:67], v1, s[24:27], s56 offen offset:1024
  buffer_load_dwordx4 v[48:51], v1, s[28:31], s53 offen
  buffer_load_dwordx4 v[68:71], v1, s[24:27], s56 offen offset:2048
  buffer_load_dwordx4 v[52:55], v1, s[28:31], s54 offen
  buffer_load_dwordx4 v[72:75], v1, s[24:27], s56 offen offset:3072
  buffer_load_dwordx4 v[56:59], v1, s[28:31], s55 offen
  buffer_load_dwordx4 v[76:79], v2, s[24:27], s56 offen
  s_add_u32 s52, s52, 1024
  s_add_u32 s53, s53, 1024
  s_add_u32 s54, s54, 1024
  s_add_u32 s55, s55, 1024
  s_add_u32 s56, s56, 5120
  s_waitcnt vmcnt(9)
  v_mfma_f32_16x16x32_bf16 v[80:83], v[24:27], v[8:11], 0
  v_mfma_f32_16x16x32_bf16 v[84:87], v[28:31], v[8:11], 0
  v_mfma_f32_16x16x32_bf16 v[88:91], v[32:35], v[8:11], 0
  v_mfma_f32_16x16x32_bf16 v[92:95], v[36:39], v[8:11], 0
  v_mfma_f32_16x16x32_bf16 v[96:99], v[40:43], v[8:11], 0
  v_mfma_f32_16x16x32_bf16 v[100:103], v[24:27], v[12:15], 0
  v_mfma_f32_16x16x32_bf16 v[104:107], v[28:31], v[12:15], 0
  v_mfma_f32_16x16x32_bf16 v[108:111], v[32:35], v[12:15], 0
  v_mfma_f32_16x16x32_bf16 v[112:115], v[36:39], v[12:15], 0
  v_mfma_f32_16x16x32_bf16 v[116:119], v[40:43], v[12:15], 0
  v_mfma_f32_16x16x32_bf16 v[120:123], v[24:27], v[16:19], 0
  v_mfma_f32_16x16x32_bf16 v[124:127], v[28:31], v[16:19], 0
  v_mfma_f32_16x16x32_bf16 v[128:131], v[32:35], v[16:19], 0
  v_mfma_f32_16x16x32_bf16 v[132:135], v[36:39], v[16:19], 0
  v_mfma_f32_16x16x32_bf16 v[136:139], v[40:43], v[16:19], 0
  v_mfma_f32_16x16x32_bf16 v[140:143], v[24:27], v[20:23], 0
  v_mfma_f32_16x16x32_bf16 v[144:147], v[28:31], v[20:23], 0
  v_mfma_f32_16x16x32_bf16 v[148:151], v[32:35], v[20:23], 0
  v_mfma_f32_16x16x32_bf16 v[152:155], v[36:39], v[20:23], 0
  v_mfma_f32_16x16x32_bf16 v[156:159], v[40:43], v[20:23], 0
  s_cmp_gt_u32 s64, 7
  s_cbranch_scc1 K2_TX0
  ds_read_b32 v164, v162
  s_waitcnt lgkmcnt(0)
  v_readfirstlane_b32 s10, v164
  s_nop 0
  s_cmp_lt_u32 s10, 4
  s_cbranch_scc1 K2_TX0
  s_add_u32 m0, s66, 0
  s_add_u32 s3, s65, 0
  buffer_load_dwordx4 v1, s[40:43], s3 offen lds
  s_add_u32 m0, s66, 1024
  s_add_u32 s3, s65, 1024
  buffer_load_dwordx4 v1, s[40:43], s3 offen lds
  s_add_u32 m0, s66, 2048
  s_add_u32 s3, s65, 2048
  buffer_load_dwordx4 v1, s[40:43], s3 offen lds
  s_add_u32 m0, s66, 3072
  s_add_u32 s3, s65, 3072
  buffer_load_dwordx4 v1, s[40:43], s3 offen lds
  s_add_u32 m0, s66, 4096
  s_add_u32 s3, s65, 4096
  buffer_load_dwordx4 v1, s[40:43], s3 offen lds
  s_add_u32 s64, s64, 1
  s_add_u32 s65, s65, 10240
  v_add_u32 v162, 4, v162
  s_add_u32 s67, s67, 1
  s_add_u32 s66, s66, 10240
  s_cmp_eq_u32 s67, 3
  s_cselect_b32 s67, 0, s67
  s_cselect_b32 s66, s58, s66
  s_mov_b32 s68, 1
K2_TX0:
  buffer_load_dwordx4 v[8:11], v1, s[28:31], s52 offen
  buffer_load_dwordx4 v[24:27], v1, s[24:27], s56 offen offset:0
  buffer_load_dwordx4 v[28:31], v1, s[24:27], s56 offen offset:1024
  buffer_load_dwordx4 v[12:15], v1, s[28:31], s53 offen
  buffer_load_dwordx4 v[32:35], v1, s[24:27], s56 offen offset:2048
  buffer_load_dwordx4 v[16:19], v1, s[28:31], s54 offen
  buffer_load_dwordx4 v[36:39], v1, s[24:27], s56 offen offset:3072
  buffer_load_dwordx4 v[20:23], v1, s[28:31], s55 offen
  buffer_load_dwordx4 v[40:43], v2, s[24:27], s56 offen
  s_add_u32 s52, s52, 1024
  s_add_u32 s53, s53, 1024
  s_add_u32 s54, s54, 1024
  s_add_u32 s55, s55, 1024
  s_add_u32 s56, s56, 5120
  s_waitcnt vmcnt(9)
  s_cmp_eq_u32 s68, 0
  s_cbranch_scc1 K2_TX1
  s_mov_b64 exec, 1
  ds_add_u32 v163, v161 offset:0
  s_mov_b64 exec, -1
  v_add_u32 v163, 4, v163
  s_mov_b32 s68, 0
K2_TX1:
  v_mfma_f32_16x16x32_bf16 v[80:83], v[60:63], v[44:47], v[80:83]
  v_mfma_f32_16x16x32_bf16 v[84:87], v[64:67], v[44:47], v[84:87]
  v_mfma_f32_16x16x32_bf16 v[88:91], v[68:71], v[44:47], v[88:91]
  v_mfma_f32_16x16x32_bf16 v[92:95], v[72:75], v[44:47], v[92:95]
  v_mfma_f32_16x16x32_bf16 v[96:99], v[76:79], v[44:47], v[96:99]
  v_mfma_f32_16x16x32_bf16 v[100:103], v[60:63], v[48:51], v[100:103]
  v_mfma_f32_16x16x32_bf16 v[104:107], v[64:67], v[48:51], v[104:107]
  v_mfma_f32_16x16x32_bf16 v[108:111], v[68:71], v[48:51], v[108:111]
  v_mfma_f32_16x16x32_bf16 v[112:115], v[72:75], v[48:51], v[112:115]
  v_mfma_f32_16x16x32_bf16 v[116:119], v[76:79], v[48:51], v[116:119]
  v_mfma_f32_16x16x32_bf16 v[120:123], v[60:63], v[52:55], v[120:123]
  v_mfma_f32_16x16x32_bf16 v[124:127], v[64:67], v[52:55], v[124:127]
  v_mfma_f32_16x16x32_bf16 v[128:131], v[68:71], v[52:55], v[128:131]
  v_mfma_f32_16x16x32_bf16 v[132:135], v[72:75], v[52:55], v[132:135]
  v_mfma_f32_16x16x32_bf16 v[136:139], v[76:79], v[52:55], v[136:139]
  v_mfma_f32_16x16x32_bf16 v[140:143], v[60:63], v[56:59], v[140:143]
  v_mfma_f32_16x16x32_bf16 v[144:147], v[64:67], v[56:59], v[144:147]
  v_mfma_f32_16x16x32_bf16 v[148:151], v[68:71], v[56:59], v[148:151]
  v_mfma_f32_16x16x32_bf16 v[152:155], v[72:75], v[56:59], v[152:155]
  v_mfma_f32_16x16x32_bf16 v[156:159], v[76:79], v[56:59], v[156:159]
  s_cmp_gt_u32 s64, 7
  s_cbranch_scc1 K2_TX2
  ds_read_b32 v164, v162
  s_waitcnt lgkmcnt(0)
  v_readfirstlane_b32 s10, v164
  s_nop 0
  s_cmp_lt_u32 s10, 4
  s_cbranch_scc1 K2_TX2
  s_add_u32 m0, s66, 0
  s_add_u32 s3, s65, 0
  buffer_load_dwordx4 v1, s[40:43], s3 offen lds
  s_add_u32 m0, s66, 1024
  s_add_u32 s3, s65, 1024
  buffer_load_dwordx4 v1, s[40:43], s3 offen lds
  s_add_u32 m0, s66, 2048
  s_add_u32 s3, s65, 2048
  buffer_load_dwordx4 v1, s[40:43], s3 offen lds
  s_add_u32 m0, s66, 3072
  s_add_u32 s3, s65, 3072
  buffer_load_dwordx4 v1, s[40:43], s3 offen lds
  s_add_u32 m0, s66, 4096
  s_add_u32 s3, s65, 4096
  buffer_load_dwordx4 v1, s[40:43], s3 offen lds
  s_add_u32 s64, s64, 1
  s_add_u32 s65, s65, 10240
  v_add_u32 v162, 4, v162
  s_add_u32 s67, s67, 1
  s_add_u32 s66, s66, 10240
  s_cmp_eq_u32 s67, 3
  s_cselect_b32 s67, 0, s67
  s_cselect_b32 s66, s58, s66
  s_mov_b32 s68, 1
K2_TX2:
  buffer_load_dwordx4 v[44:47], v1, s[28:31], s52 offen
  buffer_load_dwordx4 v[60:63], v1, s[24:27], s56 offen offset:0
  buffer_load_dwordx4 v[64:67], v1, s[24:27], s56 offen offset:1024
  buffer_load_dwordx4 v[48:51], v1, s[28:31], s53 offen
  buffer_load_dwordx4 v[68:71], v1, s[24:27], s56 offen offset:2048
  buffer_load_dwordx4 v[52:55], v1, s[28:31], s54 offen
  buffer_load_dwordx4 v[72:75], v1, s[24:27], s56 offen offset:3072
  buffer_load_dwordx4 v[56:59], v1, s[28:31], s55 offen
  buffer_load_dwordx4 v[76:79], v2, s[24:27], s56 offen
  s_add_u32 s52, s52, 1024
  s_add_u32 s53, s53, 1024
  s_add_u32 s54, s54, 1024
  s_add_u32 s55, s55, 1024
  s_add_u32 s56, s56, 5120
  s_waitcnt vmcnt(9)
  s_cmp_eq_u32 s68, 0
  s_cbranch_scc1 K2_TX3
  s_mov_b64 exec, 1
  ds_add_u32 v163, v161 offset:0
  s_mov_b64 exec, -1
  v_add_u32 v163, 4, v163
  s_mov_b32 s68, 0
K2_TX3:
  v_mfma_f32_16x16x32_bf16 v[80:83], v[24:27], v[8:11], v[80:83]
  v_mfma_f32_16x16x32_bf16 v[84:87], v[28:31], v[8:11], v[84:87]
  v_mfma_f32_16x16x32_bf16 v[88:91], v[32:35], v[8:11], v[88:91]
  v_mfma_f32_16x16x32_bf16 v[92:95], v[36:39], v[8:11], v[92:95]
  v_mfma_f32_16x16x32_bf16 v[96:99], v[40:43], v[8:11], v[96:99]
  v_mfma_f32_16x16x32_bf16 v[100:103], v[24:27], v[12:15], v[100:103]
  v_mfma_f32_16x16x32_bf16 v[104:107], v[28:31], v[12:15], v[104:107]
  v_mfma_f32_16x16x32_bf16 v[108:111], v[32:35], v[12:15], v[108:111]
  v_mfma_f32_16x16x32_bf16 v[112:115], v[36:39], v[12:15], v[112:115]
  v_mfma_f32_16x16x32_bf16 v[116:119], v[40:43], v[12:15], v[116:119]
  v_mfma_f32_16x16x32_bf16 v[120:123], v[24:27], v[16:19], v[120:123]
  v_mfma_f32_16x16x32_bf16 v[124:127], v[28:31], v[16:19], v[124:127]
  v_mfma_f32_16x16x32_bf16 v[128:131], v[32:35], v[16:19], v[128:131]
  v_mfma_f32_16x16x32_bf16 v[132:135], v[36:39], v[16:19], v[132:135]
  v_mfma_f32_16x16x32_bf16 v[136:139], v[40:43], v[16:19], v[136:139]
  v_mfma_f32_16x16x32_bf16 v[140:143], v[24:27], v[20:23], v[140:143]
  v_mfma_f32_16x16x32_bf16 v[144:147], v[28:31], v[20:23], v[144:147]
  v_mfma_f32_16x16x32_bf16 v[148:151], v[32:35], v[20:23], v[148:151]
  v_mfma_f32_16x16x32_bf16 v[152:155], v[36:39], v[20:23], v[152:155]
  v_mfma_f32_16x16x32_bf16 v[156:159], v[40:43], v[20:23], v[156:159]
  s_cmp_gt_u32 s64, 7
  s_cbranch_scc1 K2_TX4
  ds_read_b32 v164, v162
  s_waitcnt lgkmcnt(0)
  v_readfirstlane_b32 s10, v164
  s_nop 0
  s_cmp_lt_u32 s10, 4
  s_cbranch_scc1 K2_TX4
  s_add_u32 m0, s66, 0
  s_add_u32 s3, s65, 0
  buffer_load_dwordx4 v1, s[40:43], s3 offen lds
  s_add_u32 m0, s66, 1024
  s_add_u32 s3, s65, 1024
  buffer_load_dwordx4 v1, s[40:43], s3 offen lds
  s_add_u32 m0, s66, 2048
  s_add_u32 s3, s65, 2048
  buffer_load_dwordx4 v1, s[40:43], s3 offen lds
  s_add_u32 m0, s66, 3072
  s_add_u32 s3, s65, 3072
  buffer_load_dwordx4 v1, s[40:43], s3 offen lds
  s_add_u32 m0, s66, 4096
  s_add_u32 s3, s65, 4096
  buffer_load_dwordx4 v1, s[40:43], s3 offen lds
  s_add_u32 s64, s64, 1
  s_add_u32 s65, s65, 10240
  v_add_u32 v162, 4, v162
  s_add_u32 s67, s67, 1
  s_add_u32 s66, s66, 10240
  s_cmp_eq_u32 s67, 3
  s_cselect_b32 s67, 0, s67
  s_cselect_b32 s66, s58, s66
  s_mov_b32 s68, 1
K2_TX4:
  buffer_load_dwordx4 v[8:11], v1, s[28:31], s52 offen
  buffer_load_dwordx4 v[24:27], v1, s[24:27], s56 offen offset:0
  buffer_load_dwordx4 v[28:31], v1, s[24:27], s56 offen offset:1024
  buffer_load_dwordx4 v[12:15], v1, s[28:31], s53 offen
  buffer_load_dwordx4 v[32:35], v1, s[24:27], s56 offen offset:2048
  buffer_load_dwordx4 v[16:19], v1, s[28:31], s54 offen
  buffer_load_dwordx4 v[36:39], v1, s[24:27], s56 offen offset:3072
  buffer_load_dwordx4 v[20:23], v1, s[28:31], s55 offen
  buffer_load_dwordx4 v[40:43], v2, s[24:27], s56 offen
  s_add_u32 s52, s52, 1024
  s_add_u32 s53, s53, 1024
  s_add_u32 s54, s54, 1024
  s_add_u32 s55, s55, 1024
  s_add_u32 s56, s56, 5120
  s_waitcnt vmcnt(9)
  s_cmp_eq_u32 s68, 0
  s_cbranch_scc1 K2_TX5
  s_mov_b64 exec, 1
  ds_add_u32 v163, v161 offset:0
  s_mov_b64 exec, -1
  v_add_u32 v163, 4, v163
  s_mov_b32 s68, 0
K2_TX5:
  v_mfma_f32_16x16x32_bf16 v[80:83], v[60:63], v[44:47], v[80:83]
  v_mfma_f32_16x16x32_bf16 v[84:87], v[64:67], v[44:47], v[84:87]
  v_mfma_f32_16x16x32_bf16 v[88:91], v[68:71], v[44:47], v[88:91]
  v_mfma_f32_16x16x32_bf16 v[92:95], v[72:75], v[44:47], v[92:95]
  v_mfma_f32_16x16x32_bf16 v[96:99], v[76:79], v[44:47], v[96:99]
  v_mfma_f32_16x16x32_bf16 v[100:103], v[60:63], v[48:51], v[100:103]
  v_mfma_f32_16x16x32_bf16 v[104:107], v[64:67], v[48:51], v[104:107]
  v_mfma_f32_16x16x32_bf16 v[108:111], v[68:71], v[48:51], v[108:111]
  v_mfma_f32_16x16x32_bf16 v[112:115], v[72:75], v[48:51], v[112:115]
  v_mfma_f32_16x16x32_bf16 v[116:119], v[76:79], v[48:51], v[116:119]
  v_mfma_f32_16x16x32_bf16 v[120:123], v[60:63], v[52:55], v[120:123]
  v_mfma_f32_16x16x32_bf16 v[124:127], v[64:67], v[52:55], v[124:127]
  v_mfma_f32_16x16x32_bf16 v[128:131], v[68:71], v[52:55], v[128:131]
  v_mfma_f32_16x16x32_bf16 v[132:135], v[72:75], v[52:55], v[132:135]
  v_mfma_f32_16x16x32_bf16 v[136:139], v[76:79], v[52:55], v[136:139]
  v_mfma_f32_16x16x32_bf16 v[140:143], v[60:63], v[56:59], v[140:143]
  v_mfma_f32_16x16x32_bf16 v[144:147], v[64:67], v[56:59], v[144:147]
  v_mfma_f32_16x16x32_bf16 v[148:151], v[68:71], v[56:59], v[148:151]
  v_mfma_f32_16x16x32_bf16 v[152:155], v[72:75], v[56:59], v[152:155]
  v_mfma_f32_16x16x32_bf16 v[156:159], v[76:79], v[56:59], v[156:159]
  s_cmp_gt_u32 s64, 7
  s_cbranch_scc1 K2_TX6
  ds_read_b32 v164, v162
  s_waitcnt lgkmcnt(0)
  v_readfirstlane_b32 s10, v164
  s_nop 0
  s_cmp_lt_u32 s10, 4
  s_cbranch_scc1 K2_TX6
  s_add_u32 m0, s66, 0
  s_add_u32 s3, s65, 0
  buffer_load_dwordx4 v1, s[40:43], s3 offen lds
  s_add_u32 m0, s66, 1024
  s_add_u32 s3, s65, 1024
  buffer_load_dwordx4 v1, s[40:43], s3 offen lds
  s_add_u32 m0, s66, 2048
  s_add_u32 s3, s65, 2048
  buffer_load_dwordx4 v1, s[40:43], s3 offen lds
  s_add_u32 m0, s66, 3072
  s_add_u32 s3, s65, 3072
  buffer_load_dwordx4 v1, s[40:43], s3 offen lds
  s_add_u32 m0, s66, 4096
  s_add_u32 s3, s65, 4096
  buffer_load_dwordx4 v1, s[40:43], s3 offen lds
  s_add_u32 s64, s64, 1
  s_add_u32 s65, s65, 10240
  v_add_u32 v162, 4, v162
  s_add_u32 s67, s67, 1
  s_add_u32 s66, s66, 10240
  s_cmp_eq_u32 s67, 3
  s_cselect_b32 s67, 0, s67
  s_cselect_b32 s66, s58, s66
  s_mov_b32 s68, 1
K2_TX6:
  buffer_load_dwordx4 v[44:47], v1, s[28:31], s52 offen
  buffer_load_dwordx4 v[60:63], v1, s[24:27], s56 offen offset:0
  buffer_load_dwordx4 v[64:67], v1, s[24:27], s56 offen offset:1024
  buffer_load_dwordx4 v[48:51], v1, s[28:31], s53 offen
  buffer_load_dwordx4 v[68:71], v1, s[24:27], s56 offen offset:2048
  buffer_load_dwordx4 v[52:55], v1, s[28:31], s54 offen
  buffer_load_dwordx4 v[72:75], v1, s[24:27], s56 offen offset:3072
  buffer_load_dwordx4 v[56:59], v1, s[28:31], s55 offen
  buffer_load_dwordx4 v[76:79], v2, s[24:27], s56 offen
  s_add_u32 s52, s52, 1024
  s_add_u32 s53, s53, 1024
  s_add_u32 s54, s54, 1024
  s_add_u32 s55, s55, 1024
  s_add_u32 s56, s56, 5120
  s_waitcnt vmcnt(9)
  s_cmp_eq_u32 s68, 0
  s_cbranch_scc1 K2_TX7
  s_mov_b64 exec, 1
  ds_add_u32 v163, v161 offset:0
  s_mov_b64 exec, -1
  v_add_u32 v163, 4, v163
  s_mov_b32 s68, 0
K2_TX7:
  v_mfma_f32_16x16x32_bf16 v[80:83], v[24:27], v[8:11], v[80:83]
  v_mfma_f32_16x16x32_bf16 v[84:87], v[28:31], v[8:11], v[84:87]
  v_mfma_f32_16x16x32_bf16 v[88:91], v[32:35], v[8:11], v[88:91]
  v_mfma_f32_16x16x32_bf16 v[92:95], v[36:39], v[8:11], v[92:95]
  v_mfma_f32_16x16x32_bf16 v[96:99], v[40:43], v[8:11], v[96:99]
  v_mfma_f32_16x16x32_bf16 v[100:103], v[24:27], v[12:15], v[100:103]
  v_mfma_f32_16x16x32_bf16 v[104:107], v[28:31], v[12:15], v[104:107]
  v_mfma_f32_16x16x32_bf16 v[108:111], v[32:35], v[12:15], v[108:111]
  v_mfma_f32_16x16x32_bf16 v[112:115], v[36:39], v[12:15], v[112:115]
  v_mfma_f32_16x16x32_bf16 v[116:119], v[40:43], v[12:15], v[116:119]
  v_mfma_f32_16x16x32_bf16 v[120:123], v[24:27], v[16:19], v[120:123]
  v_mfma_f32_16x16x32_bf16 v[124:127], v[28:31], v[16:19], v[124:127]
  v_mfma_f32_16x16x32_bf16 v[128:131], v[32:35], v[16:19], v[128:131]
  v_mfma_f32_16x16x32_bf16 v[132:135], v[36:39], v[16:19], v[132:135]
  v_mfma_f32_16x16x32_bf16 v[136:139], v[40:43], v[16:19], v[136:139]
  v_mfma_f32_16x16x32_bf16 v[140:143], v[24:27], v[20:23], v[140:143]
  v_mfma_f32_16x16x32_bf16 v[144:147], v[28:31], v[20:23], v[144:147]
  v_mfma_f32_16x16x32_bf16 v[148:151], v[32:35], v[20:23], v[148:151]
  v_mfma_f32_16x16x32_bf16 v[152:155], v[36:39], v[20:23], v[152:155]
  v_mfma_f32_16x16x32_bf16 v[156:159], v[40:43], v[20:23], v[156:159]
  s_cmp_gt_u32 s64, 7
  s_cbranch_scc1 K2_TX8
  ds_read_b32 v164, v162
  s_waitcnt lgkmcnt(0)
  v_readfirstlane_b32 s10, v164
  s_nop 0
  s_cmp_lt_u32 s10, 4
  s_cbranch_scc1 K2_TX8
  s_add_u32 m0, s66, 0
  s_add_u32 s3, s65, 0
  buffer_load_dwordx4 v1, s[40:43], s3 offen lds
  s_add_u32 m0, s66, 1024
  s_add_u32 s3, s65, 1024
  buffer_load_dwordx4 v1, s[40:43], s3 offen lds
  s_add_u32 m0, s66, 2048
  s_add_u32 s3, s65, 2048
  buffer_load_dwordx4 v1, s[40:43], s3 offen lds
  s_add_u32 m0, s66, 3072
  s_add_u32 s3, s65, 3072
  buffer_load_dwordx4 v1, s[40:43], s3 offen lds
  s_add_u32 m0, s66, 4096
  s_add_u32 s3, s65, 4096
  buffer_load_dwordx4 v1, s[40:43], s3 offen lds
  s_add_u32 s64, s64, 1
  s_add_u32 s65, s65, 10240
  v_add_u32 v162, 4, v162
  s_add_u32 s67, s67, 1
  s_add_u32 s66, s66, 10240
  s_cmp_eq_u32 s67, 3
  s_cselect_b32 s67, 0, s67
  s_cselect_b32 s66, s58, s66
  s_mov_b32 s68, 1
K2_TX8:
  buffer_load_dwordx4 v[8:11], v1, s[28:31], s52 offen
  buffer_load_dwordx4 v[24:27], v1, s[24:27], s56 offen offset:0
  buffer_load_dwordx4 v[28:31], v1, s[24:27], s56 offen offset:1024
  buffer_load_dwordx4 v[12:15], v1, s[28:31], s53 offen
  buffer_load_dwordx4 v[32:35], v1, s[24:27], s56 offen offset:2048
  buffer_load_dwordx4 v[16:19], v1, s[28:31], s54 offen
  buffer_load_dwordx4 v[36:39], v1, s[24:27], s56 offen offset:3072
  buffer_load_dwordx4 v[20:23], v1, s[28:31], s55 offen
  buffer_load_dwordx4 v[40:43], v2, s[24:27], s56 offen
  s_add_u32 s52, s52, 1024
  s_add_u32 s53, s53, 1024
  s_add_u32 s54, s54, 1024
  s_add_u32 s55, s55, 1024
  s_add_u32 s56, s56, 5120
  s_waitcnt vmcnt(9)
  s_cmp_eq_u32 s68, 0
  s_cbranch_scc1 K2_TX9
  s_mov_b64 exec, 1
  ds_add_u32 v163, v161 offset:0
  s_mov_b64 exec, -1
  v_add_u32 v163, 4, v163
  s_mov_b32 s68, 0
K2_TX9:
  v_mfma_f32_16x16x32_bf16 v[80:83], v[60:63], v[44:47], v[80:83]
  v_mfma_f32_16x16x32_bf16 v[84:87], v[64:67], v[44:47], v[84:87]
  v_mfma_f32_16x16x32_bf16 v[88:91], v[68:71], v[44:47], v[88:91]
  v_mfma_f32_16x16x32_bf16 v[92:95], v[72:75], v[44:47], v[92:95]
  v_mfma_f32_16x16x32_bf16 v[96:99], v[76:79], v[44:47], v[96:99]
  v_mfma_f32_16x16x32_bf16 v[100:103], v[60:63], v[48:51], v[100:103]
  v_mfma_f32_16x16x32_bf16 v[104:107], v[64:67], v[48:51], v[104:107]
  v_mfma_f32_16x16x32_bf16 v[108:111], v[68:71], v[48:51], v[108:111]
  v_mfma_f32_16x16x32_bf16 v[112:115], v[72:75], v[48:51], v[112:115]
  v_mfma_f32_16x16x32_bf16 v[116:119], v[76:79], v[48:51], v[116:119]
  v_mfma_f32_16x16x32_bf16 v[120:123], v[60:63], v[52:55], v[120:123]
  v_mfma_f32_16x16x32_bf16 v[124:127], v[64:67], v[52:55], v[124:127]
  v_mfma_f32_16x16x32_bf16 v[128:131], v[68:71], v[52:55], v[128:131]
  v_mfma_f32_16x16x32_bf16 v[132:135], v[72:75], v[52:55], v[132:135]
  v_mfma_f32_16x16x32_bf16 v[136:139], v[76:79], v[52:55], v[136:139]
  v_mfma_f32_16x16x32_bf16 v[140:143], v[60:63], v[56:59], v[140:143]
  v_mfma_f32_16x16x32_bf16 v[144:147], v[64:67], v[56:59], v[144:147]
  v_mfma_f32_16x16x32_bf16 v[148:151], v[68:71], v[56:59], v[148:151]
  v_mfma_f32_16x16x32_bf16 v[152:155], v[72:75], v[56:59], v[152:155]
  v_mfma_f32_16x16x32_bf16 v[156:159], v[76:79], v[56:59], v[156:159]
  s_cmp_gt_u32 s64, 7
  s_cbranch_scc1 K2_TX10
  ds_read_b32 v164, v162
  s_waitcnt lgkmcnt(0)
  v_readfirstlane_b32 s10, v164
  s_nop 0
  s_cmp_lt_u32 s10, 4
  s_cbranch_scc1 K2_TX10
  s_add_u32 m0, s66, 0
  s_add_u32 s3, s65, 0
  buffer_load_dwordx4 v1, s[40:43], s3 offen lds
  s_add_u32 m0, s66, 1024
  s_add_u32 s3, s65, 1024
  buffer_load_dwordx4 v1, s[40:43], s3 offen lds
  s_add_u32 m0, s66, 2048
  s_add_u32 s3, s65, 2048
  buffer_load_dwordx4 v1, s[40:43], s3 offen lds
  s_add_u32 m0, s66, 3072
  s_add_u32 s3, s65, 3072
  buffer_load_dwordx4 v1, s[40:43], s3 offen lds
  s_add_u32 m0, s66, 4096
  s_add_u32 s3, s65, 4096
  buffer_load_dwordx4 v1, s[40:43], s3 offen lds
  s_add_u32 s64, s64, 1
  s_add_u32 s65, s65, 10240
  v_add_u32 v162, 4, v162
  s_add_u32 s67, s67, 1
  s_add_u32 s66, s66, 10240
  s_cmp_eq_u32 s67, 3
  s_cselect_b32 s67, 0, s67
  s_cselect_b32 s66, s58, s66
  s_mov_b32 s68, 1
K2_TX10:
  buffer_load_dwordx4 v[44:47], v1, s[28:31], s52 offen
  buffer_load_dwordx4 v[60:63], v1, s[24:27], s56 offen offset:0
  buffer_load_dwordx4 v[64:67], v1, s[24:27], s56 offen offset:1024
  buffer_load_dwordx4 v[48:51], v1, s[28:31], s53 offen
  buffer_load_dwordx4 v[68:71], v1, s[24:27], s56 offen offset:2048
  buffer_load_dwordx4 v[52:55], v1, s[28:31], s54 offen
  buffer_load_dwordx4 v[72:75], v1, s[24:27], s56 offen offset:3072
  buffer_load_dwordx4 v[56:59], v1, s[28:31], s55 offen
  buffer_load_dwordx4 v[76:79], v2, s[24:27], s56 offen
  s_add_u32 s52, s52, 1024
  s_add_u32 s53, s53, 1024
  s_add_u32 s54, s54, 1024
  s_add_u32 s55, s55, 1024
  s_add_u32 s56, s56, 5120
  s_waitcnt vmcnt(9)
  s_cmp_eq_u32 s68, 0
  s_cbranch_scc1 K2_TX11
  s_mov_b64 exec, 1
  ds_add_u32 v163, v161 offset:0
  s_mov_b64 exec, -1
  v_add_u32 v163, 4, v163
  s_mov_b32 s68, 0
K2_TX11:
  v_mfma_f32_16x16x32_bf16 v[80:83], v[24:27], v[8:11], v[80:83]
  v_mfma_f32_16x16x32_bf16 v[84:87], v[28:31], v[8:11], v[84:87]
  v_mfma_f32_16x16x32_bf16 v[88:91], v[32:35], v[8:11], v[88:91]
  v_mfma_f32_16x16x32_bf16 v[92:95], v[36:39], v[8:11], v[92:95]
  v_mfma_f32_16x16x32_bf16 v[96:99], v[40:43], v[8:11], v[96:99]
  v_mfma_f32_16x16x32_bf16 v[100:103], v[24:27], v[12:15], v[100:103]
  v_mfma_f32_16x16x32_bf16 v[104:107], v[28:31], v[12:15], v[104:107]
  v_mfma_f32_16x16x32_bf16 v[108:111], v[32:35], v[12:15], v[108:111]
  v_mfma_f32_16x16x32_bf16 v[112:115], v[36:39], v[12:15], v[112:115]
  v_mfma_f32_16x16x32_bf16 v[116:119], v[40:43], v[12:15], v[116:119]
  v_mfma_f32_16x16x32_bf16 v[120:123], v[24:27], v[16:19], v[120:123]
  v_mfma_f32_16x16x32_bf16 v[124:127], v[28:31], v[16:19], v[124:127]
  v_mfma_f32_16x16x32_bf16 v[128:131], v[32:35], v[16:19], v[128:131]
  v_mfma_f32_16x16x32_bf16 v[132:135], v[36:39], v[16:19], v[132:135]
  v_mfma_f32_16x16x32_bf16 v[136:139], v[40:43], v[16:19], v[136:139]
  v_mfma_f32_16x16x32_bf16 v[140:143], v[24:27], v[20:23], v[140:143]
  v_mfma_f32_16x16x32_bf16 v[144:147], v[28:31], v[20:23], v[144:147]
  v_mfma_f32_16x16x32_bf16 v[148:151], v[32:35], v[20:23], v[148:151]
  v_mfma_f32_16x16x32_bf16 v[152:155], v[36:39], v[20:23], v[152:155]
  v_mfma_f32_16x16x32_bf16 v[156:159], v[40:43], v[20:23], v[156:159]
  s_cmp_gt_u32 s64, 7
  s_cbranch_scc1 K2_TX12
  ds_read_b32 v164, v162
  s_waitcnt lgkmcnt(0)
  v_readfirstlane_b32 s10, v164
  s_nop 0
  s_cmp_lt_u32 s10, 4
  s_cbranch_scc1 K2_TX12
  s_add_u32 m0, s66, 0
  s_add_u32 s3, s65, 0
  buffer_load_dwordx4 v1, s[40:43], s3 offen lds
  s_add_u32 m0, s66, 1024
  s_add_u32 s3, s65, 1024
  buffer_load_dwordx4 v1, s[40:43], s3 offen lds
  s_add_u32 m0, s66, 2048
  s_add_u32 s3, s65, 2048
  buffer_load_dwordx4 v1, s[40:43], s3 offen lds
  s_add_u32 m0, s66, 3072
  s_add_u32 s3, s65, 3072
  buffer_load_dwordx4 v1, s[40:43], s3 offen lds
  s_add_u32 m0, s66, 4096
  s_add_u32 s3, s65, 4096
  buffer_load_dwordx4 v1, s[40:43], s3 offen lds
  s_add_u32 s64, s64, 1
  s_add_u32 s65, s65, 10240
  v_add_u32 v162, 4, v162
  s_add_u32 s67, s67, 1
  s_add_u32 s66, s66, 10240
  s_cmp_eq_u32 s67, 3
  s_cselect_b32 s67, 0, s67
  s_cselect_b32 s66, s58, s66
  s_mov_b32 s68, 1
K2_TX12:
  buffer_load_dwordx4 v[8:11], v1, s[28:31], s52 offen
  buffer_load_dwordx4 v[24:27], v1, s[24:27], s56 offen offset:0
  buffer_load_dwordx4 v[28:31], v1, s[24:27], s56 offen offset:1024
  buffer_load_dwordx4 v[12:15], v1, s[28:31], s53 offen
  buffer_load_dwordx4 v[32:35], v1, s[24:27], s56 offen offset:2048
  buffer_load_dwordx4 v[16:19], v1, s[28:31], s54 offen
  buffer_load_dwordx4 v[36:39], v1, s[24:27], s56 offen offset:3072
  buffer_load_dwordx4 v[20:23], v1, s[28:31], s55 offen
  buffer_load_dwordx4 v[40:43], v2, s[24:27], s56 offen
  s_add_u32 s52, s52, 1024
  s_add_u32 s53, s53, 1024
  s_add_u32 s54, s54, 1024
  s_add_u32 s55, s55, 1024
  s_add_u32 s56, s56, 5120
  s_waitcnt vmcnt(9)
  s_cmp_eq_u32 s68, 0
  s_cbranch_scc1 K2_TX13
  s_mov_b64 exec, 1
  ds_add_u32 v163, v161 offset:0
  s_mov_b64 exec, -1
  v_add_u32 v163, 4, v163
  s_mov_b32 s68, 0
K2_TX13:
  v_mfma_f32_16x16x32_bf16 v[80:83], v[60:63], v[44:47], v[80:83]
  v_mfma_f32_16x16x32_bf16 v[84:87], v[64:67], v[44:47], v[84:87]
  v_mfma_f32_16x16x32_bf16 v[88:91], v[68:71], v[44:47], v[88:91]
  v_mfma_f32_16x16x32_bf16 v[92:95], v[72:75], v[44:47], v[92:95]
  v_mfma_f32_16x16x32_bf16 v[96:99], v[76:79], v[44:47], v[96:99]
  v_mfma_f32_16x16x32_bf16 v[100:103], v[60:63], v[48:51], v[100:103]
  v_mfma_f32_16x16x32_bf16 v[104:107], v[64:67], v[48:51], v[104:107]
  v_mfma_f32_16x16x32_bf16 v[108:111], v[68:71], v[48:51], v[108:111]
  v_mfma_f32_16x16x32_bf16 v[112:115], v[72:75], v[48:51], v[112:115]
  v_mfma_f32_16x16x32_bf16 v[116:119], v[76:79], v[48:51], v[116:119]
  v_mfma_f32_16x16x32_bf16 v[120:123], v[60:63], v[52:55], v[120:123]
  v_mfma_f32_16x16x32_bf16 v[124:127], v[64:67], v[52:55], v[124:127]
  v_mfma_f32_16x16x32_bf16 v[128:131], v[68:71], v[52:55], v[128:131]
  v_mfma_f32_16x16x32_bf16 v[132:135], v[72:75], v[52:55], v[132:135]
  v_mfma_f32_16x16x32_bf16 v[136:139], v[76:79], v[52:55], v[136:139]
  v_mfma_f32_16x16x32_bf16 v[140:143], v[60:63], v[56:59], v[140:143]
  v_mfma_f32_16x16x32_bf16 v[144:147], v[64:67], v[56:59], v[144:147]
  v_mfma_f32_16x16x32_bf16 v[148:151], v[68:71], v[56:59], v[148:151]
  v_mfma_f32_16x16x32_bf16 v[152:155], v[72:75], v[56:59], v[152:155]
  v_mfma_f32_16x16x32_bf16 v[156:159], v[76:79], v[56:59], v[156:159]
  s_cmp_gt_u32 s64, 7
  s_cbranch_scc1 K2_TX14
  ds_read_b32 v164, v162
  s_waitcnt lgkmcnt(0)
  v_readfirstlane_b32 s10, v164
  s_nop 0
  s_cmp_lt_u32 s10, 4
  s_cbranch_scc1 K2_TX14
  s_add_u32 m0, s66, 0
  s_add_u32 s3, s65, 0
  buffer_load_dwordx4 v1, s[40:43], s3 offen lds
  s_add_u32 m0, s66, 1024
  s_add_u32 s3, s65, 1024
  buffer_load_dwordx4 v1, s[40:43], s3 offen lds
  s_add_u32 m0, s66, 2048
  s_add_u32 s3, s65, 2048
  buffer_load_dwordx4 v1, s[40:43], s3 offen lds
  s_add_u32 m0, s66, 3072
  s_add_u32 s3, s65, 3072
  buffer_load_dwordx4 v1, s[40:43], s3 offen lds
  s_add_u32 m0, s66, 4096
  s_add_u32 s3, s65, 4096
  buffer_load_dwordx4 v1, s[40:43], s3 offen lds
  s_add_u32 s64, s64, 1
  s_add_u32 s65, s65, 10240
  v_add_u32 v162, 4, v162
  s_add_u32 s67, s67, 1
  s_add_u32 s66, s66, 10240
  s_cmp_eq_u32 s67, 3
  s_cselect_b32 s67, 0, s67
  s_cselect_b32 s66, s58, s66
  s_mov_b32 s68, 1
K2_TX14:
  buffer_load_dwordx4 v[44:47], v1, s[28:31], s52 offen
  buffer_load_dwordx4 v[60:63], v1, s[24:27], s56 offen offset:0
  buffer_load_dwordx4 v[64:67], v1, s[24:27], s56 offen offset:1024
  buffer_load_dwordx4 v[48:51], v1, s[28:31], s53 offen
  buffer_load_dwordx4 v[68:71], v1, s[24:27], s56 offen offset:2048
  buffer_load_dwordx4 v[52:55], v1, s[28:31], s54 offen
  buffer_load_dwordx4 v[72:75], v1, s[24:27], s56 offen offset:3072
  buffer_load_dwordx4 v[56:59], v1, s[28:31], s55 offen
  buffer_load_dwordx4 v[76:79], v2, s[24:27], s56 offen
  s_add_u32 s52, s52, 1024
  s_add_u32 s53, s53, 1024
  s_add_u32 s54, s54, 1024
  s_add_u32 s55, s55, 1024
  s_add_u32 s56, s56, 5120
  s_waitcnt vmcnt(9)
  s_cmp_eq_u32 s68, 0
  s_cbranch_scc1 K2_TX15
  s_mov_b64 exec, 1
  ds_add_u32 v163, v161 offset:0
  s_mov_b64 exec, -1
  v_add_u32 v163, 4, v163
  s_mov_b32 s68, 0
K2_TX15:
  v_mfma_f32_16x16x32_bf16 v[80:83], v[24:27], v[8:11], v[80:83]
  v_mfma_f32_16x16x32_bf16 v[84:87], v[28:31], v[8:11], v[84:87]
  v_mfma_f32_16x16x32_bf16 v[88:91], v[32:35], v[8:11], v[88:91]
  v_mfma_f32_16x16x32_bf16 v[92:95], v[36:39], v[8:11], v[92:95]
  v_mfma_f32_16x16x32_bf16 v[96:99], v[40:43], v[8:11], v[96:99]
  v_mfma_f32_16x16x32_bf16 v[100:103], v[24:27], v[12:15], v[100:103]
  v_mfma_f32_16x16x32_bf16 v[104:107], v[28:31], v[12:15], v[104:107]
  v_mfma_f32_16x16x32_bf16 v[108:111], v[32:35], v[12:15], v[108:111]
  v_mfma_f32_16x16x32_bf16 v[112:115], v[36:39], v[12:15], v[112:115]
  v_mfma_f32_16x16x32_bf16 v[116:119], v[40:43], v[12:15], v[116:119]
  v_mfma_f32_16x16x32_bf16 v[120:123], v[24:27], v[16:19], v[120:123]
  v_mfma_f32_16x16x32_bf16 v[124:127], v[28:31], v[16:19], v[124:127]
  v_mfma_f32_16x16x32_bf16 v[128:131], v[32:35], v[16:19], v[128:131]
  v_mfma_f32_16x16x32_bf16 v[132:135], v[36:39], v[16:19], v[132:135]
  v_mfma_f32_16x16x32_bf16 v[136:139], v[40:43], v[16:19], v[136:139]
  v_mfma_f32_16x16x32_bf16 v[140:143], v[24:27], v[20:23], v[140:143]
  v_mfma_f32_16x16x32_bf16 v[144:147], v[28:31], v[20:23], v[144:147]
  v_mfma_f32_16x16x32_bf16 v[148:151], v[32:35], v[20:23], v[148:151]
  v_mfma_f32_16x16x32_bf16 v[152:155], v[36:39], v[20:23], v[152:155]
  v_mfma_f32_16x16x32_bf16 v[156:159], v[40:43], v[20:23], v[156:159]
  s_cmp_gt_u32 s64, 7
  s_cbranch_scc1 K2_TX16
  ds_read_b32 v164, v162
  s_waitcnt lgkmcnt(0)
  v_readfirstlane_b32 s10, v164
  s_nop 0
  s_cmp_lt_u32 s10, 4
  s_cbranch_scc1 K2_TX16
  s_add_u32 m0, s66, 0
  s_add_u32 s3, s65, 0
  buffer_load_dwordx4 v1, s[40:43], s3 offen lds
  s_add_u32 m0, s66, 1024
  s_add_u32 s3, s65, 1024
  buffer_load_dwordx4 v1, s[40:43], s3 offen lds
  s_add_u32 m0, s66, 2048
  s_add_u32 s3, s65, 2048
  buffer_load_dwordx4 v1, s[40:43], s3 offen lds
  s_add_u32 m0, s66, 3072
  s_add_u32 s3, s65, 3072
  buffer_load_dwordx4 v1, s[40:43], s3 offen lds
  s_add_u32 m0, s66, 4096
  s_add_u32 s3, s65, 4096
  buffer_load_dwordx4 v1, s[40:43], s3 offen lds
  s_add_u32 s64, s64, 1
  s_add_u32 s65, s65, 10240
  v_add_u32 v162, 4, v162
  s_add_u32 s67, s67, 1
  s_add_u32 s66, s66, 10240
  s_cmp_eq_u32 s67, 3
  s_cselect_b32 s67, 0, s67
  s_cselect_b32 s66, s58, s66
  s_mov_b32 s68, 1
K2_TX16:
  buffer_load_dwordx4 v[8:11], v1, s[28:31], s52 offen
  buffer_load_dwordx4 v[24:27], v1, s[24:27], s56 offen offset:0
  buffer_load_dwordx4 v[28:31], v1, s[24:27], s56 offen offset:1024
  buffer_load_dwordx4 v[12:15], v1, s[28:31], s53 offen
  buffer_load_dwordx4 v[32:35], v1, s[24:27], s56 offen offset:2048
  buffer_load_dwordx4 v[16:19], v1, s[28:31], s54 offen
  buffer_load_dwordx4 v[36:39], v1, s[24:27], s56 offen offset:3072
  buffer_load_dwordx4 v[20:23], v1, s[28:31], s55 offen
  buffer_load_dwordx4 v[40:43], v2, s[24:27], s56 offen
  s_add_u32 s52, s52, 1024
  s_add_u32 s53, s53, 1024
  s_add_u32 s54, s54, 1024
  s_add_u32 s55, s55, 1024
  s_add_u32 s56, s56, 5120
  s_waitcnt vmcnt(9)
  s_cmp_eq_u32 s68, 0
  s_cbranch_scc1 K2_TX17
  s_mov_b64 exec, 1
  ds_add_u32 v163, v161 offset:0
  s_mov_b64 exec, -1
  v_add_u32 v163, 4, v163
  s_mov_b32 s68, 0
K2_TX17:
  v_mfma_f32_16x16x32_bf16 v[80:83], v[60:63], v[44:47], v[80:83]
  v_mfma_f32_16x16x32_bf16 v[84:87], v[64:67], v[44:47], v[84:87]
  v_mfma_f32_16x16x32_bf16 v[88:91], v[68:71], v[44:47], v[88:91]
  v_mfma_f32_16x16x32_bf16 v[92:95], v[72:75], v[44:47], v[92:95]
  v_mfma_f32_16x16x32_bf16 v[96:99], v[76:79], v[44:47], v[96:99]
  v_mfma_f32_16x16x32_bf16 v[100:103], v[60:63], v[48:51], v[100:103]
  v_mfma_f32_16x16x32_bf16 v[104:107], v[64:67], v[48:51], v[104:107]
  v_mfma_f32_16x16x32_bf16 v[108:111], v[68:71], v[48:51], v[108:111]
  v_mfma_f32_16x16x32_bf16 v[112:115], v[72:75], v[48:51], v[112:115]
  v_mfma_f32_16x16x32_bf16 v[116:119], v[76:79], v[48:51], v[116:119]
  v_mfma_f32_16x16x32_bf16 v[120:123], v[60:63], v[52:55], v[120:123]
  v_mfma_f32_16x16x32_bf16 v[124:127], v[64:67], v[52:55], v[124:127]
  v_mfma_f32_16x16x32_bf16 v[128:131], v[68:71], v[52:55], v[128:131]
  v_mfma_f32_16x16x32_bf16 v[132:135], v[72:75], v[52:55], v[132:135]
  v_mfma_f32_16x16x32_bf16 v[136:139], v[76:79], v[52:55], v[136:139]
  v_mfma_f32_16x16x32_bf16 v[140:143], v[60:63], v[56:59], v[140:143]
  v_mfma_f32_16x16x32_bf16 v[144:147], v[64:67], v[56:59], v[144:147]
  v_mfma_f32_16x16x32_bf16 v[148:151], v[68:71], v[56:59], v[148:151]
  v_mfma_f32_16x16x32_bf16 v[152:155], v[72:75], v[56:59], v[152:155]
  v_mfma_f32_16x16x32_bf16 v[156:159], v[76:79], v[56:59], v[156:159]
  s_cmp_gt_u32 s64, 7
  s_cbranch_scc1 K2_TX18
  ds_read_b32 v164, v162
  s_waitcnt lgkmcnt(0)
  v_readfirstlane_b32 s10, v164
  s_nop 0
  s_cmp_lt_u32 s10, 4
  s_cbranch_scc1 K2_TX18
  s_add_u32 m0, s66, 0
  s_add_u32 s3, s65, 0
  buffer_load_dwordx4 v1, s[40:43], s3 offen lds
  s_add_u32 m0, s66, 1024
  s_add_u32 s3, s65, 1024
  buffer_load_dwordx4 v1, s[40:43], s3 offen lds
  s_add_u32 m0, s66, 2048
  s_add_u32 s3, s65, 2048
  buffer_load_dwordx4 v1, s[40:43], s3 offen lds
  s_add_u32 m0, s66, 3072
  s_add_u32 s3, s65, 3072
  buffer_load_dwordx4 v1, s[40:43], s3 offen lds
  s_add_u32 m0, s66, 4096
  s_add_u32 s3, s65, 4096
  buffer_load_dwordx4 v1, s[40:43], s3 offen lds
  s_add_u32 s64, s64, 1
  s_add_u32 s65, s65, 10240
  v_add_u32 v162, 4, v162
  s_add_u32 s67, s67, 1
  s_add_u32 s66, s66, 10240
  s_cmp_eq_u32 s67, 3
  s_cselect_b32 s67, 0, s67
  s_cselect_b32 s66, s58, s66
  s_mov_b32 s68, 1
K2_TX18:
  buffer_load_dwordx4 v[44:47], v1, s[28:31], s52 offen
  buffer_load_dwordx4 v[60:63], v1, s[24:27], s56 offen offset:0
  buffer_load_dwordx4 v[64:67], v1, s[24:27], s56 offen offset:1024
  buffer_load_dwordx4 v[48:51], v1, s[28:31], s53 offen
  buffer_load_dwordx4 v[68:71], v1, s[24:27], s56 offen offset:2048
  buffer_load_dwordx4 v[52:55], v1, s[28:31], s54 offen
  buffer_load_dwordx4 v[72:75], v1, s[24:27], s56 offen offset:3072
  buffer_load_dwordx4 v[56:59], v1, s[28:31], s55 offen
  buffer_load_dwordx4 v[76:79], v2, s[24:27], s56 offen
  s_add_u32 s52, s52, 1024
  s_add_u32 s53, s53, 1024
  s_add_u32 s54, s54, 1024
  s_add_u32 s55, s55, 1024
  s_add_u32 s56, s56, 5120
  s_waitcnt vmcnt(9)
  s_cmp_eq_u32 s68, 0
  s_cbranch_scc1 K2_TX19
  s_mov_b64 exec, 1
  ds_add_u32 v163, v161 offset:0
  s_mov_b64 exec, -1
  v_add_u32 v163, 4, v163
  s_mov_b32 s68, 0
K2_TX19:
  v_mfma_f32_16x16x32_bf16 v[80:83], v[24:27], v[8:11], v[80:83]
  v_mfma_f32_16x16x32_bf16 v[84:87], v[28:31], v[8:11], v[84:87]
  v_mfma_f32_16x16x32_bf16 v[88:91], v[32:35], v[8:11], v[88:91]
  v_mfma_f32_16x16x32_bf16 v[92:95], v[36:39], v[8:11], v[92:95]
  v_mfma_f32_16x16x32_bf16 v[96:99], v[40:43], v[8:11], v[96:99]
  v_mfma_f32_16x16x32_bf16 v[100:103], v[24:27], v[12:15], v[100:103]
  v_mfma_f32_16x16x32_bf16 v[104:107], v[28:31], v[12:15], v[104:107]
  v_mfma_f32_16x16x32_bf16 v[108:111], v[32:35], v[12:15], v[108:111]
  v_mfma_f32_16x16x32_bf16 v[112:115], v[36:39], v[12:15], v[112:115]
  v_mfma_f32_16x16x32_bf16 v[116:119], v[40:43], v[12:15], v[116:119]
  v_mfma_f32_16x16x32_bf16 v[120:123], v[24:27], v[16:19], v[120:123]
  v_mfma_f32_16x16x32_bf16 v[124:127], v[28:31], v[16:19], v[124:127]
  v_mfma_f32_16x16x32_bf16 v[128:131], v[32:35], v[16:19], v[128:131]
  v_mfma_f32_16x16x32_bf16 v[132:135], v[36:39], v[16:19], v[132:135]
  v_mfma_f32_16x16x32_bf16 v[136:139], v[40:43], v[16:19], v[136:139]
  v_mfma_f32_16x16x32_bf16 v[140:143], v[24:27], v[20:23], v[140:143]
  v_mfma_f32_16x16x32_bf16 v[144:147], v[28:31], v[20:23], v[144:147]
  v_mfma_f32_16x16x32_bf16 v[148:151], v[32:35], v[20:23], v[148:151]
  v_mfma_f32_16x16x32_bf16 v[152:155], v[36:39], v[20:23], v[152:155]
  v_mfma_f32_16x16x32_bf16 v[156:159], v[40:43], v[20:23], v[156:159]
  s_cmp_gt_u32 s64, 7
  s_cbranch_scc1 K2_TX20
  ds_read_b32 v164, v162
  s_waitcnt lgkmcnt(0)
  v_readfirstlane_b32 s10, v164
  s_nop 0
  s_cmp_lt_u32 s10, 4
  s_cbranch_scc1 K2_TX20
  s_add_u32 m0, s66, 0
  s_add_u32 s3, s65, 0
  buffer_load_dwordx4 v1, s[40:43], s3 offen lds
  s_add_u32 m0, s66, 1024
  s_add_u32 s3, s65, 1024
  buffer_load_dwordx4 v1, s[40:43], s3 offen lds
  s_add_u32 m0, s66, 2048
  s_add_u32 s3, s65, 2048
  buffer_load_dwordx4 v1, s[40:43], s3 offen lds
  s_add_u32 m0, s66, 3072
  s_add_u32 s3, s65, 3072
  buffer_load_dwordx4 v1, s[40:43], s3 offen lds
  s_add_u32 m0, s66, 4096
  s_add_u32 s3, s65, 4096
  buffer_load_dwordx4 v1, s[40:43], s3 offen lds
  s_add_u32 s64, s64, 1
  s_add_u32 s65, s65, 10240
  v_add_u32 v162, 4, v162
  s_add_u32 s67, s67, 1
  s_add_u32 s66, s66, 10240
  s_cmp_eq_u32 s67, 3
  s_cselect_b32 s67, 0, s67
  s_cselect_b32 s66, s58, s66
  s_mov_b32 s68, 1
K2_TX20:
  s_waitcnt vmcnt(0)
  s_cmp_eq_u32 s68, 0
  s_cbranch_scc1 K2_TX21
  s_mov_b64 exec, 1
  ds_add_u32 v163, v161 offset:0
  s_mov_b64 exec, -1
  v_add_u32 v163, 4, v163
  s_mov_b32 s68, 0
K2_TX21:
  v_mfma_f32_16x16x32_bf16 v[80:83], v[60:63], v[44:47], v[80:83]
  v_mfma_f32_16x16x32_bf16 v[84:87], v[64:67], v[44:47], v[84:87]
  v_mfma_f32_16x16x32_bf16 v[88:91], v[68:71], v[44:47], v[88:91]
  v_mfma_f32_16x16x32_bf16 v[92:95], v[72:75], v[44:47], v[92:95]
  v_mfma_f32_16x16x32_bf16 v[96:99], v[76:79], v[44:47], v[96:99]
  v_mfma_f32_16x16x32_bf16 v[100:103], v[60:63], v[48:51], v[100:103]
  v_mfma_f32_16x16x32_bf16 v[104:107], v[64:67], v[48:51], v[104:107]
  v_mfma_f32_16x16x32_bf16 v[108:111], v[68:71], v[48:51], v[108:111]
  v_mfma_f32_16x16x32_bf16 v[112:115], v[72:75], v[48:51], v[112:115]
  v_mfma_f32_16x16x32_bf16 v[116:119], v[76:79], v[48:51], v[116:119]
  v_mfma_f32_16x16x32_bf16 v[120:123], v[60:63], v[52:55], v[120:123]
  v_mfma_f32_16x16x32_bf16 v[124:127], v[64:67], v[52:55], v[124:127]
  v_mfma_f32_16x16x32_bf16 v[128:131], v[68:71], v[52:55], v[128:131]
  v_mfma_f32_16x16x32_bf16 v[132:135], v[72:75], v[52:55], v[132:135]
  v_mfma_f32_16x16x32_bf16 v[136:139], v[76:79], v[52:55], v[136:139]
  v_mfma_f32_16x16x32_bf16 v[140:143], v[60:63], v[56:59], v[140:143]
  v_mfma_f32_16x16x32_bf16 v[144:147], v[64:67], v[56:59], v[144:147]
  v_mfma_f32_16x16x32_bf16 v[148:151], v[68:71], v[56:59], v[148:151]
  v_mfma_f32_16x16x32_bf16 v[152:155], v[72:75], v[56:59], v[152:155]
  v_mfma_f32_16x16x32_bf16 v[156:159], v[76:79], v[56:59], v[156:159]
  s_nop 7
  s_cmp_gt_u32 s64, 7
  s_cbranch_scc1 K2_TX22
  ds_read_b32 v164, v162
  s_waitcnt lgkmcnt(0)
  v_readfirstlane_b32 s10, v164
  s_nop 0
  s_cmp_lt_u32 s10, 4
  s_cbranch_scc1 K2_TX22
  s_add_u32 m0, s66, 0
  s_add_u32 s3, s65, 0
  buffer_load_dwordx4 v1, s[40:43], s3 offen lds
  s_add_u32 m0, s66, 1024
  s_add_u32 s3, s65, 1024
  buffer_load_dwordx4 v1, s[40:43], s3 offen lds
  s_add_u32 m0, s66, 2048
  s_add_u32 s3, s65, 2048
  buffer_load_dwordx4 v1, s[40:43], s3 offen lds
  s_add_u32 m0, s66, 3072
  s_add_u32 s3, s65, 3072
  buffer_load_dwordx4 v1, s[40:43], s3 offen lds
  s_add_u32 m0, s66, 4096
  s_add_u32 s3, s65, 4096
  buffer_load_dwordx4 v1, s[40:43], s3 offen lds
  s_add_u32 s64, s64, 1
  s_add_u32 s65, s65, 10240
  v_add_u32 v162, 4, v162
  s_add_u32 s67, s67, 1
  s_add_u32 s66, s66, 10240
  s_cmp_eq_u32 s67, 3
  s_cselect_b32 s67, 0, s67
  s_cselect_b32 s66, s58, s66
  s_waitcnt vmcnt(0)
  s_mov_b64 exec, 1
  ds_add_u32 v163, v161 offset:0
  s_mov_b64 exec, -1
  v_add_u32 v163, 4, v163
K2_TX22:
  ds_write_b128 v3, v[80:83] offset:0
  ds_write_b128 v3, v[84:87] offset:1024
  ds_write_b128 v3, v[88:91] offset:2048
  ds_write_b128 v3, v[92:95] offset:3072
  ds_write_b128 v3, v[96:99] offset:4096
  ds_write_b128 v3, v[100:103] offset:5120
  ds_write_b128 v3, v[104:107] offset:6144
  ds_write_b128 v3, v[108:111] offset:7168
  ds_write_b128 v3, v[112:115] offset:8192
  ds_write_b128 v3, v[116:119] offset:9216
  ds_write_b128 v3, v[120:123] offset:10240
  ds_write_b128 v3, v[124:127] offset:11264
  ds_write_b128 v3, v[128:131] offset:12288
  ds_write_b128 v3, v[132:135] offset:13312
  ds_write_b128 v3, v[136:139] offset:14336
  ds_write_b128 v3, v[140:143] offset:15360
  ds_write_b128 v3, v[144:147] offset:16384
  ds_write_b128 v3, v[148:151] offset:17408
  ds_write_b128 v3, v[152:155] offset:18432
  ds_write_b128 v3, v[156:159] offset:19456
  s_cmp_gt_u32 s64, 7
  s_cbranch_scc1 K2_TX23
  ds_read_b32 v164, v162
  s_waitcnt lgkmcnt(0)
  v_readfirstlane_b32 s10, v164
  s_nop 0
  s_cmp_lt_u32 s10, 4
  s_cbranch_scc1 K2_TX23
  s_add_u32 m0, s66, 0
  s_add_u32 s3, s65, 0
  buffer_load_dwordx4 v1, s[40:43], s3 offen lds
  s_add_u32 m0, s66, 1024
  s_add_u32 s3, s65, 1024
  buffer_load_dwordx4 v1, s[40:43], s3 offen lds
  s_add_u32 m0, s66, 2048
  s_add_u32 s3, s65, 2048
  buffer_load_dwordx4 v1, s[40:43], s3 offen lds
  s_add_u32 m0, s66, 3072
  s_add_u32 s3, s65, 3072
  buffer_load_dwordx4 v1, s[40:43], s3 offen lds
  s_add_u32 m0, s66, 4096
  s_add_u32 s3, s65, 4096
  buffer_load_dwordx4 v1, s[40:43], s3 offen lds
  s_add_u32 s64, s64, 1
  s_add_u32 s65, s65, 10240
  v_add_u32 v162, 4, v162
  s_add_u32 s67, s67, 1
  s_add_u32 s66, s66, 10240
  s_cmp_eq_u32 s67, 3
  s_cselect_b32 s67, 0, s67
  s_cselect_b32 s66, s58, s66
  s_waitcnt vmcnt(0)
  s_mov_b64 exec, 1
  ds_add_u32 v163, v161 offset:0
  s_mov_b64 exec, -1
  v_add_u32 v163, 4, v163
K2_TX23:
  v_mov_b32 v7, 159136
  s_waitcnt lgkmcnt(0)
  s_mov_b64 exec, 1
  ds_add_u32 v7, v161 offset:0
  s_mov_b64 exec, -1
  s_mov_b32 s11, 262144
K2_SP4:
  ds_read_b32 v164, v7 offset:0
  s_waitcnt lgkmcnt(0)
  v_readfirstlane_b32 s10, v164
  s_sub_u32 s11, s11, 1
  s_cmp_eq_u32 s11, 0
  s_cbranch_scc1 K2_SX4
  s_cmp_ge_u32 s10, 4
  s_cbranch_scc1 K2_SX4
  s_cmp_gt_u32 s64, 7
  s_cbranch_scc1 K2_TX24
  ds_read_b32 v164, v162
  s_waitcnt lgkmcnt(0)
  v_readfirstlane_b32 s10, v164
  s_nop 0
  s_cmp_lt_u32 s10, 4
  s_cbranch_scc1 K2_TX24
  s_add_u32 m0, s66, 0
  s_add_u32 s3, s65, 0
  buffer_load_dwordx4 v1, s[40:43], s3 offen lds
  s_add_u32 m0, s66, 1024
  s_add_u32 s3, s65, 1024
  buffer_load_dwordx4 v1, s[40:43], s3 offen lds
  s_add_u32 m0, s66, 2048
  s_add_u32 s3, s65, 2048
  buffer_load_dwordx4 v1, s[40:43], s3 offen lds
  s_add_u32 m0, s66, 3072
  s_add_u32 s3, s65, 3072
  buffer_load_dwordx4 v1, s[40:43], s3 offen lds
  s_add_u32 m0, s66, 4096
  s_add_u32 s3, s65, 4096
  buffer_load_dwordx4 v1, s[40:43], s3 offen lds
  s_add_u32 s64, s64, 1
  s_add_u32 s65, s65, 10240
  v_add_u32 v162, 4, v162
  s_add_u32 s67, s67, 1
  s_add_u32 s66, s66, 10240
  s_cmp_eq_u32 s67, 3
  s_cselect_b32 s67, 0, s67
  s_cselect_b32 s66, s58, s66
  s_waitcnt vmcnt(0)
  s_mov_b64 exec, 1
  ds_add_u32 v163, v161 offset:0
  s_mov_b64 exec, -1
  v_add_u32 v163, 4, v163
K2_TX24:
  s_sleep 1
  s_branch K2_SP4
K2_SX4:
  ds_read_b128 v[80:83], v4 offset:0
  ds_read_b128 v[84:87], v4 offset:1024
  ds_read_b128 v[88:91], v4 offset:2048
  ds_read_b128 v[92:95], v4 offset:3072
  ds_read_b128 v[96:99], v4 offset:4096
  ds_read_b128 v[100:103], v4 offset:20480
  ds_read_b128 v[104:107], v4 offset:21504
  ds_read_b128 v[108:111], v4 offset:22528
  ds_read_b128 v[112:115], v4 offset:23552
  ds_read_b128 v[116:119], v4 offset:24576
  ds_read_b128 v[120:123], v5 offset:0
  ds_read_b128 v[124:127], v5 offset:1024
  ds_read_b128 v[128:131], v5 offset:2048
  ds_read_b128 v[132:135], v5 offset:3072
  ds_read_b128 v[136:139], v5 offset:4096
  ds_read_b128 v[140:143], v5 offset:20480
  ds_read_b128 v[144:147], v5 offset:21504
  ds_read_b128 v[148:151], v5 offset:22528
  ds_read_b128 v[152:155], v5 offset:23552
  ds_read_b128 v[156:159], v5 offset:24576
  s_waitcnt lgkmcnt(0)
  v_add_f32 v80, v80, v100
  v_add_f32 v120, v120, v140
  v_add_f32 v81, v81, v101
  v_add_f32 v121, v121, v141
  v_add_f32 v82, v82, v102
  v_add_f32 v122, v122, v142
  v_add_f32 v83, v83, v103
  v_add_f32 v123, v123, v143
  v_add_f32 v84, v84, v104
  v_add_f32 v124, v124, v144
  v_add_f32 v85, v85, v105
  v_add_f32 v125, v125, v145
  v_add_f32 v86, v86, v106
  v_add_f32 v126, v126, v146
  v_add_f32 v87, v87, v107
  v_add_f32 v127, v127, v147
  v_add_f32 v88, v88, v108
  v_add_f32 v128, v128, v148
  v_add_f32 v89, v89, v109
  v_add_f32 v129, v129, v149
  v_add_f32 v90, v90, v110
  v_add_f32 v130, v130, v150
  v_add_f32 v91, v91, v111
  v_add_f32 v131, v131, v151
  v_add_f32 v92, v92, v112
  v_add_f32 v132, v132, v152
  v_add_f32 v93, v93, v113
  v_add_f32 v133, v133, v153
  v_add_f32 v94, v94, v114
  v_add_f32 v134, v134, v154
  v_add_f32 v95, v95, v115
  v_add_f32 v135, v135, v155
  v_add_f32 v96, v96, v116
  v_add_f32 v136, v136, v156
  v_add_f32 v97, v97, v117
  v_add_f32 v137, v137, v157
  v_add_f32 v98, v98, v118
  v_add_f32 v138, v138, v158
  v_add_f32 v99, v99, v119
  v_add_f32 v139, v139, v159
  v_add_f32 v8, v80, v120
  v_add_f32 v9, v81, v121
  v_add_f32 v10, v82, v122
  v_add_f32 v11, v83, v123
  v_add_f32 v12, v84, v124
  v_add_f32 v13, v85, v125
  v_add_f32 v14, v86, v126
  v_add_f32 v15, v87, v127
  v_add_f32 v16, v88, v128
  v_add_f32 v17, v89, v129
  v_add_f32 v18, v90, v130
  v_add_f32 v19, v91, v131
  v_add_f32 v20, v92, v132
  v_add_f32 v21, v93, v133
  v_add_f32 v22, v94, v134
  v_add_f32 v23, v95, v135
  v_add_f32 v24, v96, v136
  v_add_f32 v25, v97, v137
  v_add_f32 v26, v98, v138
  v_add_f32 v27, v99, v139
  s_cmp_gt_u32 s64, 7
  s_cbranch_scc1 K2_TX25
  ds_read_b32 v164, v162
  s_waitcnt lgkmcnt(0)
  v_readfirstlane_b32 s10, v164
  s_nop 0
  s_cmp_lt_u32 s10, 4
  s_cbranch_scc1 K2_TX25
  s_add_u32 m0, s66, 0
  s_add_u32 s3, s65, 0
  buffer_load_dwordx4 v1, s[40:43], s3 offen lds
  s_add_u32 m0, s66, 1024
  s_add_u32 s3, s65, 1024
  buffer_load_dwordx4 v1, s[40:43], s3 offen lds
  s_add_u32 m0, s66, 2048
  s_add_u32 s3, s65, 2048
  buffer_load_dwordx4 v1, s[40:43], s3 offen lds
  s_add_u32 m0, s66, 3072
  s_add_u32 s3, s65, 3072
  buffer_load_dwordx4 v1, s[40:43], s3 offen lds
  s_add_u32 m0, s66, 4096
  s_add_u32 s3, s65, 4096
  buffer_load_dwordx4 v1, s[40:43], s3 offen lds
  s_add_u32 s64, s64, 1
  s_add_u32 s65, s65, 10240
  v_add_u32 v162, 4, v162
  s_add_u32 s67, s67, 1
  s_add_u32 s66, s66, 10240
  s_cmp_eq_u32 s67, 3
  s_cselect_b32 s67, 0, s67
  s_cselect_b32 s66, s58, s66
  s_waitcnt vmcnt(0)
  s_mov_b64 exec, 1
  ds_add_u32 v163, v161 offset:0
  s_mov_b64 exec, -1
  v_add_u32 v163, 4, v163
K2_TX25:
  s_mov_b64 exec, 1
  ds_add_u32 v7, v161 offset:4
  s_mov_b64 exec, -1
  v_mul_f32 v8, v6, v8
  v_mul_f32 v9, v6, v9
  v_mul_f32 v10, v6, v10
  v_mul_f32 v11, v6, v11
  v_mul_f32 v12, v6, v12
  v_mul_f32 v13, v6, v13
  v_mul_f32 v14, v6, v14
  v_mul_f32 v15, v6, v15
  v_mul_f32 v16, v6, v16
  v_mul_f32 v17, v6, v17
  v_mul_f32 v18, v6, v18
  v_mul_f32 v19, v6, v19
  v_mul_f32 v20, v6, v20
  v_mul_f32 v21, v6, v21
  v_mul_f32 v22, v6, v22
  v_mul_f32 v23, v6, v23
  v_mul_f32 v24, v6, v24
  v_mul_f32 v25, v6, v25
  v_mul_f32 v26, v6, v26
  v_mul_f32 v27, v6, v27
  v_cvt_pk_bf16_f32 v148, v8, v9
  v_cvt_pk_bf16_f32 v149, v10, v11
  v_cvt_pk_bf16_f32 v150, v12, v13
  v_cvt_pk_bf16_f32 v151, v14, v15
  v_cvt_pk_bf16_f32 v152, v16, v17
  v_cvt_pk_bf16_f32 v153, v18, v19
  v_cvt_pk_bf16_f32 v154, v20, v21
  v_cvt_pk_bf16_f32 v155, v22, v23
  v_cvt_pk_bf16_f32 v156, v24, v25
  v_cvt_pk_bf16_f32 v157, v26, v27
  s_add_u32 s24, s20, 16777216
  s_addc_u32 s25, s21, 0
  s_and_b32 s25, s25, 0xffff
  s_mov_b32 s26, 819200
  s_mov_b32 s27, 0x00020000
  s_mul_i32 s16, s51, 102400
  s_lshl_b32 s17, s49, 10
  s_add_u32 s16, s16, s17
  s_mov_b32 s11, 262144
K2_SP5:
  ds_read_b32 v164, v7 offset:4
  s_waitcnt lgkmcnt(0)
  v_readfirstlane_b32 s10, v164
  s_sub_u32 s11, s11, 1
  s_cmp_eq_u32 s11, 0
  s_cbranch_scc1 K2_SX5
  s_cmp_ge_u32 s10, 4
  s_cbranch_scc1 K2_SX5
  s_cmp_gt_u32 s64, 7
  s_cbranch_scc1 K2_TX26
  ds_read_b32 v164, v162
  s_waitcnt lgkmcnt(0)
  v_readfirstlane_b32 s10, v164
  s_nop 0
  s_cmp_lt_u32 s10, 4
  s_cbranch_scc1 K2_TX26
  s_add_u32 m0, s66, 0
  s_add_u32 s3, s65, 0
  buffer_load_dwordx4 v1, s[40:43], s3 offen lds
  s_add_u32 m0, s66, 1024
  s_add_u32 s3, s65, 1024
  buffer_load_dwordx4 v1, s[40:43], s3 offen lds
  s_add_u32 m0, s66, 2048
  s_add_u32 s3, s65, 2048
  buffer_load_dwordx4 v1, s[40:43], s3 offen lds
  s_add_u32 m0, s66, 3072
  s_add_u32 s3, s65, 3072
  buffer_load_dwordx4 v1, s[40:43], s3 offen lds
  s_add_u32 m0, s66, 4096
  s_add_u32 s3, s65, 4096
  buffer_load_dwordx4 v1, s[40:43], s3 offen lds
  s_add_u32 s64, s64, 1
  s_add_u32 s65, s65, 10240
  v_add_u32 v162, 4, v162
  s_add_u32 s67, s67, 1
  s_add_u32 s66, s66, 10240
  s_cmp_eq_u32 s67, 3
  s_cselect_b32 s67, 0, s67
  s_cselect_b32 s66, s58, s66
  s_waitcnt vmcnt(0)
  s_mov_b64 exec, 1
  ds_add_u32 v163, v161 offset:0
  s_mov_b64 exec, -1
  v_add_u32 v163, 4, v163
K2_TX26:
  s_sleep 1
  s_branch K2_SP5
K2_SX5:
  s_cmp_gt_u32 s64, 7
  s_cbranch_scc1 K2_TX27
  ds_read_b32 v164, v162
  s_waitcnt lgkmcnt(0)
  v_readfirstlane_b32 s10, v164
  s_nop 0
  s_cmp_lt_u32 s10, 4
  s_cbranch_scc1 K2_TX27
  s_add_u32 m0, s66, 0
  s_add_u32 s3, s65, 0
  buffer_load_dwordx4 v1, s[40:43], s3 offen lds
  s_add_u32 m0, s66, 1024
  s_add_u32 s3, s65, 1024
  buffer_load_dwordx4 v1, s[40:43], s3 offen lds
  s_add_u32 m0, s66, 2048
  s_add_u32 s3, s65, 2048
  buffer_load_dwordx4 v1, s[40:43], s3 offen lds
  s_add_u32 m0, s66, 3072
  s_add_u32 s3, s65, 3072
  buffer_load_dwordx4 v1, s[40:43], s3 offen lds
  s_add_u32 m0, s66, 4096
  s_add_u32 s3, s65, 4096
  buffer_load_dwordx4 v1, s[40:43], s3 offen lds
  s_add_u32 s64, s64, 1
  s_add_u32 s65, s65, 10240
  v_add_u32 v162, 4, v162
  s_add_u32 s67, s67, 1
  s_add_u32 s66, s66, 10240
  s_cmp_eq_u32 s67, 3
  s_cselect_b32 s67, 0, s67
  s_cselect_b32 s66, s58, s66
  s_mov_b32 s68, 1
K2_TX27:
  s_add_u32 m0, s17, 61440
  s_add_u32 s18, s16, 0
  buffer_load_dwordx4 v1, s[24:27], s18 offen lds
  s_add_u32 m0, s17, 65536
  s_add_u32 s18, s16, 4096
  buffer_load_dwordx4 v1, s[24:27], s18 offen lds
  s_add_u32 m0, s17, 69632
  s_add_u32 s18, s16, 8192
  buffer_load_dwordx4 v1, s[24:27], s18 offen lds
  s_add_u32 m0, s17, 73728
  s_add_u32 s18, s16, 12288
  buffer_load_dwordx4 v1, s[24:27], s18 offen lds
  s_waitcnt vmcnt(4)
  s_cmp_eq_u32 s68, 0
  s_cbranch_scc1 K2_TX28
  s_mov_b64 exec, 1
  ds_add_u32 v163, v161 offset:0
  s_mov_b64 exec, -1
  v_add_u32 v163, 4, v163
  s_mov_b32 s68, 0
K2_TX28:
  s_cmp_gt_u32 s64, 7
  s_cbranch_scc1 K2_TX29
  ds_read_b32 v164, v162
  s_waitcnt lgkmcnt(0)
  v_readfirstlane_b32 s10, v164
  s_nop 0
  s_cmp_lt_u32 s10, 4
  s_cbranch_scc1 K2_TX29
  s_add_u32 m0, s66, 0
  s_add_u32 s3, s65, 0
  buffer_load_dwordx4 v1, s[40:43], s3 offen lds
  s_add_u32 m0, s66, 1024
  s_add_u32 s3, s65, 1024
  buffer_load_dwordx4 v1, s[40:43], s3 offen lds
  s_add_u32 m0, s66, 2048
  s_add_u32 s3, s65, 2048
  buffer_load_dwordx4 v1, s[40:43], s3 offen lds
  s_add_u32 m0, s66, 3072
  s_add_u32 s3, s65, 3072
  buffer_load_dwordx4 v1, s[40:43], s3 offen lds
  s_add_u32 m0, s66, 4096
  s_add_u32 s3, s65, 4096
  buffer_load_dwordx4 v1, s[40:43], s3 offen lds
  s_add_u32 s64, s64, 1
  s_add_u32 s65, s65, 10240
  v_add_u32 v162, 4, v162
  s_add_u32 s67, s67, 1
  s_add_u32 s66, s66, 10240
  s_cmp_eq_u32 s67, 3
  s_cselect_b32 s67, 0, s67
  s_cselect_b32 s66, s58, s66
  s_mov_b32 s68, 1
K2_TX29:
  s_add_u32 m0, s17, 77824
  s_add_u32 s18, s16, 16384
  buffer_load_dwordx4 v1, s[24:27], s18 offen lds
  s_add_u32 m0, s17, 81920
  s_add_u32 s18, s16, 20480
  buffer_load_dwordx4 v1, s[24:27], s18 offen lds
  s_add_u32 m0, s17, 86016
  s_add_u32 s18, s16, 24576
  buffer_load_dwordx4 v1, s[24:27], s18 offen lds
  s_add_u32 m0, s17, 90112
  s_add_u32 s18, s16, 28672
  buffer_load_dwordx4 v1, s[24:27], s18 offen lds
  s_waitcnt vmcnt(4)
  s_cmp_eq_u32 s68, 0
  s_cbranch_scc1 K2_TX30
  s_mov_b64 exec, 1
  ds_add_u32 v163, v161 offset:0
  s_mov_b64 exec, -1
  v_add_u32 v163, 4, v163
  s_mov_b32 s68, 0
K2_TX30:
  s_cmp_gt_u32 s64, 7
  s_cbranch_scc1 K2_TX31
  ds_read_b32 v164, v162
  s_waitcnt lgkmcnt(0)
  v_readfirstlane_b32 s10, v164
  s_nop 0
  s_cmp_lt_u32 s10, 4
  s_cbranch_scc1 K2_TX31
  s_add_u32 m0, s66, 0
  s_add_u32 s3, s65, 0
  buffer_load_dwordx4 v1, s[40:43], s3 offen lds
  s_add_u32 m0, s66, 1024
  s_add_u32 s3, s65, 1024
  buffer_load_dwordx4 v1, s[40:43], s3 offen lds
  s_add_u32 m0, s66, 2048
  s_add_u32 s3, s65, 2048
  buffer_load_dwordx4 v1, s[40:43], s3 offen lds
  s_add_u32 m0, s66, 3072
  s_add_u32 s3, s65, 3072
  buffer_load_dwordx4 v1, s[40:43], s3 offen lds
  s_add_u32 m0, s66, 4096
  s_add_u32 s3, s65, 4096
  buffer_load_dwordx4 v1, s[40:43], s3 offen lds
  s_add_u32 s64, s64, 1
  s_add_u32 s65, s65, 10240
  v_add_u32 v162, 4, v162
  s_add_u32 s67, s67, 1
  s_add_u32 s66, s66, 10240
  s_cmp_eq_u32 s67, 3
  s_cselect_b32 s67, 0, s67
  s_cselect_b32 s66, s58, s66
  s_mov_b32 s68, 1
K2_TX31:
  s_add_u32 m0, s17, 94208
  s_add_u32 s18, s16, 32768
  buffer_load_dwordx4 v1, s[24:27], s18 offen lds
  s_add_u32 m0, s17, 98304
  s_add_u32 s18, s16, 36864
  buffer_load_dwordx4 v1, s[24:27], s18 offen lds
  s_add_u32 m0, s17, 102400
  s_add_u32 s18, s16, 40960
  buffer_load_dwordx4 v1, s[24:27], s18 offen lds
  s_add_u32 m0, s17, 106496
  s_add_u32 s18, s16, 45056
  buffer_load_dwordx4 v1, s[24:27], s18 offen lds
  s_waitcnt vmcnt(4)
  s_cmp_eq_u32 s68, 0
  s_cbranch_scc1 K2_TX32
  s_mov_b64 exec, 1
  ds_add_u32 v163, v161 offset:0
  s_mov_b64 exec, -1
  v_add_u32 v163, 4, v163
  s_mov_b32 s68, 0
K2_TX32:
  s_cmp_gt_u32 s64, 7
  s_cbranch_scc1 K2_TX33
  ds_read_b32 v164, v162
  s_waitcnt lgkmcnt(0)
  v_readfirstlane_b32 s10, v164
  s_nop 0
  s_cmp_lt_u32 s10, 4
  s_cbranch_scc1 K2_TX33
  s_add_u32 m0, s66, 0
  s_add_u32 s3, s65, 0
  buffer_load_dwordx4 v1, s[40:43], s3 offen lds
  s_add_u32 m0, s66, 1024
  s_add_u32 s3, s65, 1024
  buffer_load_dwordx4 v1, s[40:43], s3 offen lds
  s_add_u32 m0, s66, 2048
  s_add_u32 s3, s65, 2048
  buffer_load_dwordx4 v1, s[40:43], s3 offen lds
  s_add_u32 m0, s66, 3072
  s_add_u32 s3, s65, 3072
  buffer_load_dwordx4 v1, s[40:43], s3 offen lds
  s_add_u32 m0, s66, 4096
  s_add_u32 s3, s65, 4096
  buffer_load_dwordx4 v1, s[40:43], s3 offen lds
  s_add_u32 s64, s64, 1
  s_add_u32 s65, s65, 10240
  v_add_u32 v162, 4, v162
  s_add_u32 s67, s67, 1
  s_add_u32 s66, s66, 10240
  s_cmp_eq_u32 s67, 3
  s_cselect_b32 s67, 0, s67
  s_cselect_b32 s66, s58, s66
  s_mov_b32 s68, 1
K2_TX33:
  s_add_u32 m0, s17, 110592
  s_add_u32 s18, s16, 49152
  buffer_load_dwordx4 v1, s[24:27], s18 offen lds
  s_add_u32 m0, s17, 114688
  s_add_u32 s18, s16, 53248
  buffer_load_dwordx4 v1, s[24:27], s18 offen lds
  s_add_u32 m0, s17, 118784
  s_add_u32 s18, s16, 57344
  buffer_load_dwordx4 v1, s[24:27], s18 offen lds
  s_add_u32 m0, s17, 122880
  s_add_u32 s18, s16, 61440
  buffer_load_dwordx4 v1, s[24:27], s18 offen lds
  s_waitcnt vmcnt(4)
  s_cmp_eq_u32 s68, 0
  s_cbranch_scc1 K2_TX34
  s_mov_b64 exec, 1
  ds_add_u32 v163, v161 offset:0
  s_mov_b64 exec, -1
  v_add_u32 v163, 4, v163
  s_mov_b32 s68, 0
K2_TX34:
  s_cmp_gt_u32 s64, 7
  s_cbranch_scc1 K2_TX35
  ds_read_b32 v164, v162
  s_waitcnt lgkmcnt(0)
  v_readfirstlane_b32 s10, v164
  s_nop 0
  s_cmp_lt_u32 s10, 4
  s_cbranch_scc1 K2_TX35
  s_add_u32 m0, s66, 0
  s_add_u32 s3, s65, 0
  buffer_load_dwordx4 v1, s[40:43], s3 offen lds
  s_add_u32 m0, s66, 1024
  s_add_u32 s3, s65, 1024
  buffer_load_dwordx4 v1, s[40:43], s3 offen lds
  s_add_u32 m0, s66, 2048
  s_add_u32 s3, s65, 2048
  buffer_load_dwordx4 v1, s[40:43], s3 offen lds
  s_add_u32 m0, s66, 3072
  s_add_u32 s3, s65, 3072
  buffer_load_dwordx4 v1, s[40:43], s3 offen lds
  s_add_u32 m0, s66, 4096
  s_add_u32 s3, s65, 4096
  buffer_load_dwordx4 v1, s[40:43], s3 offen lds
  s_add_u32 s64, s64, 1
  s_add_u32 s65, s65, 10240
  v_add_u32 v162, 4, v162
  s_add_u32 s67, s67, 1
  s_add_u32 s66, s66, 10240
  s_cmp_eq_u32 s67, 3
  s_cselect_b32 s67, 0, s67
  s_cselect_b32 s66, s58, s66
  s_mov_b32 s68, 1
K2_TX35:
  s_add_u32 m0, s17, 126976
  s_add_u32 s18, s16, 65536
  buffer_load_dwordx4 v1, s[24:27], s18 offen lds
  s_add_u32 m0, s17, 131072
  s_add_u32 s18, s16, 69632
  buffer_load_dwordx4 v1, s[24:27], s18 offen lds
  s_add_u32 m0, s17, 135168
  s_add_u32 s18, s16, 73728
  buffer_load_dwordx4 v1, s[24:27], s18 offen lds
  s_add_u32 m0, s17, 139264
  s_add_u32 s18, s16, 77824
  buffer_load_dwordx4 v1, s[24:27], s18 offen lds
  s_waitcnt vmcnt(4)
  s_cmp_eq_u32 s68, 0
  s_cbranch_scc1 K2_TX36
  s_mov_b64 exec, 1
  ds_add_u32 v163, v161 offset:0
  s_mov_b64 exec, -1
  v_add_u32 v163, 4, v163
  s_mov_b32 s68, 0
K2_TX36:
  s_cmp_gt_u32 s64, 7
  s_cbranch_scc1 K2_TX37
  ds_read_b32 v164, v162
  s_waitcnt lgkmcnt(0)
  v_readfirstlane_b32 s10, v164
  s_nop 0
  s_cmp_lt_u32 s10, 4
  s_cbranch_scc1 K2_TX37
  s_add_u32 m0, s66, 0
  s_add_u32 s3, s65, 0
  buffer_load_dwordx4 v1, s[40:43], s3 offen lds
  s_add_u32 m0, s66, 1024
  s_add_u32 s3, s65, 1024
  buffer_load_dwordx4 v1, s[40:43], s3 offen lds
  s_add_u32 m0, s66, 2048
  s_add_u32 s3, s65, 2048
  buffer_load_dwordx4 v1, s[40:43], s3 offen lds
  s_add_u32 m0, s66, 3072
  s_add_u32 s3, s65, 3072
  buffer_load_dwordx4 v1, s[40:43], s3 offen lds
  s_add_u32 m0, s66, 4096
  s_add_u32 s3, s65, 4096
  buffer_load_dwordx4 v1, s[40:43], s3 offen lds
  s_add_u32 s64, s64, 1
  s_add_u32 s65, s65, 10240
  v_add_u32 v162, 4, v162
  s_add_u32 s67, s67, 1
  s_add_u32 s66, s66, 10240
  s_cmp_eq_u32 s67, 3
  s_cselect_b32 s67, 0, s67
  s_cselect_b32 s66, s58, s66
  s_mov_b32 s68, 1
K2_TX37:
  s_add_u32 m0, s17, 143360
  s_add_u32 s18, s16, 81920
  buffer_load_dwordx4 v1, s[24:27], s18 offen lds
  s_add_u32 m0, s17, 147456
  s_add_u32 s18, s16, 86016
  buffer_load_dwordx4 v1, s[24:27], s18 offen lds
  s_add_u32 m0, s17, 151552
  s_add_u32 s18, s16, 90112
  buffer_load_dwordx4 v1, s[24:27], s18 offen lds
  s_waitcnt vmcnt(3)
  s_cmp_eq_u32 s68, 0
  s_cbranch_scc1 K2_TX38
  s_mov_b64 exec, 1
  ds_add_u32 v163, v161 offset:0
  s_mov_b64 exec, -1
  v_add_u32 v163, 4, v163
  s_mov_b32 s68, 0
K2_TX38:
  s_mov_b32 s9, 262144
K2_TB39:
  s_cmp_gt_u32 s64, 7
  s_cbranch_scc1 K2_TX39
  ds_read_b32 v164, v162
  s_waitcnt lgkmcnt(0)
  v_readfirstlane_b32 s10, v164
  s_nop 0
  s_sub_u32 s9, s9, 1
  s_cmp_eq_u32 s9, 0
  s_cbranch_scc1 K2_TX39
  s_cmp_lt_u32 s10, 4
  s_cbranch_scc1 K2_TW39
  s_add_u32 m0, s66, 0
  s_add_u32 s3, s65, 0
  buffer_load_dwordx4 v1, s[40:43], s3 offen lds
  s_add_u32 m0, s66, 1024
  s_add_u32 s3, s65, 1024
  buffer_load_dwordx4 v1, s[40:43], s3 offen lds
  s_add_u32 m0, s66, 2048
  s_add_u32 s3, s65, 2048
  buffer_load_dwordx4 v1, s[40:43], s3 offen lds
  s_add_u32 m0, s66, 3072
  s_add_u32 s3, s65, 3072
  buffer_load_dwordx4 v1, s[40:43], s3 offen lds
  s_add_u32 m0, s66, 4096
  s_add_u32 s3, s65, 4096
  buffer_load_dwordx4 v1, s[40:43], s3 offen lds
  s_add_u32 s64, s64, 1
  s_add_u32 s65, s65, 10240
  v_add_u32 v162, 4, v162
  s_add_u32 s67, s67, 1
  s_add_u32 s66, s66, 10240
  s_cmp_eq_u32 s67, 3
  s_cselect_b32 s67, 0, s67
  s_cselect_b32 s66, s58, s66
  s_waitcnt vmcnt(0)
  s_mov_b64 exec, 1
  ds_add_u32 v163, v161 offset:0
  s_mov_b64 exec, -1
  v_add_u32 v163, 4, v163
  s_branch K2_TB39
K2_TW39:
  s_sleep 2
  s_branch K2_TB39
K2_TX39:
  v_mov_b32 v7, 158932
  s_mov_b32 s9, 262144
K2_SP6:
  ds_read_b32 v164, v7 offset:0
  s_waitcnt lgkmcnt(0)
  v_readfirstlane_b32 s10, v164
  s_sub_u32 s9, s9, 1
  s_cmp_eq_u32 s9, 0
  s_cbranch_scc1 K2_SX6
  s_cmp_ge_u32 s10, 4
  s_cbranch_scc1 K2_SX6
  s_sleep 1
  s_branch K2_SP6
K2_SX6:
  s_cmp_eq_u32 s49, 3
  s_cselect_b32 s3, 20480, 0
  s_cselect_b32 s4, 0, 1
  s_add_u32 s5, s17, 155648
  s_mul_i32 s5, s5, s4
  s_add_u32 m0, s5, s3
  s_add_u32 s18, s16, 94208
  buffer_load_dwordx4 v1, s[24:27], s18 offen lds
  s_add_u32 m0, s17, 21504
  s_add_u32 s18, s16, 98304
  buffer_load_dwordx4 v1, s[24:27], s18 offen lds
  s_mov_b32 s52, s12
  s_and_b32 s53, s13, 0xffff
  s_mov_b32 s54, 2621440
  s_mov_b32 s55, 0x00020000
  s_add_u32 s28, s20, 17825792
  s_addc_u32 s29, s21, 0
  s_and_b32 s29, s29, 0xffff
  s_mov_b32 s30, 2621440
  s_mov_b32 s31, 0x00020000
  s_lshl_b32 s3, s50, 6
  s_lshl_b32 s8, s49, 4
  s_add_u32 s3, s3, s8
  v_and_b32 v3, 15, v0
  v_add_u32 v3, s3, v3
  v_mul_u32_u24 v3, 1280, v3
  v_lshrrev_b32 v4, 4, v0
  v_lshl_add_u32 v3, v4, 3, v3
  s_mul_i32 s3, s51, 160
  v_add_u32 v3, s3, v3
  buffer_load_dwordx2 v[158:159], v3, s[52:55], 0 offen offset:0
  buffer_load_dwordx2 v[160:161], v3, s[52:55], 0 offen offset:32
  buffer_load_dwordx2 v[162:163], v3, s[52:55], 0 offen offset:64
  buffer_load_dwordx2 v[164:165], v3, s[52:55], 0 offen offset:96
  buffer_load_dwordx2 v[166:167], v3, s[52:55], 0 offen offset:128
  s_waitcnt vmcnt(0)
  s_barrier
  s_barrier
  v_mov_b32 v11, 159104
  ds_read_b128 v[12:15], v11
  ds_read_b128 v[16:19], v11 offset:16
  s_waitcnt lgkmcnt(0)
  v_or_b32 v12, v12, v13
  v_or_b32 v12, v12, v14
  v_or_b32 v12, v12, v15
  v_or_b32 v12, v12, v16
  v_or_b32 v12, v12, v17
  v_or_b32 v12, v12, v18
  v_or_b32 v12, v12, v19
  s_nop 0
  v_readfirstlane_b32 s7, v12
  s_nop 1
  s_cmp_eq_u32 s7, 0
  s_cbranch_scc1 K2_FFN_GO
  s_mov_b32 s11, 0
  s_mul_i32 s3, s45, 96
  s_add_u32 s3, s3, 158720
  v_mov_b32 v8, s3
  v_mov_b32 v9, 1
K2_FFN_PASS:
  v_add_u32 v8, 32, v8
  s_add_u32 m0, s58, 0
  s_add_u32 s3, s57, 0
  buffer_load_dwordx4 v1, s[40:43], s3 offen lds
  s_add_u32 m0, s58, 1024
  s_add_u32 s3, s57, 1024
  buffer_load_dwordx4 v1, s[40:43], s3 offen lds
  s_add_u32 m0, s58, 2048
  s_add_u32 s3, s57, 2048
  buffer_load_dwordx4 v1, s[40:43], s3 offen lds
  s_add_u32 m0, s58, 3072
  s_add_u32 s3, s57, 3072
  buffer_load_dwordx4 v1, s[40:43], s3 offen lds
  s_add_u32 m0, s58, 4096
  s_add_u32 s3, s57, 4096
  buffer_load_dwordx4 v1, s[40:43], s3 offen lds
  s_add_u32 m0, s58, 10240
  s_add_u32 s3, s57, 10240
  buffer_load_dwordx4 v1, s[40:43], s3 offen lds
  s_add_u32 m0, s58, 11264
  s_add_u32 s3, s57, 11264
  buffer_load_dwordx4 v1, s[40:43], s3 offen lds
  s_add_u32 m0, s58, 12288
  s_add_u32 s3, s57, 12288
  buffer_load_dwordx4 v1, s[40:43], s3 offen lds
  s_add_u32 m0, s58, 13312
  s_add_u32 s3, s57, 13312
  buffer_load_dwordx4 v1, s[40:43], s3 offen lds
  s_add_u32 m0, s58, 14336
  s_add_u32 s3, s57, 14336
  buffer_load_dwordx4 v1, s[40:43], s3 offen lds
  s_add_u32 m0, s58, 20480
  s_add_u32 s3, s57, 20480
  buffer_load_dwordx4 v1, s[40:43], s3 offen lds
  s_add_u32 m0, s58, 21504
  s_add_u32 s3, s57, 21504
  buffer_load_dwordx4 v1, s[40:43], s3 offen lds
  s_add_u32 m0, s58, 22528
  s_add_u32 s3, s57, 22528
  buffer_load_dwordx4 v1, s[40:43], s3 offen lds
  s_add_u32 m0, s58, 23552
  s_add_u32 s3, s57, 23552
  buffer_load_dwordx4 v1, s[40:43], s3 offen lds
  s_add_u32 m0, s58, 24576
  s_add_u32 s3, s57, 24576
  buffer_load_dwordx4 v1, s[40:43], s3 offen lds
  s_waitcnt vmcnt(10)
  s_mov_b64 exec, 1
  ds_add_u32 v8, v9 offset:0
  s_mov_b64 exec, -1
  s_waitcnt vmcnt(5)
  s_mov_b64 exec, 1
  ds_add_u32 v8, v9 offset:4
  s_mov_b64 exec, -1
  s_waitcnt vmcnt(0)
  s_mov_b64 exec, 1
  ds_add_u32 v8, v9 offset:8
  s_mov_b64 exec, -1
  s_mov_b32 s9, 262144
K2_SP7:
  ds_read_b32 v10, v8 offset:192
  s_waitcnt lgkmcnt(0)
  v_readfirstlane_b32 s10, v10
  s_sub_u32 s9, s9, 1
  s_cmp_eq_u32 s9, 0
  s_cbranch_scc1 K2_SX7
  s_cmp_ge_u32 s10, 4
  s_cbranch_scc1 K2_SX7
  s_sleep 1
  s_branch K2_SP7
K2_SX7:
  s_add_u32 m0, s58, 0
  s_add_u32 s3, s57, 30720
  buffer_load_dwordx4 v1, s[40:43], s3 offen lds
  s_add_u32 m0, s58, 1024
  s_add_u32 s3, s57, 31744
  buffer_load_dwordx4 v1, s[40:43], s3 offen lds
  s_add_u32 m0, s58, 2048
  s_add_u32 s3, s57, 32768
  buffer_load_dwordx4 v1, s[40:43], s3 offen lds
  s_add_u32 m0, s58, 3072
  s_add_u32 s3, s57, 33792
  buffer_load_dwordx4 v1, s[40:43], s3 offen lds
  s_add_u32 m0, s58, 4096
  s_add_u32 s3, s57, 34816
  buffer_load_dwordx4 v1, s[40:43], s3 offen lds
  s_waitcnt vmcnt(0)
  s_mov_b64 exec, 1
  ds_add_u32 v8, v9 offset:12
  s_mov_b64 exec, -1
  s_mov_b32 s9, 262144
K2_SP8:
  ds_read_b32 v10, v8 offset:196
  s_waitcnt lgkmcnt(0)
  v_readfirstlane_b32 s10, v10
  s_sub_u32 s9, s9, 1
  s_cmp_eq_u32 s9, 0
  s_cbranch_scc1 K2_SX8
  s_cmp_ge_u32 s10, 4
  s_cbranch_scc1 K2_SX8
  s_sleep 1
  s_branch K2_SP8
K2_SX8:
  s_add_u32 m0, s58, 10240
  s_add_u32 s3, s57, 40960
  buffer_load_dwordx4 v1, s[40:43], s3 offen lds
  s_add_u32 m0, s58, 11264
  s_add_u32 s3, s57, 41984
  buffer_load_dwordx4 v1, s[40:43], s3 offen lds
  s_add_u32 m0, s58, 12288
  s_add_u32 s3, s57, 43008
  buffer_load_dwordx4 v1, s[40:43], s3 offen lds
  s_add_u32 m0, s58, 13312
  s_add_u32 s3, s57, 44032
  buffer_load_dwordx4 v1, s[40:43], s3 offen lds
  s_add_u32 m0, s58, 14336
  s_add_u32 s3, s57, 45056
  buffer_load_dwordx4 v1, s[40:43], s3 offen lds
  s_waitcnt vmcnt(0)
  s_mov_b64 exec, 1
  ds_add_u32 v8, v9 offset:16
  s_mov_b64 exec, -1
  s_mov_b32 s9, 262144
K2_SP9:
  ds_read_b32 v10, v8 offset:200
  s_waitcnt lgkmcnt(0)
  v_readfirstlane_b32 s10, v10
  s_sub_u32 s9, s9, 1
  s_cmp_eq_u32 s9, 0
  s_cbranch_scc1 K2_SX9
  s_cmp_ge_u32 s10, 4
  s_cbranch_scc1 K2_SX9
  s_sleep 1
  s_branch K2_SP9
K2_SX9:
  s_add_u32 m0, s58, 20480
  s_add_u32 s3, s57, 51200
  buffer_load_dwordx4 v1, s[40:43], s3 offen lds
  s_add_u32 m0, s58, 21504
  s_add_u32 s3, s57, 52224
  buffer_load_dwordx4 v1, s[40:43], s3 offen lds
  s_add_u32 m0, s58, 22528
  s_add_u32 s3, s57, 53248
  buffer_load_dwordx4 v1, s[40:43], s3 offen lds
  s_add_u32 m0, s58, 23552
  s_add_u32 s3, s57, 54272
  buffer_load_dwordx4 v1, s[40:43], s3 offen lds
  s_add_u32 m0, s58, 24576
  s_add_u32 s3, s57, 55296
  buffer_load_dwordx4 v1, s[40:43], s3 offen lds
  s_waitcnt vmcnt(0)
  s_mov_b64 exec, 1
  ds_add_u32 v8, v9 offset:20
  s_mov_b64 exec, -1
  s_mov_b32 s9, 262144
K2_SP10:
  ds_read_b32 v10, v8 offset:204
  s_waitcnt lgkmcnt(0)
  v_readfirstlane_b32 s10, v10
  s_sub_u32 s9, s9, 1
  s_cmp_eq_u32 s9, 0
  s_cbranch_scc1 K2_SX10
  s_cmp_ge_u32 s10, 4
  s_cbranch_scc1 K2_SX10
  s_sleep 1
  s_branch K2_SP10
K2_SX10:
  s_add_u32 m0, s58, 0
  s_add_u32 s3, s57, 61440
  buffer_load_dwordx4 v1, s[40:43], s3 offen lds
  s_add_u32 m0, s58, 1024
  s_add_u32 s3, s57, 62464
  buffer_load_dwordx4 v1, s[40:43], s3 offen lds
  s_add_u32 m0, s58, 2048
  s_add_u32 s3, s57, 63488
  buffer_load_dwordx4 v1, s[40:43], s3 offen lds
  s_add_u32 m0, s58, 3072
  s_add_u32 s3, s57, 64512
  buffer_load_dwordx4 v1, s[40:43], s3 offen lds
  s_add_u32 m0, s58, 4096
  s_add_u32 s3, s57, 65536
  buffer_load_dwordx4 v1, s[40:43], s3 offen lds
  s_waitcnt vmcnt(0)
  s_mov_b64 exec, 1
  ds_add_u32 v8, v9 offset:24
  s_mov_b64 exec, -1
  s_mov_b32 s9, 262144
K2_SP11:
  ds_read_b32 v10, v8 offset:208
  s_waitcnt lgkmcnt(0)
  v_readfirstlane_b32 s10, v10
  s_sub_u32 s9, s9, 1
  s_cmp_eq_u32 s9, 0
  s_cbranch_scc1 K2_SX11
  s_cmp_ge_u32 s10, 4
  s_cbranch_scc1 K2_SX11
  s_sleep 1
  s_branch K2_SP11
K2_SX11:
  s_add_u32 m0, s58, 10240
  s_add_u32 s3, s57, 71680
  buffer_load_dwordx4 v1, s[40:43], s3 offen lds
  s_add_u32 m0, s58, 11264
  s_add_u32 s3, s57, 72704
  buffer_load_dwordx4 v1, s[40:43], s3 offen lds
  s_add_u32 m0, s58, 12288
  s_add_u32 s3, s57, 73728
  buffer_load_dwordx4 v1, s[40:43], s3 offen lds
  s_add_u32 m0, s58, 13312
  s_add_u32 s3, s57, 74752
  buffer_load_dwordx4 v1, s[40:43], s3 offen lds
  s_add_u32 m0, s58, 14336
  s_add_u32 s3, s57, 75776
  buffer_load_dwordx4 v1, s[40:43], s3 offen lds
  s_waitcnt vmcnt(0)
  s_mov_b64 exec, 1
  ds_add_u32 v8, v9 offset:28
  s_mov_b64 exec, -1
  s_barrier
  s_barrier
  s_cmp_eq_u32 s11, 0
  s_cbranch_scc0 K2_FFN_P2
  s_barrier
K2_FFN_P2:
  s_add_u32 s11, s11, 1
  s_cmp_lt_u32 s11, 2
  s_cbranch_scc1 K2_FFN_PASS
  s_cmp_eq_u32 s49, 3
  s_cbranch_scc0 K2_FFN_R1
  s_mov_b32 m0, 20480
  s_add_u32 s18, s16, 94208
  buffer_load_dwordx4 v1, s[24:27], s18 offen lds
K2_FFN_R1:
  s_add_u32 m0, s17, 21504
  s_add_u32 s18, s16, 98304
  buffer_load_dwordx4 v1, s[24:27], s18 offen lds
  s_waitcnt vmcnt(0)
  v_lshlrev_b32 v8, 16, v148
  v_and_b32 v9, 0xffff0000, v148
  v_lshlrev_b32 v10, 16, v149
  v_and_b32 v11, 0xffff0000, v149
  v_lshlrev_b32 v12, 16, v150
  v_and_b32 v13, 0xffff0000, v150
  v_lshlrev_b32 v14, 16, v151
  v_and_b32 v15, 0xffff0000, v151
  v_lshlrev_b32 v16, 16, v152
  v_and_b32 v17, 0xffff0000, v152
  v_lshlrev_b32 v18, 16, v153
  v_and_b32 v19, 0xffff0000, v153
  v_lshlrev_b32 v20, 16, v154
  v_and_b32 v21, 0xffff0000, v154
  v_lshlrev_b32 v22, 16, v155
  v_and_b32 v23, 0xffff0000, v155
  v_lshlrev_b32 v24, 16, v156
  v_and_b32 v25, 0xffff0000, v156
  v_lshlrev_b32 v26, 16, v157
  v_and_b32 v27, 0xffff0000, v157
  s_mov_b32 s3, 3216550459
  v_mul_f32 v108, s3, v8
  v_mul_f32 v109, s3, v9
  v_mul_f32 v110, s3, v10
  v_mul_f32 v111, s3, v11
  v_mul_f32 v112, s3, v12
  v_mul_f32 v113, s3, v13
  v_mul_f32 v114, s3, v14
  v_mul_f32 v115, s3, v15
  v_mul_f32 v116, s3, v16
  v_mul_f32 v117, s3, v17
  v_mul_f32 v118, s3, v18
  v_mul_f32 v119, s3, v19
  v_mul_f32 v120, s3, v20
  v_mul_f32 v121, s3, v21
  v_mul_f32 v122, s3, v22
  v_mul_f32 v123, s3, v23
  v_mul_f32 v124, s3, v24
  v_mul_f32 v125, s3, v25
  v_mul_f32 v126, s3, v26
  v_mul_f32 v127, s3, v27
  v_exp_f32 v108, v108
  v_exp_f32 v109, v109
  v_exp_f32 v110, v110
  v_exp_f32 v111, v111
  v_exp_f32 v112, v112
  v_exp_f32 v113, v113
  v_exp_f32 v114, v114
  v_exp_f32 v115, v115
  v_exp_f32 v116, v116
  v_exp_f32 v117, v117
  v_exp_f32 v118, v118
  v_exp_f32 v119, v119
  v_exp_f32 v120, v120
  v_exp_f32 v121, v121
  v_exp_f32 v122, v122
  v_exp_f32 v123, v123
  v_exp_f32 v124, v124
  v_exp_f32 v125, v125
  v_exp_f32 v126, v126
  v_exp_f32 v127, v127
  v_add_f32 v108, 1.0, v108
  v_add_f32 v109, 1.0, v109
  v_add_f32 v110, 1.0, v110
  v_add_f32 v111, 1.0, v111
  v_add_f32 v112, 1.0, v112
  v_add_f32 v113, 1.0, v113
  v_add_f32 v114, 1.0, v114
  v_add_f32 v115, 1.0, v115
  v_add_f32 v116, 1.0, v116
  v_add_f32 v117, 1.0, v117
  v_add_f32 v118, 1.0, v118
  v_add_f32 v119, 1.0, v119
  v_add_f32 v120, 1.0, v120
  v_add_f32 v121, 1.0, v121
  v_add_f32 v122, 1.0, v122
  v_add_f32 v123, 1.0, v123
  v_add_f32 v124, 1.0, v124
  v_add_f32 v125, 1.0, v125
  v_add_f32 v126, 1.0, v126
  v_add_f32 v127, 1.0, v127
  v_rcp_f32 v108, v108
  v_rcp_f32 v109, v109
  v_rcp_f32 v110, v110
  v_rcp_f32 v111, v111
  v_rcp_f32 v112, v112
  v_rcp_f32 v113, v113
  v_rcp_f32 v114, v114
  v_rcp_f32 v115, v115
  v_rcp_f32 v116, v116
  v_rcp_f32 v117, v117
  v_rcp_f32 v118, v118
  v_rcp_f32 v119, v119
  v_rcp_f32 v120, v120
  v_rcp_f32 v121, v121
  v_rcp_f32 v122, v122
  v_rcp_f32 v123, v123
  v_rcp_f32 v124, v124
  v_rcp_f32 v125, v125
  v_rcp_f32 v126, v126
  v_rcp_f32 v127, v127
  v_mul_f32 v8, v8, v108
  v_mul_f32 v9, v9, v109
  v_mul_f32 v10, v10, v110
  v_mul_f32 v11, v11, v111
  v_mul_f32 v12, v12, v112
  v_mul_f32 v13, v13, v113
  v_mul_f32 v14, v14, v114
  v_mul_f32 v15, v15, v115
  v_mul_f32 v16, v16, v116
  v_mul_f32 v17, v17, v117
  v_mul_f32 v18, v18, v118
  v_mul_f32 v19, v19, v119
  v_mul_f32 v20, v20, v120
  v_mul_f32 v21, v21, v121
  v_mul_f32 v22, v22, v122
  v_mul_f32 v23, v23, v123
  v_mul_f32 v24, v24, v124
  v_mul_f32 v25, v25, v125
  v_mul_f32 v26, v26, v126
  v_mul_f32 v27, v27, v127
  v_cvt_pk_bf16_f32 v148, v8, v9
  v_cvt_pk_bf16_f32 v149, v10, v11
  v_cvt_pk_bf16_f32 v150, v12, v13
  v_cvt_pk_bf16_f32 v151, v14, v15
  v_cvt_pk_bf16_f32 v152, v16, v17
  v_cvt_pk_bf16_f32 v153, v18, v19
  v_cvt_pk_bf16_f32 v154, v20, v21
  v_cvt_pk_bf16_f32 v155, v22, v23
  v_cvt_pk_bf16_f32 v156, v24, v25
  v_cvt_pk_bf16_f32 v157, v26, v27
  s_branch K2_FFN_GO2
K2_FFN_GO:
  v_lshlrev_b32 v8, 16, v148
  v_and_b32 v9, 0xffff0000, v148
  v_lshlrev_b32 v10, 16, v149
  v_and_b32 v11, 0xffff0000, v149
  v_lshlrev_b32 v12, 16, v150
  v_and_b32 v13, 0xffff0000, v150
  v_lshlrev_b32 v14, 16, v151
  v_and_b32 v15, 0xffff0000, v151
  v_lshlrev_b32 v16, 16, v152
  v_and_b32 v17, 0xffff0000, v152
  v_lshlrev_b32 v18, 16, v153
  v_and_b32 v19, 0xffff0000, v153
  v_lshlrev_b32 v20, 16, v154
  v_and_b32 v21, 0xffff0000, v154
  v_lshlrev_b32 v22, 16, v155
  v_and_b32 v23, 0xffff0000, v155
  v_lshlrev_b32 v24, 16, v156
  v_and_b32 v25, 0xffff0000, v156
  v_lshlrev_b32 v26, 16, v157
  v_and_b32 v27, 0xffff0000, v157
  s_mov_b32 s3, 3216550459
  v_mul_f32 v108, s3, v8
  v_mul_f32 v109, s3, v9
  v_mul_f32 v110, s3, v10
  v_mul_f32 v111, s3, v11
  v_mul_f32 v112, s3, v12
  v_mul_f32 v113, s3, v13
  v_mul_f32 v114, s3, v14
  v_mul_f32 v115, s3, v15
  v_mul_f32 v116, s3, v16
  v_mul_f32 v117, s3, v17
  v_mul_f32 v118, s3, v18
  v_mul_f32 v119, s3, v19
  v_mul_f32 v120, s3, v20
  v_mul_f32 v121, s3, v21
  v_mul_f32 v122, s3, v22
  v_mul_f32 v123, s3, v23
  v_mul_f32 v124, s3, v24
  v_mul_f32 v125, s3, v25
  v_mul_f32 v126, s3, v26
  v_mul_f32 v127, s3, v27
  v_exp_f32 v108, v108
  v_exp_f32 v109, v109
  v_exp_f32 v110, v110
  v_exp_f32 v111, v111
  v_exp_f32 v112, v112
  v_exp_f32 v113, v113
  v_exp_f32 v114, v114
  v_exp_f32 v115, v115
  v_exp_f32 v116, v116
  v_exp_f32 v117, v117
  v_exp_f32 v118, v118
  v_exp_f32 v119, v119
  v_exp_f32 v120, v120
  v_exp_f32 v121, v121
  v_exp_f32 v122, v122
  v_exp_f32 v123, v123
  v_exp_f32 v124, v124
  v_exp_f32 v125, v125
  v_exp_f32 v126, v126
  v_exp_f32 v127, v127
  v_add_f32 v108, 1.0, v108
  v_add_f32 v109, 1.0, v109
  v_add_f32 v110, 1.0, v110
  v_add_f32 v111, 1.0, v111
  v_add_f32 v112, 1.0, v112
  v_add_f32 v113, 1.0, v113
  v_add_f32 v114, 1.0, v114
  v_add_f32 v115, 1.0, v115
  v_add_f32 v116, 1.0, v116
  v_add_f32 v117, 1.0, v117
  v_add_f32 v118, 1.0, v118
  v_add_f32 v119, 1.0, v119
  v_add_f32 v120, 1.0, v120
  v_add_f32 v121, 1.0, v121
  v_add_f32 v122, 1.0, v122
  v_add_f32 v123, 1.0, v123
  v_add_f32 v124, 1.0, v124
  v_add_f32 v125, 1.0, v125
  v_add_f32 v126, 1.0, v126
  v_add_f32 v127, 1.0, v127
  v_rcp_f32 v108, v108
  v_rcp_f32 v109, v109
  v_rcp_f32 v110, v110
  v_rcp_f32 v111, v111
  v_rcp_f32 v112, v112
  v_rcp_f32 v113, v113
  v_rcp_f32 v114, v114
  v_rcp_f32 v115, v115
  v_rcp_f32 v116, v116
  v_rcp_f32 v117, v117
  v_rcp_f32 v118, v118
  v_rcp_f32 v119, v119
  v_rcp_f32 v120, v120
  v_rcp_f32 v121, v121
  v_rcp_f32 v122, v122
  v_rcp_f32 v123, v123
  v_rcp_f32 v124, v124
  v_rcp_f32 v125, v125
  v_rcp_f32 v126, v126
  v_rcp_f32 v127, v127
  v_mul_f32 v8, v8, v108
  v_mul_f32 v9, v9, v109
  v_mul_f32 v10, v10, v110
  v_mul_f32 v11, v11, v111
  v_mul_f32 v12, v12, v112
  v_mul_f32 v13, v13, v113
  v_mul_f32 v14, v14, v114
  v_mul_f32 v15, v15, v115
  v_mul_f32 v16, v16, v116
  v_mul_f32 v17, v17, v117
  v_mul_f32 v18, v18, v118
  v_mul_f32 v19, v19, v119
  v_mul_f32 v20, v20, v120
  v_mul_f32 v21, v21, v121
  v_mul_f32 v22, v22, v122
  v_mul_f32 v23, v23, v123
  v_mul_f32 v24, v24, v124
  v_mul_f32 v25, v25, v125
  v_mul_f32 v26, v26, v126
  v_mul_f32 v27, v27, v127
  v_cvt_pk_bf16_f32 v148, v8, v9
  v_cvt_pk_bf16_f32 v149, v10, v11
  v_cvt_pk_bf16_f32 v150, v12, v13
  v_cvt_pk_bf16_f32 v151, v14, v15
  v_cvt_pk_bf16_f32 v152, v16, v17
  v_cvt_pk_bf16_f32 v153, v18, v19
  v_cvt_pk_bf16_f32 v154, v20, v21
  v_cvt_pk_bf16_f32 v155, v22, v23
  v_cvt_pk_bf16_f32 v156, v24, v25
  v_cvt_pk_bf16_f32 v157, v26, v27
K2_FFN_GO2:
  s_lshl_b32 s3, s50, 2
  s_add_u32 s3, s3, s49
  s_mul_i32 s19, s3, 20480
  s_mov_b32 s56, s14
  s_and_b32 s57, s15, 0xffff
  s_mov_b32 s58, 2621440
  s_mov_b32 s59, 0x00020000
  v_add_u32 v4, 61440, v1
  v_add_u32 v5, 112640, v1
  v_add_u32 v6, 20480, v1
  v_mov_b32 v7, 159168
  v_mov_b32 v0, v3
  s_mov_b32 s9, 262144
K2_SP12:
  ds_read_b32 v2, v7 offset:0
  s_waitcnt lgkmcnt(0)
  v_readfirstlane_b32 s10, v2
  s_sub_u32 s9, s9, 1
  s_cmp_eq_u32 s9, 0
  s_cbranch_scc1 K2_SX12
  s_cmp_ge_u32 s10, 8
  s_cbranch_scc1 K2_SX12
  s_sleep 1
  s_branch K2_SP12
K2_SX12:
  s_add_u32 s22, s19, 0
  buffer_load_dwordx4 v[8:11], v1, s[28:31], s22 offen sc1
  s_add_u32 s22, s19, 1024
  buffer_load_dwordx4 v[12:15], v1, s[28:31], s22 offen sc1
  s_add_u32 s22, s19, 2048
  buffer_load_dwordx4 v[16:19], v1, s[28:31], s22 offen sc1
  s_add_u32 s22, s19, 3072
  buffer_load_dwordx4 v[20:23], v1, s[28:31], s22 offen sc1
  s_add_u32 s22, s19, 4096
  buffer_load_dwordx4 v[24:27], v1, s[28:31], s22 offen sc1
  s_add_u32 s22, s19, 5120
  buffer_load_dwordx4 v[28:31], v1, s[28:31], s22 offen sc1
  s_add_u32 s22, s19, 6144
  buffer_load_dwordx4 v[32:35], v1, s[28:31], s22 offen sc1
  s_add_u32 s22, s19, 7168
  buffer_load_dwordx4 v[36:39], v1, s[28:31], s22 offen sc1
  s_add_u32 s22, s19, 8192
  buffer_load_dwordx4 v[40:43], v1, s[28:31], s22 offen sc1
  s_add_u32 s22, s19, 9216
  buffer_load_dwordx4 v[44:47], v1, s[28:31], s22 offen sc1
  s_add_u32 s22, s19, 10240
  buffer_load_dwordx4 v[48:51], v1, s[28:31], s22 offen sc1
  s_add_u32 s22, s19, 11264
  buffer_load_dwordx4 v[52:55], v1, s[28:31], s22 offen sc1
  s_add_u32 s22, s19, 12288
  buffer_load_dwordx4 v[56:59], v1, s[28:31], s22 offen sc1
  s_add_u32 s22, s19, 13312
  buffer_load_dwordx4 v[60:63], v1, s[28:31], s22 offen sc1
  s_add_u32 s22, s19, 14336
  buffer_load_dwordx4 v[64:67], v1, s[28:31], s22 offen sc1
  s_add_u32 s22, s19, 15360
  buffer_load_dwordx4 v[68:71], v1, s[28:31], s22 offen sc1
  s_add_u32 s22, s19, 16384
  buffer_load_dwordx4 v[72:75], v1, s[28:31], s22 offen sc1
  s_add_u32 s22, s19, 17408
  buffer_load_dwordx4 v[76:79], v1, s[28:31], s22 offen sc1
  s_add_u32 s22, s19, 18432
  buffer_load_dwordx4 v[80:83], v1, s[28:31], s22 offen sc1
  s_add_u32 s22, s19, 19456
  buffer_load_dwordx4 v[84:87], v1, s[28:31], s22 offen sc1
  ds_read_b128 v[108:111], v4 offset:0
  ds_read_b128 v[112:115], v4 offset:1024
  ds_read_b128 v[116:119], v4 offset:2048
  ds_read_b128 v[120:123], v4 offset:3072
  ds_read_b128 v[124:127], v4 offset:4096
  s_mov_b32 s24, 262144
  s_waitcnt vmcnt(16)
K2_CK0:
  s_mov_b64 s[8:9], 0
  v_cmp_eq_u32 vcc, -1, v8
  v_cmp_eq_u32 s[10:11], -1, v10
  s_nop 0
  s_or_b64 s[8:9], s[8:9], vcc
  s_or_b64 s[8:9], s[8:9], s[10:11]
  v_cmp_eq_u32 vcc, -1, v12
  v_cmp_eq_u32 s[10:11], -1, v14
  s_nop 0
  s_or_b64 s[8:9], s[8:9], vcc
  s_or_b64 s[8:9], s[8:9], s[10:11]
  v_cmp_eq_u32 vcc, -1, v16
  v_cmp_eq_u32 s[10:11], -1, v18
  s_nop 0
  s_or_b64 s[8:9], s[8:9], vcc
  s_or_b64 s[8:9], s[8:9], s[10:11]
  v_cmp_eq_u32 vcc, -1, v20
  v_cmp_eq_u32 s[10:11], -1, v22
  s_nop 0
  s_or_b64 s[8:9], s[8:9], vcc
  s_or_b64 s[8:9], s[8:9], s[10:11]
  s_cmp_eq_u64 s[8:9], 0
  s_cbranch_scc1 K2_CX0
  s_sub_u32 s24, s24, 1
  s_cmp_eq_u32 s24, 0
  s_cbranch_scc1 K2_CX0
  s_add_u32 s22, s19, 0
  buffer_load_dwordx4 v[8:11], v1, s[28:31], s22 offen sc1
  s_add_u32 s22, s19, 1024
  buffer_load_dwordx4 v[12:15], v1, s[28:31], s22 offen sc1
  s_add_u32 s22, s19, 2048
  buffer_load_dwordx4 v[16:19], v1, s[28:31], s22 offen sc1
  s_add_u32 s22, s19, 3072
  buffer_load_dwordx4 v[20:23], v1, s[28:31], s22 offen sc1
  s_waitcnt vmcnt(0)
  s_branch K2_CK0
K2_CX0:
  ds_read_b128 v[128:131], v4 offset:5120
  ds_read_b128 v[132:135], v4 offset:6144
  ds_read_b128 v[136:139], v4 offset:7168
  ds_read_b128 v[140:143], v4 offset:8192
  ds_read_b128 v[144:147], v4 offset:9216
  s_waitcnt lgkmcnt(5)
  v_mfma_f32_16x16x32_bf16 v[88:91], v[108:111], v[8:11], 0
  v_mfma_f32_16x16x32_bf16 v[92:95], v[112:115], v[8:11], 0
  v_mfma_f32_16x16x32_bf16 v[96:99], v[116:119], v[8:11], 0
  v_mfma_f32_16x16x32_bf16 v[100:103], v[120:123], v[8:11], 0
  v_mfma_f32_16x16x32_bf16 v[104:107], v[124:127], v[8:11], 0
  ds_read_b128 v[108:111], v4 offset:10240
  ds_read_b128 v[112:115], v4 offset:11264
  ds_read_b128 v[116:119], v4 offset:12288
  ds_read_b128 v[120:123], v4 offset:13312
  ds_read_b128 v[124:127], v4 offset:14336
  s_waitcnt lgkmcnt(5)
  v_mfma_f32_16x16x32_bf16 v[88:91], v[128:131], v[12:15], v[88:91]
  v_mfma_f32_16x16x32_bf16 v[92:95], v[132:135], v[12:15], v[92:95]
  v_mfma_f32_16x16x32_bf16 v[96:99], v[136:139], v[12:15], v[96:99]
  v_mfma_f32_16x16x32_bf16 v[100:103], v[140:143], v[12:15], v[100:103]
  v_mfma_f32_16x16x32_bf16 v[104:107], v[144:147], v[12:15], v[104:107]
  ds_read_b128 v[128:131], v4 offset:15360
  ds_read_b128 v[132:135], v4 offset:16384
  ds_read_b128 v[136:139], v4 offset:17408
  ds_read_b128 v[140:143], v4 offset:18432
  ds_read_b128 v[144:147], v4 offset:19456
  s_waitcnt lgkmcnt(5)
  v_mfma_f32_16x16x32_bf16 v[88:91], v[108:111], v[16:19], v[88:91]
  v_mfma_f32_16x16x32_bf16 v[92:95], v[112:115], v[16:19], v[92:95]
  v_mfma_f32_16x16x32_bf16 v[96:99], v[116:119], v[16:19], v[96:99]
  v_mfma_f32_16x16x32_bf16 v[100:103], v[120:123], v[16:19], v[100:103]
  v_mfma_f32_16x16x32_bf16 v[104:107], v[124:127], v[16:19], v[104:107]
  ds_read_b128 v[108:111], v4 offset:20480
  ds_read_b128 v[112:115], v4 offset:21504
  ds_read_b128 v[116:119], v4 offset:22528
  ds_read_b128 v[120:123], v4 offset:23552
  ds_read_b128 v[124:127], v4 offset:24576
  s_waitcnt lgkmcnt(5)
  v_mfma_f32_16x16x32_bf16 v[88:91], v[128:131], v[20:23], v[88:91]
  v_mfma_f32_16x16x32_bf16 v[92:95], v[132:135], v[20:23], v[92:95]
  v_mfma_f32_16x16x32_bf16 v[96:99], v[136:139], v[20:23], v[96:99]
  v_mfma_f32_16x16x32_bf16 v[100:103], v[140:143], v[20:23], v[100:103]
  v_mfma_f32_16x16x32_bf16 v[104:107], v[144:147], v[20:23], v[104:107]
  s_mov_b32 s24, 262144
  s_waitcnt vmcnt(12)
K2_CK1:
  s_mov_b64 s[8:9], 0
  v_cmp_eq_u32 vcc, -1, v24
  v_cmp_eq_u32 s[10:11], -1, v26
  s_nop 0
  s_or_b64 s[8:9], s[8:9], vcc
  s_or_b64 s[8:9], s[8:9], s[10:11]
  v_cmp_eq_u32 vcc, -1, v28
  v_cmp_eq_u32 s[10:11], -1, v30
  s_nop 0
  s_or_b64 s[8:9], s[8:9], vcc
  s_or_b64 s[8:9], s[8:9], s[10:11]
  v_cmp_eq_u32 vcc, -1, v32
  v_cmp_eq_u32 s[10:11], -1, v34
  s_nop 0
  s_or_b64 s[8:9], s[8:9], vcc
  s_or_b64 s[8:9], s[8:9], s[10:11]
  v_cmp_eq_u32 vcc, -1, v36
  v_cmp_eq_u32 s[10:11], -1, v38
  s_nop 0
  s_or_b64 s[8:9], s[8:9], vcc
  s_or_b64 s[8:9], s[8:9], s[10:11]
  s_cmp_eq_u64 s[8:9], 0
  s_cbranch_scc1 K2_CX1
  s_sub_u32 s24, s24, 1
  s_cmp_eq_u32 s24, 0
  s_cbranch_scc1 K2_CX1
  s_add_u32 s22, s19, 4096
  buffer_load_dwordx4 v[24:27], v1, s[28:31], s22 offen sc1
  s_add_u32 s22, s19, 5120
  buffer_load_dwordx4 v[28:31], v1, s[28:31], s22 offen sc1
  s_add_u32 s22, s19, 6144
  buffer_load_dwordx4 v[32:35], v1, s[28:31], s22 offen sc1
  s_add_u32 s22, s19, 7168
  buffer_load_dwordx4 v[36:39], v1, s[28:31], s22 offen sc1
  s_waitcnt vmcnt(0)
  s_branch K2_CK1
K2_CX1:
  ds_read_b128 v[128:131], v4 offset:25600
  ds_read_b128 v[132:135], v4 offset:26624
  ds_read_b128 v[136:139], v4 offset:27648
  ds_read_b128 v[140:143], v4 offset:28672
  ds_read_b128 v[144:147], v4 offset:29696
  s_waitcnt lgkmcnt(5)
  v_mfma_f32_16x16x32_bf16 v[88:91], v[108:111], v[24:27], v[88:91]
  v_mfma_f32_16x16x32_bf16 v[92:95], v[112:115], v[24:27], v[92:95]
  v_mfma_f32_16x16x32_bf16 v[96:99], v[116:119], v[24:27], v[96:99]
  v_mfma_f32_16x16x32_bf16 v[100:103], v[120:123], v[24:27], v[100:103]
  v_mfma_f32_16x16x32_bf16 v[104:107], v[124:127], v[24:27], v[104:107]
  ds_read_b128 v[108:111], v4 offset:30720
  ds_read_b128 v[112:115], v4 offset:31744
  ds_read_b128 v[116:119], v4 offset:32768
  ds_read_b128 v[120:123], v4 offset:33792
  ds_read_b128 v[124:127], v4 offset:34816
  s_waitcnt lgkmcnt(5)
  v_mfma_f32_16x16x32_bf16 v[88:91], v[128:131], v[28:31], v[88:91]
  v_mfma_f32_16x16x32_bf16 v[92:95], v[132:135], v[28:31], v[92:95]
  v_mfma_f32_16x16x32_bf16 v[96:99], v[136:139], v[28:31], v[96:99]
  v_mfma_f32_16x16x32_bf16 v[100:103], v[140:143], v[28:31], v[100:103]
  v_mfma_f32_16x16x32_bf16 v[104:107], v[144:147], v[28:31], v[104:107]
  ds_read_b128 v[128:131], v4 offset:35840
  ds_read_b128 v[132:135], v4 offset:36864
  ds_read_b128 v[136:139], v4 offset:37888
  ds_read_b128 v[140:143], v4 offset:38912
  ds_read_b128 v[144:147], v4 offset:39936
  s_waitcnt lgkmcnt(5)
  v_mfma_f32_16x16x32_bf16 v[88:91], v[108:111], v[32:35], v[88:91]
  v_mfma_f32_16x16x32_bf16 v[92:95], v[112:115], v[32:35], v[92:95]
  v_mfma_f32_16x16x32_bf16 v[96:99], v[116:119], v[32:35], v[96:99]
  v_mfma_f32_16x16x32_bf16 v[100:103], v[120:123], v[32:35], v[100:103]
  v_mfma_f32_16x16x32_bf16 v[104:107], v[124:127], v[32:35], v[104:107]
  ds_read_b128 v[108:111], v4 offset:40960
  ds_read_b128 v[112:115], v4 offset:41984
  ds_read_b128 v[116:119], v4 offset:43008
  ds_read_b128 v[120:123], v4 offset:44032
  ds_read_b128 v[124:127], v4 offset:45056
  s_waitcnt lgkmcnt(5)
  v_mfma_f32_16x16x32_bf16 v[88:91], v[128:131], v[36:39], v[88:91]
  v_mfma_f32_16x16x32_bf16 v[92:95], v[132:135], v[36:39], v[92:95]
  v_mfma_f32_16x16x32_bf16 v[96:99], v[136:139], v[36:39], v[96:99]
  v_mfma_f32_16x16x32_bf16 v[100:103], v[140:143], v[36:39], v[100:103]
  v_mfma_f32_16x16x32_bf16 v[104:107], v[144:147], v[36:39], v[104:107]
  s_mov_b32 s24, 262144
  s_waitcnt vmcnt(8)
K2_CK2:
  s_mov_b64 s[8:9], 0
  v_cmp_eq_u32 vcc, -1, v40
  v_cmp_eq_u32 s[10:11], -1, v42
  s_nop 0
  s_or_b64 s[8:9], s[8:9], vcc
  s_or_b64 s[8:9], s[8:9], s[10:11]
  v_cmp_eq_u32 vcc, -1, v44
  v_cmp_eq_u32 s[10:11], -1, v46
  s_nop 0
  s_or_b64 s[8:9], s[8:9], vcc
  s_or_b64 s[8:9], s[8:9], s[10:11]
  v_cmp_eq_u32 vcc, -1, v48
  v_cmp_eq_u32 s[10:11], -1, v50
  s_nop 0
  s_or_b64 s[8:9], s[8:9], vcc
  s_or_b64 s[8:9], s[8:9], s[10:11]
  v_cmp_eq_u32 vcc, -1, v52
  v_cmp_eq_u32 s[10:11], -1, v54
  s_nop 0
  s_or_b64 s[8:9], s[8:9], vcc
  s_or_b64 s[8:9], s[8:9], s[10:11]
  s_cmp_eq_u64 s[8:9], 0
  s_cbranch_scc1 K2_CX2
  s_sub_u32 s24, s24, 1
  s_cmp_eq_u32 s24, 0
  s_cbranch_scc1 K2_CX2
  s_add_u32 s22, s19, 8192
  buffer_load_dwordx4 v[40:43], v1, s[28:31], s22 offen sc1
  s_add_u32 s22, s19, 9216
  buffer_load_dwordx4 v[44:47], v1, s[28:31], s22 offen sc1
  s_add_u32 s22, s19, 10240
  buffer_load_dwordx4 v[48:51], v1, s[28:31], s22 offen sc1
  s_add_u32 s22, s19, 11264
  buffer_load_dwordx4 v[52:55], v1, s[28:31], s22 offen sc1
  s_waitcnt vmcnt(0)
  s_branch K2_CK2
K2_CX2:
  ds_read_b128 v[128:131], v4 offset:46080
  ds_read_b128 v[132:135], v4 offset:47104
  ds_read_b128 v[136:139], v4 offset:48128
  ds_read_b128 v[140:143], v4 offset:49152
  ds_read_b128 v[144:147], v4 offset:50176
  s_waitcnt lgkmcnt(5)
  v_mfma_f32_16x16x32_bf16 v[88:91], v[108:111], v[40:43], v[88:91]
  v_mfma_f32_16x16x32_bf16 v[92:95], v[112:115], v[40:43], v[92:95]
  v_mfma_f32_16x16x32_bf16 v[96:99], v[116:119], v[40:43], v[96:99]
  v_mfma_f32_16x16x32_bf16 v[100:103], v[120:123], v[40:43], v[100:103]
  v_mfma_f32_16x16x32_bf16 v[104:107], v[124:127], v[40:43], v[104:107]
  ds_read_b128 v[108:111], v5 offset:0
  ds_read_b128 v[112:115], v5 offset:1024
  ds_read_b128 v[116:119], v5 offset:2048
  ds_read_b128 v[120:123], v5 offset:3072
  ds_read_b128 v[124:127], v5 offset:4096
  s_waitcnt lgkmcnt(5)
  v_mfma_f32_16x16x32_bf16 v[88:91], v[128:131], v[44:47], v[88:91]
  v_mfma_f32_16x16x32_bf16 v[92:95], v[132:135], v[44:47], v[92:95]
  v_mfma_f32_16x16x32_bf16 v[96:99], v[136:139], v[44:47], v[96:99]
  v_mfma_f32_16x16x32_bf16 v[100:103], v[140:143], v[44:47], v[100:103]
  v_mfma_f32_16x16x32_bf16 v[104:107], v[144:147], v[44:47], v[104:107]
  ds_read_b128 v[128:131], v5 offset:5120
  ds_read_b128 v[132:135], v5 offset:6144
  ds_read_b128 v[136:139], v5 offset:7168
  ds_read_b128 v[140:143], v5 offset:8192
  ds_read_b128 v[144:147], v5 offset:9216
  s_waitcnt lgkmcnt(5)
  v_mfma_f32_16x16x32_bf16 v[88:91], v[108:111], v[48:51], v[88:91]
  v_mfma_f32_16x16x32_bf16 v[92:95], v[112:115], v[48:51], v[92:95]
  v_mfma_f32_16x16x32_bf16 v[96:99], v[116:119], v[48:51], v[96:99]
  v_mfma_f32_16x16x32_bf16 v[100:103], v[120:123], v[48:51], v[100:103]
  v_mfma_f32_16x16x32_bf16 v[104:107], v[124:127], v[48:51], v[104:107]
  ds_read_b128 v[108:111], v5 offset:10240
  ds_read_b128 v[112:115], v5 offset:11264
  ds_read_b128 v[116:119], v5 offset:12288
  ds_read_b128 v[120:123], v5 offset:13312
  ds_read_b128 v[124:127], v5 offset:14336
  s_waitcnt lgkmcnt(5)
  v_mfma_f32_16x16x32_bf16 v[88:91], v[128:131], v[52:55], v[88:91]
  v_mfma_f32_16x16x32_bf16 v[92:95], v[132:135], v[52:55], v[92:95]
  v_mfma_f32_16x16x32_bf16 v[96:99], v[136:139], v[52:55], v[96:99]
  v_mfma_f32_16x16x32_bf16 v[100:103], v[140:143], v[52:55], v[100:103]
  v_mfma_f32_16x16x32_bf16 v[104:107], v[144:147], v[52:55], v[104:107]
  s_mov_b32 s24, 262144
  s_waitcnt vmcnt(4)
K2_CK3:
  s_mov_b64 s[8:9], 0
  v_cmp_eq_u32 vcc, -1, v56
  v_cmp_eq_u32 s[10:11], -1, v58
  s_nop 0
  s_or_b64 s[8:9], s[8:9], vcc
  s_or_b64 s[8:9], s[8:9], s[10:11]
  v_cmp_eq_u32 vcc, -1, v60
  v_cmp_eq_u32 s[10:11], -1, v62
  s_nop 0
  s_or_b64 s[8:9], s[8:9], vcc
  s_or_b64 s[8:9], s[8:9], s[10:11]
  v_cmp_eq_u32 vcc, -1, v64
  v_cmp_eq_u32 s[10:11], -1, v66
  s_nop 0
  s_or_b64 s[8:9], s[8:9], vcc
  s_or_b64 s[8:9], s[8:9], s[10:11]
  v_cmp_eq_u32 vcc, -1, v68
  v_cmp_eq_u32 s[10:11], -1, v70
  s_nop 0
  s_or_b64 s[8:9], s[8:9], vcc
  s_or_b64 s[8:9], s[8:9], s[10:11]
  s_cmp_eq_u64 s[8:9], 0
  s_cbranch_scc1 K2_CX3
  s_sub_u32 s24, s24, 1
  s_cmp_eq_u32 s24, 0
  s_cbranch_scc1 K2_CX3
  s_add_u32 s22, s19, 12288
  buffer_load_dwordx4 v[56:59], v1, s[28:31], s22 offen sc1
  s_add_u32 s22, s19, 13312
  buffer_load_dwordx4 v[60:63], v1, s[28:31], s22 offen sc1
  s_add_u32 s22, s19, 14336
  buffer_load_dwordx4 v[64:67], v1, s[28:31], s22 offen sc1
  s_add_u32 s22, s19, 15360
  buffer_load_dwordx4 v[68:71], v1, s[28:31], s22 offen sc1
  s_waitcnt vmcnt(0)
  s_branch K2_CK3
K2_CX3:
  ds_read_b128 v[128:131], v5 offset:15360
  ds_read_b128 v[132:135], v5 offset:16384
  ds_read_b128 v[136:139], v5 offset:17408
  ds_read_b128 v[140:143], v5 offset:18432
  ds_read_b128 v[144:147], v5 offset:19456
  s_waitcnt lgkmcnt(5)
  v_mfma_f32_16x16x32_bf16 v[88:91], v[108:111], v[56:59], v[88:91]
  v_mfma_f32_16x16x32_bf16 v[92:95], v[112:115], v[56:59], v[92:95]
  v_mfma_f32_16x16x32_bf16 v[96:99], v[116:119], v[56:59], v[96:99]
  v_mfma_f32_16x16x32_bf16 v[100:103], v[120:123], v[56:59], v[100:103]
  v_mfma_f32_16x16x32_bf16 v[104:107], v[124:127], v[56:59], v[104:107]
  ds_read_b128 v[108:111], v5 offset:20480
  ds_read_b128 v[112:115], v5 offset:21504
  ds_read_b128 v[116:119], v5 offset:22528
  ds_read_b128 v[120:123], v5 offset:23552
  ds_read_b128 v[124:127], v5 offset:24576
  s_waitcnt lgkmcnt(5)
  v_mfma_f32_16x16x32_bf16 v[88:91], v[128:131], v[60:63], v[88:91]
  v_mfma_f32_16x16x32_bf16 v[92:95], v[132:135], v[60:63], v[92:95]
  v_mfma_f32_16x16x32_bf16 v[96:99], v[136:139], v[60:63], v[96:99]
  v_mfma_f32_16x16x32_bf16 v[100:103], v[140:143], v[60:63], v[100:103]
  v_mfma_f32_16x16x32_bf16 v[104:107], v[144:147], v[60:63], v[104:107]
  ds_read_b128 v[128:131], v5 offset:25600
  ds_read_b128 v[132:135], v5 offset:26624
  ds_read_b128 v[136:139], v5 offset:27648
  ds_read_b128 v[140:143], v5 offset:28672
  ds_read_b128 v[144:147], v5 offset:29696
  s_waitcnt lgkmcnt(5)
  v_mfma_f32_16x16x32_bf16 v[88:91], v[108:111], v[64:67], v[88:91]
  v_mfma_f32_16x16x32_bf16 v[92:95], v[112:115], v[64:67], v[92:95]
  v_mfma_f32_16x16x32_bf16 v[96:99], v[116:119], v[64:67], v[96:99]
  v_mfma_f32_16x16x32_bf16 v[100:103], v[120:123], v[64:67], v[100:103]
  v_mfma_f32_16x16x32_bf16 v[104:107], v[124:127], v[64:67], v[104:107]
  ds_read_b128 v[108:111], v5 offset:30720
  ds_read_b128 v[112:115], v5 offset:31744
  ds_read_b128 v[116:119], v5 offset:32768
  ds_read_b128 v[120:123], v5 offset:33792
  ds_read_b128 v[124:127], v5 offset:34816
  s_waitcnt lgkmcnt(5)
  v_mfma_f32_16x16x32_bf16 v[88:91], v[128:131], v[68:71], v[88:91]
  v_mfma_f32_16x16x32_bf16 v[92:95], v[132:135], v[68:71], v[92:95]
  v_mfma_f32_16x16x32_bf16 v[96:99], v[136:139], v[68:71], v[96:99]
  v_mfma_f32_16x16x32_bf16 v[100:103], v[140:143], v[68:71], v[100:103]
  v_mfma_f32_16x16x32_bf16 v[104:107], v[144:147], v[68:71], v[104:107]
  s_mov_b32 s24, 262144
  s_waitcnt vmcnt(0)
K2_CK4:
  s_mov_b64 s[8:9], 0
  v_cmp_eq_u32 vcc, -1, v72
  v_cmp_eq_u32 s[10:11], -1, v74
  s_nop 0
  s_or_b64 s[8:9], s[8:9], vcc
  s_or_b64 s[8:9], s[8:9], s[10:11]
  v_cmp_eq_u32 vcc, -1, v76
  v_cmp_eq_u32 s[10:11], -1, v78
  s_nop 0
  s_or_b64 s[8:9], s[8:9], vcc
  s_or_b64 s[8:9], s[8:9], s[10:11]
  v_cmp_eq_u32 vcc, -1, v80
  v_cmp_eq_u32 s[10:11], -1, v82
  s_nop 0
  s_or_b64 s[8:9], s[8:9], vcc
  s_or_b64 s[8:9], s[8:9], s[10:11]
  v_cmp_eq_u32 vcc, -1, v84
  v_cmp_eq_u32 s[10:11], -1, v86
  s_nop 0
  s_or_b64 s[8:9], s[8:9], vcc
  s_or_b64 s[8:9], s[8:9], s[10:11]
  s_cmp_eq_u64 s[8:9], 0
  s_cbranch_scc1 K2_CX4
  s_sub_u32 s24, s24, 1
  s_cmp_eq_u32 s24, 0
  s_cbranch_scc1 K2_CX4
  s_add_u32 s22, s19, 16384
  buffer_load_dwordx4 v[72:75], v1, s[28:31], s22 offen sc1
  s_add_u32 s22, s19, 17408
  buffer_load_dwordx4 v[76:79], v1, s[28:31], s22 offen sc1
  s_add_u32 s22, s19, 18432
  buffer_load_dwordx4 v[80:83], v1, s[28:31], s22 offen sc1
  s_add_u32 s22, s19, 19456
  buffer_load_dwordx4 v[84:87], v1, s[28:31], s22 offen sc1
  s_waitcnt vmcnt(0)
  s_branch K2_CK4
K2_CX4:
  ds_read_b128 v[128:131], v5 offset:35840
  ds_read_b128 v[132:135], v5 offset:36864
  ds_read_b128 v[136:139], v5 offset:37888
  ds_read_b128 v[140:143], v5 offset:38912
  ds_read_b128 v[144:147], v5 offset:39936
  s_waitcnt lgkmcnt(5)
  v_mfma_f32_16x16x32_bf16 v[88:91], v[108:111], v[72:75], v[88:91]
  v_mfma_f32_16x16x32_bf16 v[92:95], v[112:115], v[72:75], v[92:95]
  v_mfma_f32_16x16x32_bf16 v[96:99], v[116:119], v[72:75], v[96:99]
  v_mfma_f32_16x16x32_bf16 v[100:103], v[120:123], v[72:75], v[100:103]
  v_mfma_f32_16x16x32_bf16 v[104:107], v[124:127], v[72:75], v[104:107]
  ds_read_b128 v[108:111], v5 offset:40960
  ds_read_b128 v[112:115], v5 offset:41984
  ds_read_b128 v[116:119], v5 offset:43008
  ds_read_b128 v[120:123], v5 offset:44032
  ds_read_b128 v[124:127], v5 offset:45056
  s_waitcnt lgkmcnt(5)
  v_mfma_f32_16x16x32_bf16 v[88:91], v[128:131], v[76:79], v[88:91]
  v_mfma_f32_16x16x32_bf16 v[92:95], v[132:135], v[76:79], v[92:95]
  v_mfma_f32_16x16x32_bf16 v[96:99], v[136:139], v[76:79], v[96:99]
  v_mfma_f32_16x16x32_bf16 v[100:103], v[140:143], v[76:79], v[100:103]
  v_mfma_f32_16x16x32_bf16 v[104:107], v[144:147], v[76:79], v[104:107]
  ds_read_b128 v[128:131], v6 offset:0
  ds_read_b128 v[132:135], v6 offset:1024
  ds_read_b128 v[136:139], v6 offset:2048
  ds_read_b128 v[140:143], v6 offset:3072
  ds_read_b128 v[144:147], v6 offset:4096
  s_waitcnt lgkmcnt(5)
  v_mfma_f32_16x16x32_bf16 v[88:91], v[108:111], v[80:83], v[88:91]
  v_mfma_f32_16x16x32_bf16 v[92:95], v[112:115], v[80:83], v[92:95]
  v_mfma_f32_16x16x32_bf16 v[96:99], v[116:119], v[80:83], v[96:99]
  v_mfma_f32_16x16x32_bf16 v[100:103], v[120:123], v[80:83], v[100:103]
  v_mfma_f32_16x16x32_bf16 v[104:107], v[124:127], v[80:83], v[104:107]
  s_waitcnt lgkmcnt(0)
  v_mfma_f32_16x16x32_bf16 v[88:91], v[128:131], v[84:87], v[88:91]
  v_mfma_f32_16x16x32_bf16 v[92:95], v[132:135], v[84:87], v[92:95]
  v_mfma_f32_16x16x32_bf16 v[96:99], v[136:139], v[84:87], v[96:99]
  v_mfma_f32_16x16x32_bf16 v[100:103], v[140:143], v[84:87], v[100:103]
  v_mfma_f32_16x16x32_bf16 v[104:107], v[144:147], v[84:87], v[104:107]
  s_nop 7
  v_cvt_pk_bf16_f32 v8, v88, v89
  v_lshlrev_b32 v10, 16, v148
  v_and_b32 v11, 0xffff0000, v148
  v_and_b32 v9, 0xffff0000, v8
  v_lshlrev_b32 v8, 16, v8
  v_lshlrev_b32 v12, 16, v158
  v_and_b32 v13, 0xffff0000, v158
  v_pk_mul_f32 v[8:9], v[8:9], v[10:11]
  v_cvt_pk_bf16_f32 v8, v8, v9
  v_and_b32 v9, 0xffff0000, v8
  v_lshlrev_b32 v8, 16, v8
  v_pk_add_f32 v[8:9], v[8:9], v[12:13]
  v_cvt_pk_bf16_f32 v158, v8, v9
  v_cvt_pk_bf16_f32 v16, v90, v91
  v_lshlrev_b32 v18, 16, v149
  v_and_b32 v19, 0xffff0000, v149
  v_and_b32 v17, 0xffff0000, v16
  v_lshlrev_b32 v16, 16, v16
  v_lshlrev_b32 v20, 16, v159
  v_and_b32 v21, 0xffff0000, v159
  v_pk_mul_f32 v[16:17], v[16:17], v[18:19]
  v_cvt_pk_bf16_f32 v16, v16, v17
  v_and_b32 v17, 0xffff0000, v16
  v_lshlrev_b32 v16, 16, v16
  v_pk_add_f32 v[16:17], v[16:17], v[20:21]
  v_cvt_pk_bf16_f32 v159, v16, v17
  buffer_store_dwordx2 v[158:159], v0, s[56:59], 0 offen offset:0
  v_cvt_pk_bf16_f32 v24, v92, v93
  v_lshlrev_b32 v26, 16, v150
  v_and_b32 v27, 0xffff0000, v150
  v_and_b32 v25, 0xffff0000, v24
  v_lshlrev_b32 v24, 16, v24
  v_lshlrev_b32 v28, 16, v160
  v_and_b32 v29, 0xffff0000, v160
  v_pk_mul_f32 v[24:25], v[24:25], v[26:27]
  v_cvt_pk_bf16_f32 v24, v24, v25
  v_and_b32 v25, 0xffff0000, v24
  v_lshlrev_b32 v24, 16, v24
  v_pk_add_f32 v[24:25], v[24:25], v[28:29]
  v_cvt_pk_bf16_f32 v160, v24, v25
  v_cvt_pk_bf16_f32 v32, v94, v95
  v_lshlrev_b32 v34, 16, v151
  v_and_b32 v35, 0xffff0000, v151
  v_and_b32 v33, 0xffff0000, v32
  v_lshlrev_b32 v32, 16, v32
  v_lshlrev_b32 v36, 16, v161
  v_and_b32 v37, 0xffff0000, v161
  v_pk_mul_f32 v[32:33], v[32:33], v[34:35]
  v_cvt_pk_bf16_f32 v32, v32, v33
  v_and_b32 v33, 0xffff0000, v32
  v_lshlrev_b32 v32, 16, v32
  v_pk_add_f32 v[32:33], v[32:33], v[36:37]
  v_cvt_pk_bf16_f32 v161, v32, v33
  buffer_store_dwordx2 v[160:161], v0, s[56:59], 0 offen offset:32
  v_cvt_pk_bf16_f32 v40, v96, v97
  v_lshlrev_b32 v42, 16, v152
  v_and_b32 v43, 0xffff0000, v152
  v_and_b32 v41, 0xffff0000, v40
  v_lshlrev_b32 v40, 16, v40
  v_lshlrev_b32 v44, 16, v162
  v_and_b32 v45, 0xffff0000, v162
  v_pk_mul_f32 v[40:41], v[40:41], v[42:43]
  v_cvt_pk_bf16_f32 v40, v40, v41
  v_and_b32 v41, 0xffff0000, v40
  v_lshlrev_b32 v40, 16, v40
  v_pk_add_f32 v[40:41], v[40:41], v[44:45]
  v_cvt_pk_bf16_f32 v162, v40, v41
  v_cvt_pk_bf16_f32 v48, v98, v99
  v_lshlrev_b32 v50, 16, v153
  v_and_b32 v51, 0xffff0000, v153
  v_and_b32 v49, 0xffff0000, v48
  v_lshlrev_b32 v48, 16, v48
  v_lshlrev_b32 v52, 16, v163
  v_and_b32 v53, 0xffff0000, v163
  v_pk_mul_f32 v[48:49], v[48:49], v[50:51]
  v_cvt_pk_bf16_f32 v48, v48, v49
  v_and_b32 v49, 0xffff0000, v48
  v_lshlrev_b32 v48, 16, v48
  v_pk_add_f32 v[48:49], v[48:49], v[52:53]
  v_cvt_pk_bf16_f32 v163, v48, v49
  buffer_store_dwordx2 v[162:163], v0, s[56:59], 0 offen offset:64
  v_cvt_pk_bf16_f32 v56, v100, v101
  v_lshlrev_b32 v58, 16, v154
  v_and_b32 v59, 0xffff0000, v154
  v_and_b32 v57, 0xffff0000, v56
  v_lshlrev_b32 v56, 16, v56
  v_lshlrev_b32 v60, 16, v164
  v_and_b32 v61, 0xffff0000, v164
  v_pk_mul_f32 v[56:57], v[56:57], v[58:59]
  v_cvt_pk_bf16_f32 v56, v56, v57
  v_and_b32 v57, 0xffff0000, v56
  v_lshlrev_b32 v56, 16, v56
  v_pk_add_f32 v[56:57], v[56:57], v[60:61]
  v_cvt_pk_bf16_f32 v164, v56, v57
  v_cvt_pk_bf16_f32 v64, v102, v103
  v_lshlrev_b32 v66, 16, v155
  v_and_b32 v67, 0xffff0000, v155
  v_and_b32 v65, 0xffff0000, v64
  v_lshlrev_b32 v64, 16, v64
  v_lshlrev_b32 v68, 16, v165
  v_and_b32 v69, 0xffff0000, v165
  v_pk_mul_f32 v[64:65], v[64:65], v[66:67]
  v_cvt_pk_bf16_f32 v64, v64, v65
  v_and_b32 v65, 0xffff0000, v64
  v_lshlrev_b32 v64, 16, v64
  v_pk_add_f32 v[64:65], v[64:65], v[68:69]
  v_cvt_pk_bf16_f32 v165, v64, v65
  buffer_store_dwordx2 v[164:165], v0, s[56:59], 0 offen offset:96
  v_cvt_pk_bf16_f32 v72, v104, v105
  v_lshlrev_b32 v74, 16, v156
  v_and_b32 v75, 0xffff0000, v156
  v_and_b32 v73, 0xffff0000, v72
  v_lshlrev_b32 v72, 16, v72
  v_lshlrev_b32 v76, 16, v166
  v_and_b32 v77, 0xffff0000, v166
  v_pk_mul_f32 v[72:73], v[72:73], v[74:75]
  v_cvt_pk_bf16_f32 v72, v72, v73
  v_and_b32 v73, 0xffff0000, v72
  v_lshlrev_b32 v72, 16, v72
  v_pk_add_f32 v[72:73], v[72:73], v[76:77]
  v_cvt_pk_bf16_f32 v166, v72, v73
  v_cvt_pk_bf16_f32 v80, v106, v107
  v_lshlrev_b32 v82, 16, v157
  v_and_b32 v83, 0xffff0000, v157
  v_and_b32 v81, 0xffff0000, v80
  v_lshlrev_b32 v80, 16, v80
  v_lshlrev_b32 v84, 16, v167
  v_and_b32 v85, 0xffff0000, v167
  v_pk_mul_f32 v[80:81], v[80:81], v[82:83]
  v_cvt_pk_bf16_f32 v80, v80, v81
  v_and_b32 v81, 0xffff0000, v80
  v_lshlrev_b32 v80, 16, v80
  v_pk_add_f32 v[80:81], v[80:81], v[84:85]
  v_cvt_pk_bf16_f32 v167, v80, v81
  buffer_store_dwordx2 v[166:167], v0, s[56:59], 0 offen offset:128
K2_END:
  s_endpgm
.section .rodata,"a"
.p2align 6
.amdhsa_kernel attn_kernel
  .amdhsa_next_free_vgpr 168
  .amdhsa_next_free_sgpr 102
  .amdhsa_accum_offset 168
  .amdhsa_group_segment_fixed_size 0
  .amdhsa_kernarg_size 72
  .amdhsa_user_sgpr_count 2
  .amdhsa_user_sgpr_kernarg_segment_ptr 1
  .amdhsa_system_sgpr_workgroup_id_x 1
  .amdhsa_float_denorm_mode_32 3
.end_amdhsa_kernel
```
